```python
import torch

def _softmax(x, axis=-1):
    return torch.softmax(x, dim=axis)
def _gelu(x):
    return torch.nn.functional.gelu(x, approximate="tanh")
def _silu(x):
    return torch.nn.functional.silu(x)
def _sigmoid(x):
    return torch.sigmoid(x)
def _layernorm(x, axis=-1, eps=1e-5):
    m = x.mean(dim=axis, keepdim=True)
    v = x.var(dim=axis, keepdim=True, unbiased=False)
    return (x - m) / torch.sqrt(v + eps)
def _scatter_add(tgt, idx, src, axis=0):
    return tgt.clone().index_add_(axis, idx, src)
def _segment_sum(src, seg, n):
    out = torch.zeros((n,) + src.shape[1:], dtype=src.dtype)
    return out.index_add_(0, seg, src)
def _pad(x, pw):
    flat = tuple(v for pair in reversed(pw) for v in pair)
    return torch.nn.functional.pad(x, flat)

kernel_name = 'interleave_layers__mha_block__glu_gated_geglu__prompt'

def setup_inputs():

    _w = (lambda a: (lambda t: t.to(torch.bfloat16) if t.is_floating_point() else t)(torch.as_tensor(a)))
    def _A_setup():
        B, S, D, H = 1, 2048, 640, 32
        return {
            "x": _w((lambda *s: torch.randn(*s, dtype=torch.bfloat16) * 0.05)(B, S, D)),
            "wqkv": _w((lambda *s: torch.randn(*s, dtype=torch.bfloat16) * 0.05)(D, 3 * D)),
            "wo": _w((lambda *s: torch.randn(*s, dtype=torch.bfloat16) * 0.05)(D, D)),
        }
    _A_in = _A_setup()

    def _B_setup():
        B, S, Dm, Df = 1, 2048, 640, 1728
        return {
            "x": _w((lambda *s: torch.randn(*s, dtype=torch.bfloat16) * 0.05)(B, S, Dm)),
            "w_gate": _w((lambda *s: torch.randn(*s, dtype=torch.bfloat16) * 0.8)(Dm, Df) * (Dm ** -0.5)),
            "w_up": _w((lambda *s: torch.randn(*s, dtype=torch.bfloat16) * 0.8)(Dm, Df) * (Dm ** -0.5)),
            "w_down": _w((lambda *s: torch.randn(*s, dtype=torch.bfloat16) * 0.8)(Df, Dm) * (Df ** -0.5)),
        }
    _B_in = _B_setup()

    return {
        "A_x": _A_in["x"],
        "A_wqkv": _A_in["wqkv"],
        "A_wo": _A_in["wo"],
        "B_x": _B_in["x"],
        "B_w_gate": _B_in["w_gate"],
        "B_w_up": _B_in["w_up"],
        "B_w_down": _B_in["w_down"],
    }

def reference(A_x, A_wqkv, A_wo, B_x, B_w_gate, B_w_up, B_w_down):
    def _A_ref(x, wqkv, wo):
        B, S, D = x.shape
        H = 32
        Dh = D // H
        qkv = (lambda x, *d: x.permute(*d))((x @ wqkv).reshape(B, S, 3, H, Dh), 2, 0, 3, 1, 4)
        q, k, v = qkv[0], qkv[1], qkv[2]
        scores = torch.einsum("bhqd,bhkd->bhqk", q, k) * (Dh ** -0.5)
        p = _softmax(scores, axis=-1)
        o = torch.einsum("bhqk,bhkd->bhqd", p, v)
        return (lambda x, *d: x.permute(*d))(o, 0, 2, 1, 3).reshape(B, S, D) @ wo

    def _B_ref(x, w_gate, w_up, w_down):
        g = torch.einsum("bsd,df->bsf", x, w_gate)
        u = torch.einsum("bsd,df->bsf", x, w_up)
        h = _gelu(g) * u
        return torch.einsum("bsf,fd->bsd", h, w_down)

    x = A_x
    x = x + _A_ref(_layernorm(x, axis=-1), A_wqkv, A_wo)
    x = x + _B_ref(_layernorm(x, axis=-1), B_w_gate, B_w_up, B_w_down)
    x = x + _A_ref(_layernorm(x, axis=-1), A_wqkv, A_wo)
    x = x + _B_ref(_layernorm(x, axis=-1), B_w_gate, B_w_up, B_w_down)
    return x
```

```asm
; @launch kernel=prep_kernel grid=(943,1,1) block=(256,1,1) lds=17408
; @launch kernel=qkv_kernel grid=(240,1,1) block=(256,1,1) lds=163840
; @launch kernel=attn_kernel grid=(256,1,1) block=(512,1,1) lds=163840
; @launch kernel=wo_kernel grid=(256,1,1) block=(256,1,1) lds=81920
; @launch kernel=gu_kernel grid=(224,1,1) block=(256,1,1) lds=163840
; @launch kernel=down_kernel grid=(256,1,1) block=(256,1,1) lds=81920
; @launch kernel=qkv_kernel grid=(240,1,1) block=(256,1,1) lds=163840
; @launch kernel=attn_kernel grid=(256,1,1) block=(512,1,1) lds=163840
; @launch kernel=wo_kernel grid=(256,1,1) block=(256,1,1) lds=81920
; @launch kernel=gu_kernel grid=(224,1,1) block=(256,1,1) lds=163840
; @launch kernel=downf_kernel grid=(256,1,1) block=(256,1,1) lds=81920
.amdgcn_target "amdgcn-amd-amdhsa--gfx950"
.text
.globl prep_kernel
.p2align 8
.type prep_kernel,@function
prep_kernel:
    s_load_dwordx16 s[4:19], s[0:1], 0
    s_load_dwordx4 s[20:23], s[0:1], 64
    v_lshrrev_b32 v1, 6, v0
    v_mov_b32 v40, v0
    v_and_b32 v0, 63, v0
    s_nop 0
    v_readfirstlane_b32 s24, v1
    v_and_b32 v2, 31, v0
    v_lshrrev_b32 v3, 5, v0
    v_lshlrev_b32 v4, 4, v0
    v_and_b32 v41, 15, v40
    v_lshrrev_b32 v42, 4, v40
    s_waitcnt lgkmcnt(0)
    s_add_u32 s48, s22, 0x0
    s_addc_u32 s49, s23, 0
    s_and_b32 s49, s49, 0xffff
    s_mov_b32 s50, 0x10000000
    s_mov_b32 s51, 0x00020000
    s_cmp_ge_u32 s2, 943
    s_cbranch_scc1 L_prep_end
    s_cmp_ge_u32 s2, 943
    s_cbranch_scc1 L_prep_pad
    s_cmp_ge_u32 s2, 783
    s_cbranch_scc1 L_prep_x
    s_cmp_lt_u32 s2, 168
    s_cbranch_scc1 L_prep_cs
    s_cmp_ge_u32 s2, 318
    s_cbranch_scc1 L_prep_nq
    s_mov_b32 s28, s6
    s_and_b32 s29, s7, 0xffff
    s_mov_b32 s30, 0x258000
    s_mov_b32 s31, 0x00020000
    s_mov_b32 s32, 3840
    s_sub_u32 s34, s2, 168
    s_mul_hi_u32 s37, s34, 0x11111112
    s_mul_i32 s38, s37, 15
    s_sub_u32 s38, s34, s38
    s_mov_b32 s35, 0x0
    s_mov_b32 s36, 40
    s_mov_b32 s33, 60
    s_branch L_prep_w
L_prep_nq:
    s_cmp_ge_u32 s2, 368
    s_cbranch_scc1 L_prep_no
    s_mov_b32 s28, s8
    s_and_b32 s29, s9, 0xffff
    s_mov_b32 s30, 0xc8000
    s_mov_b32 s31, 0x00020000
    s_mov_b32 s32, 1280
    s_sub_u32 s34, s2, 318
    s_mul_hi_u32 s37, s34, 0x33333334
    s_mul_i32 s38, s37, 5
    s_sub_u32 s38, s34, s38
    s_mov_b32 s35, 0x400000
    s_mov_b32 s36, 40
    s_mov_b32 s33, 20
    s_branch L_prep_w
L_prep_no:
    s_cmp_ge_u32 s2, 508
    s_cbranch_scc1 L_prep_ng
    s_mov_b32 s28, s12
    s_and_b32 s29, s13, 0xffff
    s_mov_b32 s30, 0x21c000
    s_mov_b32 s31, 0x00020000
    s_mov_b32 s32, 3456
    s_sub_u32 s34, s2, 368
    s_mul_hi_u32 s37, s34, 0x12492493
    s_mul_i32 s38, s37, 14
    s_sub_u32 s38, s34, s38
    s_mov_b32 s35, 0x600000
    s_mov_b32 s36, 40
    s_mov_b32 s33, 54
    s_branch L_prep_w
L_prep_ng:
    s_cmp_ge_u32 s2, 648
    s_cbranch_scc1 L_prep_nu
    s_mov_b32 s28, s14
    s_and_b32 s29, s15, 0xffff
    s_mov_b32 s30, 0x21c000
    s_mov_b32 s31, 0x00020000
    s_mov_b32 s32, 3456
    s_sub_u32 s34, s2, 508
    s_mul_hi_u32 s37, s34, 0x12492493
    s_mul_i32 s38, s37, 14
    s_sub_u32 s38, s34, s38
    s_mov_b32 s35, 0x900000
    s_mov_b32 s36, 40
    s_mov_b32 s33, 54
    s_branch L_prep_w
L_prep_nu:
    s_cmp_ge_u32 s2, 783
    s_cbranch_scc1 L_prep_nd
    s_mov_b32 s28, s16
    s_and_b32 s29, s17, 0xffff
    s_mov_b32 s30, 0x21c000
    s_mov_b32 s31, 0x00020000
    s_mov_b32 s32, 1280
    s_sub_u32 s34, s2, 648
    s_mul_hi_u32 s37, s34, 0x33333334
    s_mul_i32 s38, s37, 5
    s_sub_u32 s38, s34, s38
    s_mov_b32 s35, 0xc00000
    s_mov_b32 s36, 108
    s_mov_b32 s33, 20
    s_branch L_prep_w
L_prep_nd:
L_prep_w:
    s_lshl_b32 s41, s37, 6
    v_add_u32 v5, s41, v42
    v_mul_lo_u32 v5, v5, s32
    s_lshl_b32 s41, s38, 8
    v_lshl_add_u32 v6, v41, 4, s41
    v_add_u32 v5, v5, v6
    s_mul_i32 s42, s32, 0
    buffer_load_dwordx4 v[16:19], v5, s[28:31], s42 offen
    s_mul_i32 s42, s32, 16
    buffer_load_dwordx4 v[20:23], v5, s[28:31], s42 offen
    s_mul_i32 s42, s32, 32
    buffer_load_dwordx4 v[24:27], v5, s[28:31], s42 offen
    s_mul_i32 s42, s32, 48
    buffer_load_dwordx4 v[28:31], v5, s[28:31], s42 offen
    v_mul_u32_u24 v6, 272, v42
    v_lshl_add_u32 v6, v41, 4, v6
    v_bfe_u32 v7, v0, 2, 2
    v_lshl_add_u32 v7, v3, 2, v7
    v_mul_u32_u24 v7, 272, v7
    v_and_b32 v8, 3, v0
    v_lshl_add_u32 v7, v8, 3, v7
    v_bfe_u32 v8, v0, 4, 1
    v_lshl_add_u32 v7, v8, 5, v7
    s_lshl_b32 s41, s24, 6
    v_add_u32 v7, s41, v7
    s_waitcnt vmcnt(0)
    ds_write_b128 v6, v[16:19] offset:0
    ds_write_b128 v6, v[20:23] offset:4352
    ds_write_b128 v6, v[24:27] offset:8704
    ds_write_b128 v6, v[28:31] offset:13056
    s_waitcnt lgkmcnt(0)
    s_barrier
    ds_read_b64_tr_b16 v[16:17], v7 offset:0
    ds_read_b64_tr_b16 v[18:19], v7 offset:2176
    ds_read_b64_tr_b16 v[20:21], v7 offset:4352
    ds_read_b64_tr_b16 v[22:23], v7 offset:6528
    ds_read_b64_tr_b16 v[24:25], v7 offset:8704
    ds_read_b64_tr_b16 v[26:27], v7 offset:10880
    ds_read_b64_tr_b16 v[28:29], v7 offset:13056
    ds_read_b64_tr_b16 v[30:31], v7 offset:15232
    s_lshl_b32 s43, s38, 2
    s_add_u32 s43, s43, s24
    s_cmp_ge_u32 s43, s33
    s_cbranch_scc1 L_prep_end
    s_mul_i32 s43, s43, s36
    s_lshl_b32 s44, s37, 2
    s_add_u32 s43, s43, s44
    s_lshl_b32 s43, s43, 10
    s_add_u32 s43, s43, s35
    s_waitcnt lgkmcnt(0)
    buffer_store_dwordx4 v[16:19], v4, s[48:51], s43 offen offset:0
    buffer_store_dwordx4 v[20:23], v4, s[48:51], s43 offen offset:1024
    buffer_store_dwordx4 v[24:27], v4, s[48:51], s43 offen offset:2048
    buffer_store_dwordx4 v[28:31], v4, s[48:51], s43 offen offset:3072
    s_branch L_prep_end
L_prep_pad:
    s_sub_u32 s34, s2, 943
    s_lshl_b32 s34, s34, 2
    s_add_u32 s34, s34, s24
    s_lshl_b32 s34, s34, 11
    v_mov_b32 v16, 0
    v_mov_b32 v17, 0
    v_mov_b32 v18, 0
    v_mov_b32 v19, 0
    v_cmp_eq_u32 vcc, 20, v2
    v_cmp_eq_u32 s[44:45], 24, v2
    s_or_b64 vcc, vcc, s[44:45]
    v_mov_b32 v24, 0x3f803f80
    s_nop 1
    v_cndmask_b32 v20, 0, v24, vcc
    v_cndmask_b32 v21, 0, v24, vcc
    v_cndmask_b32 v22, 0, v24, vcc
    v_cndmask_b32 v23, 0, v24, vcc
    s_add_u32 s35, s34, 0x1400000
    buffer_store_dwordx4 v[16:19], v4, s[48:51], s35 offen offset:1024
    s_add_u32 s35, s34, 0x1800000
    buffer_store_dwordx4 v[16:19], v4, s[48:51], s35 offen offset:1024
    s_add_u32 s35, s34, 0x1c00000
    buffer_store_dwordx4 v[20:23], v4, s[48:51], s35 offen
    buffer_store_dwordx4 v[20:23], v4, s[48:51], s35 offen offset:1024
    s_branch L_prep_end
L_prep_x:
    s_mov_b32 s28, s4
    s_and_b32 s29, s5, 0xffff
    s_mov_b32 s30, 0x280000
    s_mov_b32 s31, 0x00020000
    s_sub_u32 s34, s2, 783
    s_lshl_b32 s34, s34, 2
    s_add_u32 s34, s34, s24
    s_mul_hi_u32 s37, s34, 0x1999999a
    s_mul_i32 s38, s37, 10
    s_sub_u32 s38, s34, s38
    s_lshl_b32 s39, s37, 5
    v_add_u32 v5, s39, v2
    s_movk_i32 s32, 1280
    v_mul_lo_u32 v6, v5, s32
    v_lshl_add_u32 v6, v3, 3, v6
    s_lshl_b32 s41, s38, 7
    buffer_load_dwordx2 v[16:17], v6, s[28:31], s41 offen offset:0
    buffer_load_dwordx2 v[18:19], v6, s[28:31], s41 offen offset:16
    buffer_load_dwordx2 v[20:21], v6, s[28:31], s41 offen offset:32
    buffer_load_dwordx2 v[22:23], v6, s[28:31], s41 offen offset:48
    buffer_load_dwordx2 v[24:25], v6, s[28:31], s41 offen offset:64
    buffer_load_dwordx2 v[26:27], v6, s[28:31], s41 offen offset:80
    buffer_load_dwordx2 v[28:29], v6, s[28:31], s41 offen offset:96
    buffer_load_dwordx2 v[30:31], v6, s[28:31], s41 offen offset:112
    s_mul_i32 s43, s37, 40
    s_lshl_b32 s44, s38, 2
    s_add_u32 s43, s43, s44
    s_lshl_b32 s43, s43, 10
    s_add_u32 s43, s43, 0x1000000
    v_mov_b32 v9, 0x3f803f80
    s_waitcnt vmcnt(0)
    buffer_store_dwordx4 v[16:19], v4, s[48:51], s43 offen offset:0
    buffer_store_dwordx4 v[20:23], v4, s[48:51], s43 offen offset:1024
    buffer_store_dwordx4 v[24:27], v4, s[48:51], s43 offen offset:2048
    buffer_store_dwordx4 v[28:31], v4, s[48:51], s43 offen offset:3072
    v_mov_b32 v44, 0
    v_mov_b32 v45, 0
    v_dot2_f32_bf16 v44, v16, v9, v44
    v_dot2_f32_bf16 v45, v16, v16, v45
    v_dot2_f32_bf16 v44, v17, v9, v44
    v_dot2_f32_bf16 v45, v17, v17, v45
    v_dot2_f32_bf16 v44, v18, v9, v44
    v_dot2_f32_bf16 v45, v18, v18, v45
    v_dot2_f32_bf16 v44, v19, v9, v44
    v_dot2_f32_bf16 v45, v19, v19, v45
    v_dot2_f32_bf16 v44, v20, v9, v44
    v_dot2_f32_bf16 v45, v20, v20, v45
    v_dot2_f32_bf16 v44, v21, v9, v44
    v_dot2_f32_bf16 v45, v21, v21, v45
    v_dot2_f32_bf16 v44, v22, v9, v44
    v_dot2_f32_bf16 v45, v22, v22, v45
    v_dot2_f32_bf16 v44, v23, v9, v44
    v_dot2_f32_bf16 v45, v23, v23, v45
    v_mov_b32 v46, 0
    v_mov_b32 v47, 0
    v_dot2_f32_bf16 v46, v24, v9, v46
    v_dot2_f32_bf16 v47, v24, v24, v47
    v_dot2_f32_bf16 v46, v25, v9, v46
    v_dot2_f32_bf16 v47, v25, v25, v47
    v_dot2_f32_bf16 v46, v26, v9, v46
    v_dot2_f32_bf16 v47, v26, v26, v47
    v_dot2_f32_bf16 v46, v27, v9, v46
    v_dot2_f32_bf16 v47, v27, v27, v47
    v_dot2_f32_bf16 v46, v28, v9, v46
    v_dot2_f32_bf16 v47, v28, v28, v47
    v_dot2_f32_bf16 v46, v29, v9, v46
    v_dot2_f32_bf16 v47, v29, v29, v47
    v_dot2_f32_bf16 v46, v30, v9, v46
    v_dot2_f32_bf16 v47, v30, v30, v47
    v_dot2_f32_bf16 v46, v31, v9, v46
    v_dot2_f32_bf16 v47, v31, v31, v47
    s_nop 4
    v_mov_b32 v48, v44
    v_mov_b32 v49, v45
    v_mov_b32 v50, v46
    v_mov_b32 v51, v47
    s_nop 1
    v_permlane32_swap_b32 v48, v44
    v_permlane32_swap_b32 v49, v45
    v_permlane32_swap_b32 v50, v46
    v_permlane32_swap_b32 v51, v47
    s_nop 1
    v_add_f32 v44, v44, v48
    v_add_f32 v45, v45, v49
    v_add_f32 v46, v46, v50
    v_add_f32 v47, v47, v51
    v_lshlrev_b32 v7, 3, v5
    s_lshl_b32 s44, s38, 15
    s_add_u32 s44, s44, 0x1300000
    s_add_u32 s45, s44, 16384
    buffer_store_dwordx2 v[44:45], v7, s[48:51], s44 offen
    buffer_store_dwordx2 v[46:47], v7, s[48:51], s45 offen
    s_branch L_prep_end
L_prep_cs:
    s_cmp_ge_u32 s2, 60
    s_cbranch_scc1 L_cs_nq
    s_mov_b32 s28, s6
    s_and_b32 s29, s7, 0xffff
    s_mov_b32 s30, 0x258000
    s_mov_b32 s31, 0x00020000
    s_mov_b32 s32, 3840
    s_sub_u32 s38, s2, 0
    s_add_u32 s52, s22, 0xf00000
    s_addc_u32 s53, s23, 0
    s_and_b32 s53, s53, 0xffff
    s_mov_b32 s54, 0x1e00
    s_mov_b32 s55, 0x00020000
    s_branch L_cs_w
L_cs_nq:
    s_cmp_ge_u32 s2, 114
    s_cbranch_scc1 L_cs_ng
    s_mov_b32 s28, s12
    s_and_b32 s29, s13, 0xffff
    s_mov_b32 s30, 0x21c000
    s_mov_b32 s31, 0x00020000
    s_mov_b32 s32, 3456
    s_sub_u32 s38, s2, 60
    s_add_u32 s52, s22, 0xf04000
    s_addc_u32 s53, s23, 0
    s_and_b32 s53, s53, 0xffff
    s_mov_b32 s54, 0x1b00
    s_mov_b32 s55, 0x00020000
    s_branch L_cs_w
L_cs_ng:
    s_cmp_ge_u32 s2, 168
    s_cbranch_scc1 L_cs_nu
    s_mov_b32 s28, s14
    s_and_b32 s29, s15, 0xffff
    s_mov_b32 s30, 0x21c000
    s_mov_b32 s31, 0x00020000
    s_mov_b32 s32, 3456
    s_sub_u32 s38, s2, 114
    s_add_u32 s52, s22, 0xf08000
    s_addc_u32 s53, s23, 0
    s_and_b32 s53, s53, 0xffff
    s_mov_b32 s54, 0x1b00
    s_mov_b32 s55, 0x00020000
    s_branch L_cs_w
L_cs_nu:
L_cs_w:
    v_and_b32 v41, 3, v40
    v_lshrrev_b32 v42, 2, v40
    v_mul_lo_u32 v5, v42, s32
    s_lshl_b32 s41, s38, 6
    v_lshl_add_u32 v6, v41, 4, s41
    v_add_u32 v5, v5, v6
    s_mul_i32 s42, s32, 0
    buffer_load_dwordx4 v[48:51], v5, s[28:31], s42 offen
    s_mul_i32 s42, s32, 64
    buffer_load_dwordx4 v[52:55], v5, s[28:31], s42 offen
    s_mul_i32 s42, s32, 128
    buffer_load_dwordx4 v[56:59], v5, s[28:31], s42 offen
    s_mul_i32 s42, s32, 192
    buffer_load_dwordx4 v[60:63], v5, s[28:31], s42 offen
    s_mul_i32 s42, s32, 256
    buffer_load_dwordx4 v[64:67], v5, s[28:31], s42 offen
    s_mul_i32 s42, s32, 320
    buffer_load_dwordx4 v[68:71], v5, s[28:31], s42 offen
    s_mul_i32 s42, s32, 384
    buffer_load_dwordx4 v[72:75], v5, s[28:31], s42 offen
    s_mul_i32 s42, s32, 448
    buffer_load_dwordx4 v[76:79], v5, s[28:31], s42 offen
    s_mul_i32 s42, s32, 512
    buffer_load_dwordx4 v[80:83], v5, s[28:31], s42 offen
    s_mul_i32 s42, s32, 576
    buffer_load_dwordx4 v[84:87], v5, s[28:31], s42 offen
    v_mov_b32 v16, 0
    v_mov_b32 v17, 0
    v_mov_b32 v18, 0
    v_mov_b32 v19, 0
    v_mov_b32 v20, 0
    v_mov_b32 v21, 0
    v_mov_b32 v22, 0
    v_mov_b32 v23, 0
    s_waitcnt vmcnt(9)
    v_lshlrev_b32 v24, 16, v48
    v_and_b32 v25, 0xffff0000, v48
    v_add_f32 v16, v16, v24
    v_add_f32 v17, v17, v25
    v_lshlrev_b32 v24, 16, v49
    v_and_b32 v25, 0xffff0000, v49
    v_add_f32 v18, v18, v24
    v_add_f32 v19, v19, v25
    v_lshlrev_b32 v24, 16, v50
    v_and_b32 v25, 0xffff0000, v50
    v_add_f32 v20, v20, v24
    v_add_f32 v21, v21, v25
    v_lshlrev_b32 v24, 16, v51
    v_and_b32 v25, 0xffff0000, v51
    v_add_f32 v22, v22, v24
    v_add_f32 v23, v23, v25
    s_waitcnt vmcnt(8)
    v_lshlrev_b32 v24, 16, v52
    v_and_b32 v25, 0xffff0000, v52
    v_add_f32 v16, v16, v24
    v_add_f32 v17, v17, v25
    v_lshlrev_b32 v24, 16, v53
    v_and_b32 v25, 0xffff0000, v53
    v_add_f32 v18, v18, v24
    v_add_f32 v19, v19, v25
    v_lshlrev_b32 v24, 16, v54
    v_and_b32 v25, 0xffff0000, v54
    v_add_f32 v20, v20, v24
    v_add_f32 v21, v21, v25
    v_lshlrev_b32 v24, 16, v55
    v_and_b32 v25, 0xffff0000, v55
    v_add_f32 v22, v22, v24
    v_add_f32 v23, v23, v25
    s_waitcnt vmcnt(7)
    v_lshlrev_b32 v24, 16, v56
    v_and_b32 v25, 0xffff0000, v56
    v_add_f32 v16, v16, v24
    v_add_f32 v17, v17, v25
    v_lshlrev_b32 v24, 16, v57
    v_and_b32 v25, 0xffff0000, v57
    v_add_f32 v18, v18, v24
    v_add_f32 v19, v19, v25
    v_lshlrev_b32 v24, 16, v58
    v_and_b32 v25, 0xffff0000, v58
    v_add_f32 v20, v20, v24
    v_add_f32 v21, v21, v25
    v_lshlrev_b32 v24, 16, v59
    v_and_b32 v25, 0xffff0000, v59
    v_add_f32 v22, v22, v24
    v_add_f32 v23, v23, v25
    s_waitcnt vmcnt(6)
    v_lshlrev_b32 v24, 16, v60
    v_and_b32 v25, 0xffff0000, v60
    v_add_f32 v16, v16, v24
    v_add_f32 v17, v17, v25
    v_lshlrev_b32 v24, 16, v61
    v_and_b32 v25, 0xffff0000, v61
    v_add_f32 v18, v18, v24
    v_add_f32 v19, v19, v25
    v_lshlrev_b32 v24, 16, v62
    v_and_b32 v25, 0xffff0000, v62
    v_add_f32 v20, v20, v24
    v_add_f32 v21, v21, v25
    v_lshlrev_b32 v24, 16, v63
    v_and_b32 v25, 0xffff0000, v63
    v_add_f32 v22, v22, v24
    v_add_f32 v23, v23, v25
    s_waitcnt vmcnt(5)
    v_lshlrev_b32 v24, 16, v64
    v_and_b32 v25, 0xffff0000, v64
    v_add_f32 v16, v16, v24
    v_add_f32 v17, v17, v25
    v_lshlrev_b32 v24, 16, v65
    v_and_b32 v25, 0xffff0000, v65
    v_add_f32 v18, v18, v24
    v_add_f32 v19, v19, v25
    v_lshlrev_b32 v24, 16, v66
    v_and_b32 v25, 0xffff0000, v66
    v_add_f32 v20, v20, v24
    v_add_f32 v21, v21, v25
    v_lshlrev_b32 v24, 16, v67
    v_and_b32 v25, 0xffff0000, v67
    v_add_f32 v22, v22, v24
    v_add_f32 v23, v23, v25
    s_waitcnt vmcnt(4)
    v_lshlrev_b32 v24, 16, v68
    v_and_b32 v25, 0xffff0000, v68
    v_add_f32 v16, v16, v24
    v_add_f32 v17, v17, v25
    v_lshlrev_b32 v24, 16, v69
    v_and_b32 v25, 0xffff0000, v69
    v_add_f32 v18, v18, v24
    v_add_f32 v19, v19, v25
    v_lshlrev_b32 v24, 16, v70
    v_and_b32 v25, 0xffff0000, v70
    v_add_f32 v20, v20, v24
    v_add_f32 v21, v21, v25
    v_lshlrev_b32 v24, 16, v71
    v_and_b32 v25, 0xffff0000, v71
    v_add_f32 v22, v22, v24
    v_add_f32 v23, v23, v25
    s_waitcnt vmcnt(3)
    v_lshlrev_b32 v24, 16, v72
    v_and_b32 v25, 0xffff0000, v72
    v_add_f32 v16, v16, v24
    v_add_f32 v17, v17, v25
    v_lshlrev_b32 v24, 16, v73
    v_and_b32 v25, 0xffff0000, v73
    v_add_f32 v18, v18, v24
    v_add_f32 v19, v19, v25
    v_lshlrev_b32 v24, 16, v74
    v_and_b32 v25, 0xffff0000, v74
    v_add_f32 v20, v20, v24
    v_add_f32 v21, v21, v25
    v_lshlrev_b32 v24, 16, v75
    v_and_b32 v25, 0xffff0000, v75
    v_add_f32 v22, v22, v24
    v_add_f32 v23, v23, v25
    s_waitcnt vmcnt(2)
    v_lshlrev_b32 v24, 16, v76
    v_and_b32 v25, 0xffff0000, v76
    v_add_f32 v16, v16, v24
    v_add_f32 v17, v17, v25
    v_lshlrev_b32 v24, 16, v77
    v_and_b32 v25, 0xffff0000, v77
    v_add_f32 v18, v18, v24
    v_add_f32 v19, v19, v25
    v_lshlrev_b32 v24, 16, v78
    v_and_b32 v25, 0xffff0000, v78
    v_add_f32 v20, v20, v24
    v_add_f32 v21, v21, v25
    v_lshlrev_b32 v24, 16, v79
    v_and_b32 v25, 0xffff0000, v79
    v_add_f32 v22, v22, v24
    v_add_f32 v23, v23, v25
    s_waitcnt vmcnt(1)
    v_lshlrev_b32 v24, 16, v80
    v_and_b32 v25, 0xffff0000, v80
    v_add_f32 v16, v16, v24
    v_add_f32 v17, v17, v25
    v_lshlrev_b32 v24, 16, v81
    v_and_b32 v25, 0xffff0000, v81
    v_add_f32 v18, v18, v24
    v_add_f32 v19, v19, v25
    v_lshlrev_b32 v24, 16, v82
    v_and_b32 v25, 0xffff0000, v82
    v_add_f32 v20, v20, v24
    v_add_f32 v21, v21, v25
    v_lshlrev_b32 v24, 16, v83
    v_and_b32 v25, 0xffff0000, v83
    v_add_f32 v22, v22, v24
    v_add_f32 v23, v23, v25
    s_waitcnt vmcnt(0)
    v_lshlrev_b32 v24, 16, v84
    v_and_b32 v25, 0xffff0000, v84
    v_add_f32 v16, v16, v24
    v_add_f32 v17, v17, v25
    v_lshlrev_b32 v24, 16, v85
    v_and_b32 v25, 0xffff0000, v85
    v_add_f32 v18, v18, v24
    v_add_f32 v19, v19, v25
    v_lshlrev_b32 v24, 16, v86
    v_and_b32 v25, 0xffff0000, v86
    v_add_f32 v20, v20, v24
    v_add_f32 v21, v21, v25
    v_lshlrev_b32 v24, 16, v87
    v_and_b32 v25, 0xffff0000, v87
    v_add_f32 v22, v22, v24
    v_add_f32 v23, v23, v25
    v_lshlrev_b32 v6, 7, v42
    v_lshl_add_u32 v6, v41, 5, v6
    ds_write_b128 v6, v[16:19]
    ds_write_b128 v6, v[20:23] offset:16
    s_waitcnt lgkmcnt(0)
    s_barrier
    s_cmp_ge_u32 s24, 1
    s_cbranch_scc1 L_prep_end
    v_lshlrev_b32 v6, 2, v2
    v_lshl_add_u32 v6, v3, 12, v6
    ds_read_b32 v64, v6 offset:0
    ds_read_b32 v65, v6 offset:128
    ds_read_b32 v66, v6 offset:256
    ds_read_b32 v67, v6 offset:384
    ds_read_b32 v68, v6 offset:512
    ds_read_b32 v69, v6 offset:640
    ds_read_b32 v70, v6 offset:768
    ds_read_b32 v71, v6 offset:896
    ds_read_b32 v72, v6 offset:1024
    ds_read_b32 v73, v6 offset:1152
    ds_read_b32 v74, v6 offset:1280
    ds_read_b32 v75, v6 offset:1408
    ds_read_b32 v76, v6 offset:1536
    ds_read_b32 v77, v6 offset:1664
    ds_read_b32 v78, v6 offset:1792
    ds_read_b32 v79, v6 offset:1920
    ds_read_b32 v80, v6 offset:2048
    ds_read_b32 v81, v6 offset:2176
    ds_read_b32 v82, v6 offset:2304
    ds_read_b32 v83, v6 offset:2432
    ds_read_b32 v84, v6 offset:2560
    ds_read_b32 v85, v6 offset:2688
    ds_read_b32 v86, v6 offset:2816
    ds_read_b32 v87, v6 offset:2944
    ds_read_b32 v88, v6 offset:3072
    ds_read_b32 v89, v6 offset:3200
    ds_read_b32 v90, v6 offset:3328
    ds_read_b32 v91, v6 offset:3456
    ds_read_b32 v92, v6 offset:3584
    ds_read_b32 v93, v6 offset:3712
    ds_read_b32 v94, v6 offset:3840
    ds_read_b32 v95, v6 offset:3968
    s_waitcnt lgkmcnt(0)
    v_add_f32 v64, v64, v65
    v_add_f32 v64, v64, v66
    v_add_f32 v64, v64, v67
    v_add_f32 v64, v64, v68
    v_add_f32 v64, v64, v69
    v_add_f32 v64, v64, v70
    v_add_f32 v64, v64, v71
    v_add_f32 v64, v64, v72
    v_add_f32 v64, v64, v73
    v_add_f32 v64, v64, v74
    v_add_f32 v64, v64, v75
    v_add_f32 v64, v64, v76
    v_add_f32 v64, v64, v77
    v_add_f32 v64, v64, v78
    v_add_f32 v64, v64, v79
    v_add_f32 v64, v64, v80
    v_add_f32 v64, v64, v81
    v_add_f32 v64, v64, v82
    v_add_f32 v64, v64, v83
    v_add_f32 v64, v64, v84
    v_add_f32 v64, v64, v85
    v_add_f32 v64, v64, v86
    v_add_f32 v64, v64, v87
    v_add_f32 v64, v64, v88
    v_add_f32 v64, v64, v89
    v_add_f32 v64, v64, v90
    v_add_f32 v64, v64, v91
    v_add_f32 v64, v64, v92
    v_add_f32 v64, v64, v93
    v_add_f32 v64, v64, v94
    v_add_f32 v64, v64, v95
    v_mov_b32 v65, v64
    s_nop 1
    v_permlane32_swap_b32 v65, v64
    s_nop 1
    v_add_f32 v64, v64, v65
    v_lshlrev_b32 v6, 2, v2
    s_lshl_b32 s41, s38, 7
    buffer_store_dword v64, v6, s[52:55], s41 offen
L_prep_end:
    s_endpgm
.globl qkv_kernel
.p2align 8
.type qkv_kernel,@function
qkv_kernel:
    s_load_dwordx2 s[4:5], s[0:1], 72
    s_cmp_ge_u32 s2, 240
    s_cbranch_scc1 L_qkv_end
    s_and_b32 s6, s2, 7
    s_lshr_b32 s7, s2, 3
    s_mul_hi_u32 s8, s7, 0x11111112
    s_mul_i32 s9, s8, 15
    s_sub_u32 s9, s7, s9
    s_lshl_b32 s6, s6, 1
    s_add_u32 s8, s8, s6
    v_lshrrev_b32 v1, 6, v0
    v_and_b32 v0, 63, v0
    s_nop 0
    v_readfirstlane_b32 s10, v1
    v_and_b32 v1, 31, v0
    v_lshrrev_b32 v2, 5, v0
    v_lshlrev_b32 v3, 4, v0
    v_add_u32 v4, 0x10000, v3
    v_add_u32 v5, 0x20000, v3
    s_waitcnt lgkmcnt(0)
    s_add_u32 s12, s4, 0x1000000
    s_addc_u32 s13, s5, 0
    s_and_b32 s13, s13, 0xffff
    s_mov_b32 s14, 0x280000
    s_mov_b32 s15, 0x00020000
    s_add_u32 s16, s4, 0x0
    s_addc_u32 s17, s5, 0
    s_and_b32 s17, s17, 0xffff
    s_mov_b32 s18, 0x258000
    s_mov_b32 s19, 0x00020000
    s_add_u32 s20, s4, 0x1300000
    s_addc_u32 s21, s5, 0
    s_and_b32 s21, s21, 0xffff
    s_mov_b32 s22, 0x50000
    s_mov_b32 s23, 0x00020000
    s_add_u32 s24, s4, 0xf00000
    s_addc_u32 s25, s5, 0
    s_and_b32 s25, s25, 0xffff
    s_mov_b32 s26, 0x1e00
    s_mov_b32 s27, 0x00020000
    s_add_u32 s28, s4, 0x1400000
    s_addc_u32 s29, s5, 0
    s_and_b32 s29, s29, 0xffff
    s_mov_b32 s30, 0xc00000
    s_mov_b32 s31, 0x00020000
    s_lshl_b32 s11, s9, 2
    s_add_u32 s11, s11, s10
    s_lshl_b32 s33, s8, 2
    s_add_u32 s33, s33, s10
    s_mul_i32 s34, s33, 40960
    s_lshl_b32 s35, s10, 10
    s_mul_i32 s36, s11, 40960
    v_add_u32 v6, s36, v3
    s_lshl_b32 s36, s33, 8
    v_lshl_add_u32 v9, v1, 3, s36
    s_lshl_b32 s36, s11, 7
    v_lshl_add_u32 v10, v2, 4, s36
    v_lshl_add_u32 v11, v1, 2, s36
    s_lshl_b32 s36, s10, 7
    v_lshl_add_u32 v16, v1, 2, s36
    s_mul_hi_u32 s44, s11, 0xccccccd
    s_mul_i32 s45, s44, 20
    s_sub_u32 s45, s11, s45
    s_lshl_b32 s45, s45, 5
    s_lshl_b32 s46, s44, 22
    s_mul_i32 s47, s8, 5120
    s_add_u32 s46, s46, s47
    s_cmp_eq_u32 s44, 2
    s_cbranch_scc1 L_qkv_v
L_qkv_qk:
    s_add_u32 s42, s35, 0x0
    s_mov_b32 m0, s42
    s_add_u32 s43, s34, 0x0
    buffer_load_dwordx4 v3, s[12:15], s43 offen lds
    s_mov_b32 s40, 0x0
    buffer_load_dwordx4 a[0:3], v6, s[16:19], s40 offen offset:0
    s_add_u32 s42, s35, 0x1000
    s_mov_b32 m0, s42
    s_add_u32 s43, s34, 0x400
    buffer_load_dwordx4 v3, s[12:15], s43 offen lds
    buffer_load_dwordx4 a[4:7], v6, s[16:19], s40 offen offset:1024
    s_add_u32 s42, s35, 0x2000
    s_mov_b32 m0, s42
    s_add_u32 s43, s34, 0x800
    buffer_load_dwordx4 v3, s[12:15], s43 offen lds
    buffer_load_dwordx4 a[8:11], v6, s[16:19], s40 offen offset:2048
    s_add_u32 s42, s35, 0x3000
    s_mov_b32 m0, s42
    s_add_u32 s43, s34, 0xc00
    buffer_load_dwordx4 v3, s[12:15], s43 offen lds
    buffer_load_dwordx4 a[12:15], v6, s[16:19], s40 offen offset:3072
    s_add_u32 s42, s35, 0x4000
    s_mov_b32 m0, s42
    s_add_u32 s43, s34, 0x1000
    buffer_load_dwordx4 v3, s[12:15], s43 offen lds
    s_mov_b32 s40, 0x1000
    buffer_load_dwordx4 a[16:19], v6, s[16:19], s40 offen offset:0
    s_add_u32 s42, s35, 0x5000
    s_mov_b32 m0, s42
    s_add_u32 s43, s34, 0x1400
    buffer_load_dwordx4 v3, s[12:15], s43 offen lds
    buffer_load_dwordx4 a[20:23], v6, s[16:19], s40 offen offset:1024
    s_add_u32 s42, s35, 0x6000
    s_mov_b32 m0, s42
    s_add_u32 s43, s34, 0x1800
    buffer_load_dwordx4 v3, s[12:15], s43 offen lds
    buffer_load_dwordx4 a[24:27], v6, s[16:19], s40 offen offset:2048
    s_add_u32 s42, s35, 0x7000
    s_mov_b32 m0, s42
    s_add_u32 s43, s34, 0x1c00
    buffer_load_dwordx4 v3, s[12:15], s43 offen lds
    buffer_load_dwordx4 a[28:31], v6, s[16:19], s40 offen offset:3072
    s_add_u32 s42, s35, 0x8000
    s_mov_b32 m0, s42
    s_add_u32 s43, s34, 0x2000
    buffer_load_dwordx4 v3, s[12:15], s43 offen lds
    s_mov_b32 s40, 0x2000
    buffer_load_dwordx4 a[32:35], v6, s[16:19], s40 offen offset:0
    s_add_u32 s42, s35, 0x9000
    s_mov_b32 m0, s42
    s_add_u32 s43, s34, 0x2400
    buffer_load_dwordx4 v3, s[12:15], s43 offen lds
    buffer_load_dwordx4 a[36:39], v6, s[16:19], s40 offen offset:1024
    buffer_load_dwordx4 a[40:43], v6, s[16:19], s40 offen offset:2048
    buffer_load_dwordx4 a[44:47], v6, s[16:19], s40 offen offset:3072
    s_mov_b32 s40, 0x3000
    buffer_load_dwordx4 a[48:51], v6, s[16:19], s40 offen offset:0
    buffer_load_dwordx4 a[52:55], v6, s[16:19], s40 offen offset:1024
    buffer_load_dwordx4 a[56:59], v6, s[16:19], s40 offen offset:2048
    buffer_load_dwordx4 a[60:63], v6, s[16:19], s40 offen offset:3072
    s_waitcnt vmcnt(7)
    s_barrier
    ds_read_b128 v[20:23], v3 offset:0
    ds_read_b128 v[24:27], v3 offset:1024
    ds_read_b128 v[28:31], v3 offset:2048
    ds_read_b128 v[32:35], v3 offset:3072
    ds_read_b128 v[36:39], v3 offset:4096
    ds_read_b128 v[40:43], v3 offset:5120
    ds_read_b128 v[44:47], v3 offset:6144
    ds_read_b128 v[48:51], v3 offset:7168
    ds_read_b128 v[52:55], v3 offset:8192
    ds_read_b128 v[56:59], v3 offset:9216
    ds_read_b128 v[60:63], v3 offset:10240
    ds_read_b128 v[64:67], v3 offset:11264
    s_waitcnt lgkmcnt(8)
    v_mfma_f32_32x32x16_bf16 v[128:143], a[0:3], v[20:23], 0
    v_mfma_f32_32x32x16_bf16 v[144:159], a[0:3], v[24:27], 0
    v_mfma_f32_32x32x16_bf16 v[160:175], a[0:3], v[28:31], 0
    v_mfma_f32_32x32x16_bf16 v[176:191], a[0:3], v[32:35], 0
    s_add_u32 s42, s35, 0xa000
    s_mov_b32 m0, s42
    s_add_u32 s43, s34, 0x2800
    buffer_load_dwordx4 v3, s[12:15], s43 offen lds
    s_add_u32 s42, s35, 0xb000
    s_mov_b32 m0, s42
    s_add_u32 s43, s34, 0x2c00
    buffer_load_dwordx4 v3, s[12:15], s43 offen lds
    s_mov_b32 s40, 0x4000
    buffer_load_dwordx4 a[0:3], v6, s[16:19], s40 offen offset:0
    ds_read_b128 v[20:23], v3 offset:12288
    ds_read_b128 v[24:27], v3 offset:13312
    ds_read_b128 v[28:31], v3 offset:14336
    ds_read_b128 v[32:35], v3 offset:15360
    s_waitcnt lgkmcnt(8)
    v_mfma_f32_32x32x16_bf16 v[128:143], a[4:7], v[36:39], v[128:143]
    v_mfma_f32_32x32x16_bf16 v[144:159], a[4:7], v[40:43], v[144:159]
    v_mfma_f32_32x32x16_bf16 v[160:175], a[4:7], v[44:47], v[160:175]
    v_mfma_f32_32x32x16_bf16 v[176:191], a[4:7], v[48:51], v[176:191]
    s_add_u32 s42, s35, 0xc000
    s_mov_b32 m0, s42
    s_add_u32 s43, s34, 0x3000
    buffer_load_dwordx4 v3, s[12:15], s43 offen lds
    s_add_u32 s42, s35, 0xd000
    s_mov_b32 m0, s42
    s_add_u32 s43, s34, 0x3400
    buffer_load_dwordx4 v3, s[12:15], s43 offen lds
    buffer_load_dwordx4 a[4:7], v6, s[16:19], s40 offen offset:1024
    s_mov_b32 s41, 0x0
    buffer_load_dwordx2 v[100:101], v9, s[20:23], s41 offen
    s_mov_b32 s41, 0x4000
    buffer_load_dwordx2 v[102:103], v9, s[20:23], s41 offen
    s_mov_b32 s41, 0x8000
    buffer_load_dwordx2 v[104:105], v9, s[20:23], s41 offen
    s_mov_b32 s41, 0xc000
    buffer_load_dwordx2 v[106:107], v9, s[20:23], s41 offen
    ds_read_b128 v[36:39], v3 offset:16384
    ds_read_b128 v[40:43], v3 offset:17408
    ds_read_b128 v[44:47], v3 offset:18432
    ds_read_b128 v[48:51], v3 offset:19456
    s_waitcnt lgkmcnt(8)
    v_mfma_f32_32x32x16_bf16 v[128:143], a[8:11], v[52:55], v[128:143]
    v_mfma_f32_32x32x16_bf16 v[144:159], a[8:11], v[56:59], v[144:159]
    v_mfma_f32_32x32x16_bf16 v[160:175], a[8:11], v[60:63], v[160:175]
    v_mfma_f32_32x32x16_bf16 v[176:191], a[8:11], v[64:67], v[176:191]
    s_add_u32 s42, s35, 0xe000
    s_mov_b32 m0, s42
    s_add_u32 s43, s34, 0x3800
    buffer_load_dwordx4 v3, s[12:15], s43 offen lds
    s_add_u32 s42, s35, 0xf000
    s_mov_b32 m0, s42
    s_add_u32 s43, s34, 0x3c00
    buffer_load_dwordx4 v3, s[12:15], s43 offen lds
    buffer_load_dwordx4 a[8:11], v6, s[16:19], s40 offen offset:2048
    ds_read_b128 v[52:55], v3 offset:20480
    ds_read_b128 v[56:59], v3 offset:21504
    ds_read_b128 v[60:63], v3 offset:22528
    ds_read_b128 v[64:67], v3 offset:23552
    s_waitcnt lgkmcnt(8)
    v_mfma_f32_32x32x16_bf16 v[128:143], a[12:15], v[20:23], v[128:143]
    v_mfma_f32_32x32x16_bf16 v[144:159], a[12:15], v[24:27], v[144:159]
    v_mfma_f32_32x32x16_bf16 v[160:175], a[12:15], v[28:31], v[160:175]
    v_mfma_f32_32x32x16_bf16 v[176:191], a[12:15], v[32:35], v[176:191]
    s_add_u32 s42, s35, 0x10000
    s_mov_b32 m0, s42
    s_add_u32 s43, s34, 0x4000
    buffer_load_dwordx4 v3, s[12:15], s43 offen lds
    s_add_u32 s42, s35, 0x11000
    s_mov_b32 m0, s42
    s_add_u32 s43, s34, 0x4400
    buffer_load_dwordx4 v3, s[12:15], s43 offen lds
    buffer_load_dwordx4 a[12:15], v6, s[16:19], s40 offen offset:3072
    s_mov_b32 s41, 0x10000
    buffer_load_dwordx2 v[108:109], v9, s[20:23], s41 offen
    s_mov_b32 s41, 0x14000
    buffer_load_dwordx2 v[110:111], v9, s[20:23], s41 offen
    s_mov_b32 s41, 0x18000
    buffer_load_dwordx2 v[112:113], v9, s[20:23], s41 offen
    s_mov_b32 s41, 0x1c000
    buffer_load_dwordx2 v[114:115], v9, s[20:23], s41 offen
    ds_read_b128 v[20:23], v3 offset:24576
    ds_read_b128 v[24:27], v3 offset:25600
    ds_read_b128 v[28:31], v3 offset:26624
    ds_read_b128 v[32:35], v3 offset:27648
    s_waitcnt lgkmcnt(8)
    v_mfma_f32_32x32x16_bf16 v[128:143], a[16:19], v[36:39], v[128:143]
    v_mfma_f32_32x32x16_bf16 v[144:159], a[16:19], v[40:43], v[144:159]
    v_mfma_f32_32x32x16_bf16 v[160:175], a[16:19], v[44:47], v[160:175]
    v_mfma_f32_32x32x16_bf16 v[176:191], a[16:19], v[48:51], v[176:191]
    s_add_u32 s42, s35, 0x12000
    s_mov_b32 m0, s42
    s_add_u32 s43, s34, 0x4800
    buffer_load_dwordx4 v3, s[12:15], s43 offen lds
    s_add_u32 s42, s35, 0x13000
    s_mov_b32 m0, s42
    s_add_u32 s43, s34, 0x4c00
    buffer_load_dwordx4 v3, s[12:15], s43 offen lds
    s_mov_b32 s40, 0x5000
    buffer_load_dwordx4 a[16:19], v6, s[16:19], s40 offen offset:0
    ds_read_b128 v[36:39], v3 offset:28672
    ds_read_b128 v[40:43], v3 offset:29696
    ds_read_b128 v[44:47], v3 offset:30720
    ds_read_b128 v[48:51], v3 offset:31744
    s_waitcnt lgkmcnt(8)
    v_mfma_f32_32x32x16_bf16 v[128:143], a[20:23], v[52:55], v[128:143]
    v_mfma_f32_32x32x16_bf16 v[144:159], a[20:23], v[56:59], v[144:159]
    v_mfma_f32_32x32x16_bf16 v[160:175], a[20:23], v[60:63], v[160:175]
    v_mfma_f32_32x32x16_bf16 v[176:191], a[20:23], v[64:67], v[176:191]
    s_add_u32 s42, s35, 0x14000
    s_mov_b32 m0, s42
    s_add_u32 s43, s34, 0x5000
    buffer_load_dwordx4 v3, s[12:15], s43 offen lds
    s_add_u32 s42, s35, 0x15000
    s_mov_b32 m0, s42
    s_add_u32 s43, s34, 0x5400
    buffer_load_dwordx4 v3, s[12:15], s43 offen lds
    buffer_load_dwordx4 a[20:23], v6, s[16:19], s40 offen offset:1024
    s_mov_b32 s41, 0x20000
    buffer_load_dwordx2 v[116:117], v9, s[20:23], s41 offen
    s_mov_b32 s41, 0x24000
    buffer_load_dwordx2 v[118:119], v9, s[20:23], s41 offen
    s_mov_b32 s41, 0x28000
    buffer_load_dwordx2 v[120:121], v9, s[20:23], s41 offen
    s_mov_b32 s41, 0x2c000
    buffer_load_dwordx2 v[122:123], v9, s[20:23], s41 offen
    ds_read_b128 v[52:55], v3 offset:32768
    ds_read_b128 v[56:59], v3 offset:33792
    ds_read_b128 v[60:63], v3 offset:34816
    ds_read_b128 v[64:67], v3 offset:35840
    s_waitcnt lgkmcnt(8)
    v_mfma_f32_32x32x16_bf16 v[128:143], a[24:27], v[20:23], v[128:143]
    v_mfma_f32_32x32x16_bf16 v[144:159], a[24:27], v[24:27], v[144:159]
    v_mfma_f32_32x32x16_bf16 v[160:175], a[24:27], v[28:31], v[160:175]
    v_mfma_f32_32x32x16_bf16 v[176:191], a[24:27], v[32:35], v[176:191]
    s_add_u32 s42, s35, 0x16000
    s_mov_b32 m0, s42
    s_add_u32 s43, s34, 0x5800
    buffer_load_dwordx4 v3, s[12:15], s43 offen lds
    s_add_u32 s42, s35, 0x17000
    s_mov_b32 m0, s42
    s_add_u32 s43, s34, 0x5c00
    buffer_load_dwordx4 v3, s[12:15], s43 offen lds
    buffer_load_dwordx4 a[24:27], v6, s[16:19], s40 offen offset:2048
    buffer_load_dwordx4 v[68:71], v10, s[24:27], 0 offen offset:0
    buffer_load_dwordx4 v[72:75], v10, s[24:27], 0 offen offset:32
    buffer_load_dwordx4 v[76:79], v10, s[24:27], 0 offen offset:64
    buffer_load_dwordx4 v[80:83], v10, s[24:27], 0 offen offset:96
    ds_read_b128 v[20:23], v3 offset:36864
    ds_read_b128 v[24:27], v3 offset:37888
    ds_read_b128 v[28:31], v3 offset:38912
    ds_read_b128 v[32:35], v3 offset:39936
    s_waitcnt lgkmcnt(8)
    v_mfma_f32_32x32x16_bf16 v[128:143], a[28:31], v[36:39], v[128:143]
    v_mfma_f32_32x32x16_bf16 v[144:159], a[28:31], v[40:43], v[144:159]
    v_mfma_f32_32x32x16_bf16 v[160:175], a[28:31], v[44:47], v[160:175]
    v_mfma_f32_32x32x16_bf16 v[176:191], a[28:31], v[48:51], v[176:191]
    s_add_u32 s42, s35, 0x18000
    s_mov_b32 m0, s42
    s_add_u32 s43, s34, 0x6000
    buffer_load_dwordx4 v3, s[12:15], s43 offen lds
    s_add_u32 s42, s35, 0x19000
    s_mov_b32 m0, s42
    s_add_u32 s43, s34, 0x6400
    buffer_load_dwordx4 v3, s[12:15], s43 offen lds
    buffer_load_dwordx4 a[28:31], v6, s[16:19], s40 offen offset:3072
    s_waitcnt vmcnt(30)
    v_mov_b32 v124, v100
    v_mov_b32 v125, v101
    v_add_f32 v124, v124, v102
    v_add_f32 v125, v125, v103
    v_add_f32 v124, v124, v104
    v_add_f32 v125, v125, v105
    v_add_f32 v124, v124, v106
    v_add_f32 v125, v125, v107
    s_mov_b32 s41, 0x30000
    buffer_load_dwordx2 v[100:101], v9, s[20:23], s41 offen
    s_mov_b32 s41, 0x34000
    buffer_load_dwordx2 v[102:103], v9, s[20:23], s41 offen
    s_mov_b32 s41, 0x38000
    buffer_load_dwordx2 v[104:105], v9, s[20:23], s41 offen
    s_mov_b32 s41, 0x3c000
    buffer_load_dwordx2 v[106:107], v9, s[20:23], s41 offen
    s_waitcnt lgkmcnt(4)
    v_mfma_f32_32x32x16_bf16 v[128:143], a[32:35], v[52:55], v[128:143]
    v_mfma_f32_32x32x16_bf16 v[144:159], a[32:35], v[56:59], v[144:159]
    v_mfma_f32_32x32x16_bf16 v[160:175], a[32:35], v[60:63], v[160:175]
    v_mfma_f32_32x32x16_bf16 v[176:191], a[32:35], v[64:67], v[176:191]
    s_add_u32 s42, s35, 0x1a000
    s_mov_b32 m0, s42
    s_add_u32 s43, s34, 0x6800
    buffer_load_dwordx4 v3, s[12:15], s43 offen lds
    s_add_u32 s42, s35, 0x1b000
    s_mov_b32 m0, s42
    s_add_u32 s43, s34, 0x6c00
    buffer_load_dwordx4 v3, s[12:15], s43 offen lds
    s_mov_b32 s40, 0x6000
    buffer_load_dwordx4 a[32:35], v6, s[16:19], s40 offen offset:0
    s_waitcnt lgkmcnt(0)
    v_mfma_f32_32x32x16_bf16 v[128:143], a[36:39], v[20:23], v[128:143]
    v_mfma_f32_32x32x16_bf16 v[144:159], a[36:39], v[24:27], v[144:159]
    v_mfma_f32_32x32x16_bf16 v[160:175], a[36:39], v[28:31], v[160:175]
    v_mfma_f32_32x32x16_bf16 v[176:191], a[36:39], v[32:35], v[176:191]
    s_add_u32 s42, s35, 0x1c000
    s_mov_b32 m0, s42
    s_add_u32 s43, s34, 0x7000
    buffer_load_dwordx4 v3, s[12:15], s43 offen lds
    s_add_u32 s42, s35, 0x1d000
    s_mov_b32 m0, s42
    s_add_u32 s43, s34, 0x7400
    buffer_load_dwordx4 v3, s[12:15], s43 offen lds
    buffer_load_dwordx4 a[36:39], v6, s[16:19], s40 offen offset:1024
    s_waitcnt vmcnt(30)
    v_add_f32 v124, v124, v108
    v_add_f32 v125, v125, v109
    v_add_f32 v124, v124, v110
    v_add_f32 v125, v125, v111
    v_add_f32 v124, v124, v112
    v_add_f32 v125, v125, v113
    v_add_f32 v124, v124, v114
    v_add_f32 v125, v125, v115
    s_mov_b32 s41, 0x40000
    buffer_load_dwordx2 v[108:109], v9, s[20:23], s41 offen
    s_mov_b32 s41, 0x44000
    buffer_load_dwordx2 v[110:111], v9, s[20:23], s41 offen
    s_mov_b32 s41, 0x48000
    buffer_load_dwordx2 v[112:113], v9, s[20:23], s41 offen
    s_mov_b32 s41, 0x4c000
    buffer_load_dwordx2 v[114:115], v9, s[20:23], s41 offen
    s_waitcnt vmcnt(32)
    s_barrier
    ds_read_b128 v[36:39], v3 offset:40960
    ds_read_b128 v[40:43], v3 offset:41984
    ds_read_b128 v[44:47], v3 offset:43008
    ds_read_b128 v[48:51], v3 offset:44032
    ds_read_b128 v[52:55], v3 offset:45056
    ds_read_b128 v[56:59], v3 offset:46080
    ds_read_b128 v[60:63], v3 offset:47104
    ds_read_b128 v[64:67], v3 offset:48128
    ds_read_b128 v[20:23], v3 offset:49152
    ds_read_b128 v[24:27], v3 offset:50176
    ds_read_b128 v[28:31], v3 offset:51200
    ds_read_b128 v[32:35], v3 offset:52224
    s_waitcnt lgkmcnt(8)
    v_mfma_f32_32x32x16_bf16 v[128:143], a[40:43], v[36:39], v[128:143]
    v_mfma_f32_32x32x16_bf16 v[144:159], a[40:43], v[40:43], v[144:159]
    v_mfma_f32_32x32x16_bf16 v[160:175], a[40:43], v[44:47], v[160:175]
    v_mfma_f32_32x32x16_bf16 v[176:191], a[40:43], v[48:51], v[176:191]
    s_add_u32 s42, s35, 0x1e000
    s_mov_b32 m0, s42
    s_add_u32 s43, s34, 0x7800
    buffer_load_dwordx4 v3, s[12:15], s43 offen lds
    s_add_u32 s42, s35, 0x1f000
    s_mov_b32 m0, s42
    s_add_u32 s43, s34, 0x7c00
    buffer_load_dwordx4 v3, s[12:15], s43 offen lds
    buffer_load_dwordx4 a[40:43], v6, s[16:19], s40 offen offset:2048
    ds_read_b128 v[36:39], v3 offset:53248
    ds_read_b128 v[40:43], v3 offset:54272
    ds_read_b128 v[44:47], v3 offset:55296
    ds_read_b128 v[48:51], v3 offset:56320
    s_waitcnt lgkmcnt(8)
    v_mfma_f32_32x32x16_bf16 v[128:143], a[44:47], v[52:55], v[128:143]
    v_mfma_f32_32x32x16_bf16 v[144:159], a[44:47], v[56:59], v[144:159]
    v_mfma_f32_32x32x16_bf16 v[160:175], a[44:47], v[60:63], v[160:175]
    v_mfma_f32_32x32x16_bf16 v[176:191], a[44:47], v[64:67], v[176:191]
    s_add_u32 s42, s35, 0x20000
    s_mov_b32 m0, s42
    s_add_u32 s43, s34, 0x8000
    buffer_load_dwordx4 v3, s[12:15], s43 offen lds
    s_add_u32 s42, s35, 0x21000
    s_mov_b32 m0, s42
    s_add_u32 s43, s34, 0x8400
    buffer_load_dwordx4 v3, s[12:15], s43 offen lds
    buffer_load_dwordx4 a[44:47], v6, s[16:19], s40 offen offset:3072
    s_waitcnt vmcnt(30)
    v_add_f32 v124, v124, v116
    v_add_f32 v125, v125, v117
    v_add_f32 v124, v124, v118
    v_add_f32 v125, v125, v119
    v_add_f32 v124, v124, v120
    v_add_f32 v125, v125, v121
    v_add_f32 v124, v124, v122
    v_add_f32 v125, v125, v123
    ds_read_b128 v[52:55], v3 offset:57344
    ds_read_b128 v[56:59], v3 offset:58368
    ds_read_b128 v[60:63], v3 offset:59392
    ds_read_b128 v[64:67], v3 offset:60416
    s_waitcnt lgkmcnt(8)
    v_mfma_f32_32x32x16_bf16 v[128:143], a[48:51], v[20:23], v[128:143]
    v_mfma_f32_32x32x16_bf16 v[144:159], a[48:51], v[24:27], v[144:159]
    v_mfma_f32_32x32x16_bf16 v[160:175], a[48:51], v[28:31], v[160:175]
    v_mfma_f32_32x32x16_bf16 v[176:191], a[48:51], v[32:35], v[176:191]
    s_add_u32 s42, s35, 0x22000
    s_mov_b32 m0, s42
    s_add_u32 s43, s34, 0x8800
    buffer_load_dwordx4 v3, s[12:15], s43 offen lds
    s_add_u32 s42, s35, 0x23000
    s_mov_b32 m0, s42
    s_add_u32 s43, s34, 0x8c00
    buffer_load_dwordx4 v3, s[12:15], s43 offen lds
    s_mov_b32 s40, 0x7000
    buffer_load_dwordx4 a[48:51], v6, s[16:19], s40 offen offset:0
    ds_read_b128 v[20:23], v3 offset:61440
    ds_read_b128 v[24:27], v3 offset:62464
    ds_read_b128 v[28:31], v3 offset:63488
    ds_read_b128 v[32:35], v3 offset:64512
    s_waitcnt lgkmcnt(8)
    v_mfma_f32_32x32x16_bf16 v[128:143], a[52:55], v[36:39], v[128:143]
    v_mfma_f32_32x32x16_bf16 v[144:159], a[52:55], v[40:43], v[144:159]
    v_mfma_f32_32x32x16_bf16 v[160:175], a[52:55], v[44:47], v[160:175]
    v_mfma_f32_32x32x16_bf16 v[176:191], a[52:55], v[48:51], v[176:191]
    s_add_u32 s42, s35, 0x24000
    s_mov_b32 m0, s42
    s_add_u32 s43, s34, 0x9000
    buffer_load_dwordx4 v3, s[12:15], s43 offen lds
    s_add_u32 s42, s35, 0x25000
    s_mov_b32 m0, s42
    s_add_u32 s43, s34, 0x9400
    buffer_load_dwordx4 v3, s[12:15], s43 offen lds
    buffer_load_dwordx4 a[52:55], v6, s[16:19], s40 offen offset:1024
    s_waitcnt vmcnt(22)
    v_add_f32 v124, v124, v100
    v_add_f32 v125, v125, v101
    v_add_f32 v124, v124, v102
    v_add_f32 v125, v125, v103
    v_add_f32 v124, v124, v104
    v_add_f32 v125, v125, v105
    v_add_f32 v124, v124, v106
    v_add_f32 v125, v125, v107
    ds_read_b128 v[36:39], v4 offset:0
    ds_read_b128 v[40:43], v4 offset:1024
    ds_read_b128 v[44:47], v4 offset:2048
    ds_read_b128 v[48:51], v4 offset:3072
    s_waitcnt lgkmcnt(8)
    v_mfma_f32_32x32x16_bf16 v[128:143], a[56:59], v[52:55], v[128:143]
    v_mfma_f32_32x32x16_bf16 v[144:159], a[56:59], v[56:59], v[144:159]
    v_mfma_f32_32x32x16_bf16 v[160:175], a[56:59], v[60:63], v[160:175]
    v_mfma_f32_32x32x16_bf16 v[176:191], a[56:59], v[64:67], v[176:191]
    s_add_u32 s42, s35, 0x26000
    s_mov_b32 m0, s42
    s_add_u32 s43, s34, 0x9800
    buffer_load_dwordx4 v3, s[12:15], s43 offen lds
    s_add_u32 s42, s35, 0x27000
    s_mov_b32 m0, s42
    s_add_u32 s43, s34, 0x9c00
    buffer_load_dwordx4 v3, s[12:15], s43 offen lds
    buffer_load_dwordx4 a[56:59], v6, s[16:19], s40 offen offset:2048
    ds_read_b128 v[52:55], v4 offset:4096
    ds_read_b128 v[56:59], v4 offset:5120
    ds_read_b128 v[60:63], v4 offset:6144
    ds_read_b128 v[64:67], v4 offset:7168
    s_waitcnt lgkmcnt(8)
    v_mfma_f32_32x32x16_bf16 v[128:143], a[60:63], v[20:23], v[128:143]
    v_mfma_f32_32x32x16_bf16 v[144:159], a[60:63], v[24:27], v[144:159]
    v_mfma_f32_32x32x16_bf16 v[160:175], a[60:63], v[28:31], v[160:175]
    v_mfma_f32_32x32x16_bf16 v[176:191], a[60:63], v[32:35], v[176:191]
    buffer_load_dwordx4 a[60:63], v6, s[16:19], s40 offen offset:3072
    s_waitcnt vmcnt(16)
    v_add_f32 v124, v124, v108
    v_add_f32 v125, v125, v109
    v_add_f32 v124, v124, v110
    v_add_f32 v125, v125, v111
    v_add_f32 v124, v124, v112
    v_add_f32 v125, v125, v113
    v_add_f32 v124, v124, v114
    v_add_f32 v125, v125, v115
    ds_read_b128 v[20:23], v4 offset:8192
    ds_read_b128 v[24:27], v4 offset:9216
    ds_read_b128 v[28:31], v4 offset:10240
    ds_read_b128 v[32:35], v4 offset:11264
    s_waitcnt lgkmcnt(8)
    v_mfma_f32_32x32x16_bf16 v[128:143], a[0:3], v[36:39], v[128:143]
    v_mfma_f32_32x32x16_bf16 v[144:159], a[0:3], v[40:43], v[144:159]
    v_mfma_f32_32x32x16_bf16 v[160:175], a[0:3], v[44:47], v[160:175]
    v_mfma_f32_32x32x16_bf16 v[176:191], a[0:3], v[48:51], v[176:191]
    s_mov_b32 s40, 0x8000
    buffer_load_dwordx4 a[0:3], v6, s[16:19], s40 offen offset:0
    ds_read_b128 v[36:39], v4 offset:12288
    ds_read_b128 v[40:43], v4 offset:13312
    ds_read_b128 v[44:47], v4 offset:14336
    ds_read_b128 v[48:51], v4 offset:15360
    s_waitcnt lgkmcnt(8)
    v_mfma_f32_32x32x16_bf16 v[128:143], a[4:7], v[52:55], v[128:143]
    v_mfma_f32_32x32x16_bf16 v[144:159], a[4:7], v[56:59], v[144:159]
    v_mfma_f32_32x32x16_bf16 v[160:175], a[4:7], v[60:63], v[160:175]
    v_mfma_f32_32x32x16_bf16 v[176:191], a[4:7], v[64:67], v[176:191]
    buffer_load_dwordx4 a[4:7], v6, s[16:19], s40 offen offset:1024
    v_mul_f32 v102, 0x3acccccd, v124
    v_mul_f32 v103, 0x3acccccd, v125
    v_fma_f32 v103, -v102, v102, v103
    v_max_f32 v103, 0, v103
    v_cvt_pk_bf16_f32 v102, v102, v102
    v_lshlrev_b32 v102, 16, v102
    v_cvt_pk_bf16_f32 v103, v103, v103
    v_lshlrev_b32 v103, 16, v103
    v_add_f32 v103, 0x3727c5ac, v103
    v_cvt_pk_bf16_f32 v103, v103, v103
    v_lshlrev_b32 v103, 16, v103
    v_sqrt_f32 v103, v103
    s_nop 0
    v_cvt_pk_bf16_f32 v103, v103, v103
    v_lshlrev_b32 v103, 16, v103
    v_rcp_f32 v18, v103
    s_nop 0
    v_mul_f32 v19, v102, v18
    v_sub_f32 v19, 0, v19
    s_waitcnt lgkmcnt(4)
    v_mfma_f32_32x32x16_bf16 v[128:143], a[8:11], v[20:23], v[128:143]
    v_mfma_f32_32x32x16_bf16 v[144:159], a[8:11], v[24:27], v[144:159]
    v_mfma_f32_32x32x16_bf16 v[160:175], a[8:11], v[28:31], v[160:175]
    v_mfma_f32_32x32x16_bf16 v[176:191], a[8:11], v[32:35], v[176:191]
    buffer_load_dwordx4 a[8:11], v6, s[16:19], s40 offen offset:2048
    s_waitcnt lgkmcnt(0)
    v_mfma_f32_32x32x16_bf16 v[128:143], a[12:15], v[36:39], v[128:143]
    v_mfma_f32_32x32x16_bf16 v[144:159], a[12:15], v[40:43], v[144:159]
    v_mfma_f32_32x32x16_bf16 v[160:175], a[12:15], v[44:47], v[160:175]
    v_mfma_f32_32x32x16_bf16 v[176:191], a[12:15], v[48:51], v[176:191]
    buffer_load_dwordx4 a[12:15], v6, s[16:19], s40 offen offset:3072
    s_barrier
    ds_write_b32 v16, v18
    ds_write_b32 v16, v19 offset:512
    s_waitcnt lgkmcnt(0)
    ds_read_b128 v[52:55], v4 offset:16384
    ds_read_b128 v[56:59], v4 offset:17408
    ds_read_b128 v[60:63], v4 offset:18432
    ds_read_b128 v[64:67], v4 offset:19456
    ds_read_b128 v[20:23], v4 offset:20480
    ds_read_b128 v[24:27], v4 offset:21504
    ds_read_b128 v[28:31], v4 offset:22528
    ds_read_b128 v[32:35], v4 offset:23552
    ds_read_b128 v[36:39], v4 offset:24576
    ds_read_b128 v[40:43], v4 offset:25600
    ds_read_b128 v[44:47], v4 offset:26624
    ds_read_b128 v[48:51], v4 offset:27648
    s_waitcnt lgkmcnt(8)
    v_mfma_f32_32x32x16_bf16 v[128:143], a[16:19], v[52:55], v[128:143]
    v_mfma_f32_32x32x16_bf16 v[144:159], a[16:19], v[56:59], v[144:159]
    v_mfma_f32_32x32x16_bf16 v[160:175], a[16:19], v[60:63], v[160:175]
    v_mfma_f32_32x32x16_bf16 v[176:191], a[16:19], v[64:67], v[176:191]
    s_mov_b32 s40, 0x9000
    buffer_load_dwordx4 a[16:19], v6, s[16:19], s40 offen offset:0
    ds_read_b128 v[52:55], v4 offset:28672
    ds_read_b128 v[56:59], v4 offset:29696
    ds_read_b128 v[60:63], v4 offset:30720
    ds_read_b128 v[64:67], v4 offset:31744
    s_waitcnt lgkmcnt(8)
    v_mfma_f32_32x32x16_bf16 v[128:143], a[20:23], v[20:23], v[128:143]
    v_mfma_f32_32x32x16_bf16 v[144:159], a[20:23], v[24:27], v[144:159]
    v_mfma_f32_32x32x16_bf16 v[160:175], a[20:23], v[28:31], v[160:175]
    v_mfma_f32_32x32x16_bf16 v[176:191], a[20:23], v[32:35], v[176:191]
    buffer_load_dwordx4 a[20:23], v6, s[16:19], s40 offen offset:1024
    ds_read_b128 v[20:23], v4 offset:32768
    ds_read_b128 v[24:27], v4 offset:33792
    ds_read_b128 v[28:31], v4 offset:34816
    ds_read_b128 v[32:35], v4 offset:35840
    s_waitcnt lgkmcnt(8)
    v_mfma_f32_32x32x16_bf16 v[128:143], a[24:27], v[36:39], v[128:143]
    v_mfma_f32_32x32x16_bf16 v[144:159], a[24:27], v[40:43], v[144:159]
    v_mfma_f32_32x32x16_bf16 v[160:175], a[24:27], v[44:47], v[160:175]
    v_mfma_f32_32x32x16_bf16 v[176:191], a[24:27], v[48:51], v[176:191]
    buffer_load_dwordx4 a[24:27], v6, s[16:19], s40 offen offset:2048
    ds_read_b128 v[36:39], v4 offset:36864
    ds_read_b128 v[40:43], v4 offset:37888
    ds_read_b128 v[44:47], v4 offset:38912
    ds_read_b128 v[48:51], v4 offset:39936
    s_waitcnt lgkmcnt(8)
    v_mfma_f32_32x32x16_bf16 v[128:143], a[28:31], v[52:55], v[128:143]
    v_mfma_f32_32x32x16_bf16 v[144:159], a[28:31], v[56:59], v[144:159]
    v_mfma_f32_32x32x16_bf16 v[160:175], a[28:31], v[60:63], v[160:175]
    v_mfma_f32_32x32x16_bf16 v[176:191], a[28:31], v[64:67], v[176:191]
    buffer_load_dwordx4 a[28:31], v6, s[16:19], s40 offen offset:3072
    ds_read_b128 v[52:55], v4 offset:40960
    ds_read_b128 v[56:59], v4 offset:41984
    ds_read_b128 v[60:63], v4 offset:43008
    ds_read_b128 v[64:67], v4 offset:44032
    s_waitcnt lgkmcnt(8)
    v_mfma_f32_32x32x16_bf16 v[128:143], a[32:35], v[20:23], v[128:143]
    v_mfma_f32_32x32x16_bf16 v[144:159], a[32:35], v[24:27], v[144:159]
    v_mfma_f32_32x32x16_bf16 v[160:175], a[32:35], v[28:31], v[160:175]
    v_mfma_f32_32x32x16_bf16 v[176:191], a[32:35], v[32:35], v[176:191]
    ds_read_b128 v[20:23], v4 offset:45056
    ds_read_b128 v[24:27], v4 offset:46080
    ds_read_b128 v[28:31], v4 offset:47104
    ds_read_b128 v[32:35], v4 offset:48128
    s_waitcnt lgkmcnt(8)
    v_mfma_f32_32x32x16_bf16 v[128:143], a[36:39], v[36:39], v[128:143]
    v_mfma_f32_32x32x16_bf16 v[144:159], a[36:39], v[40:43], v[144:159]
    v_mfma_f32_32x32x16_bf16 v[160:175], a[36:39], v[44:47], v[160:175]
    v_mfma_f32_32x32x16_bf16 v[176:191], a[36:39], v[48:51], v[176:191]
    ds_read_b128 v[36:39], v4 offset:49152
    ds_read_b128 v[40:43], v4 offset:50176
    ds_read_b128 v[44:47], v4 offset:51200
    ds_read_b128 v[48:51], v4 offset:52224
    s_waitcnt lgkmcnt(8)
    s_waitcnt vmcnt(21)
    v_mfma_f32_32x32x16_bf16 v[128:143], a[40:43], v[52:55], v[128:143]
    v_mfma_f32_32x32x16_bf16 v[144:159], a[40:43], v[56:59], v[144:159]
    v_mfma_f32_32x32x16_bf16 v[160:175], a[40:43], v[60:63], v[160:175]
    v_mfma_f32_32x32x16_bf16 v[176:191], a[40:43], v[64:67], v[176:191]
    ds_read_b128 v[52:55], v4 offset:53248
    ds_read_b128 v[56:59], v4 offset:54272
    ds_read_b128 v[60:63], v4 offset:55296
    ds_read_b128 v[64:67], v4 offset:56320
    s_waitcnt lgkmcnt(8)
    s_waitcnt vmcnt(18)
    v_mfma_f32_32x32x16_bf16 v[128:143], a[44:47], v[20:23], v[128:143]
    v_mfma_f32_32x32x16_bf16 v[144:159], a[44:47], v[24:27], v[144:159]
    v_mfma_f32_32x32x16_bf16 v[160:175], a[44:47], v[28:31], v[160:175]
    v_mfma_f32_32x32x16_bf16 v[176:191], a[44:47], v[32:35], v[176:191]
    s_waitcnt lgkmcnt(4)
    s_waitcnt vmcnt(15)
    v_mfma_f32_32x32x16_bf16 v[128:143], a[48:51], v[36:39], v[128:143]
    v_mfma_f32_32x32x16_bf16 v[144:159], a[48:51], v[40:43], v[144:159]
    v_mfma_f32_32x32x16_bf16 v[160:175], a[48:51], v[44:47], v[160:175]
    v_mfma_f32_32x32x16_bf16 v[176:191], a[48:51], v[48:51], v[176:191]
    s_waitcnt lgkmcnt(0)
    s_waitcnt vmcnt(12)
    v_mfma_f32_32x32x16_bf16 v[128:143], a[52:55], v[52:55], v[128:143]
    v_mfma_f32_32x32x16_bf16 v[144:159], a[52:55], v[56:59], v[144:159]
    v_mfma_f32_32x32x16_bf16 v[160:175], a[52:55], v[60:63], v[160:175]
    v_mfma_f32_32x32x16_bf16 v[176:191], a[52:55], v[64:67], v[176:191]
    s_waitcnt vmcnt(10)
    s_barrier
    ds_read_b128 v[20:23], v4 offset:57344
    ds_read_b128 v[24:27], v4 offset:58368
    ds_read_b128 v[28:31], v4 offset:59392
    ds_read_b128 v[32:35], v4 offset:60416
    ds_read_b128 v[36:39], v4 offset:61440
    ds_read_b128 v[40:43], v4 offset:62464
    ds_read_b128 v[44:47], v4 offset:63488
    ds_read_b128 v[48:51], v4 offset:64512
    ds_read_b128 v[52:55], v5 offset:0
    ds_read_b128 v[56:59], v5 offset:1024
    ds_read_b128 v[60:63], v5 offset:2048
    ds_read_b128 v[64:67], v5 offset:3072
    s_waitcnt lgkmcnt(8)
    s_waitcnt vmcnt(9)
    v_mfma_f32_32x32x16_bf16 v[128:143], a[56:59], v[20:23], v[128:143]
    v_mfma_f32_32x32x16_bf16 v[144:159], a[56:59], v[24:27], v[144:159]
    v_mfma_f32_32x32x16_bf16 v[160:175], a[56:59], v[28:31], v[160:175]
    v_mfma_f32_32x32x16_bf16 v[176:191], a[56:59], v[32:35], v[176:191]
    ds_read_b128 v[20:23], v5 offset:4096
    ds_read_b128 v[24:27], v5 offset:5120
    ds_read_b128 v[28:31], v5 offset:6144
    ds_read_b128 v[32:35], v5 offset:7168
    s_waitcnt lgkmcnt(8)
    s_waitcnt vmcnt(8)
    v_mfma_f32_32x32x16_bf16 v[128:143], a[60:63], v[36:39], v[128:143]
    v_mfma_f32_32x32x16_bf16 v[144:159], a[60:63], v[40:43], v[144:159]
    v_mfma_f32_32x32x16_bf16 v[160:175], a[60:63], v[44:47], v[160:175]
    v_mfma_f32_32x32x16_bf16 v[176:191], a[60:63], v[48:51], v[176:191]
    ds_read_b128 v[36:39], v5 offset:8192
    ds_read_b128 v[40:43], v5 offset:9216
    ds_read_b128 v[44:47], v5 offset:10240
    ds_read_b128 v[48:51], v5 offset:11264
    s_waitcnt lgkmcnt(8)
    s_waitcnt vmcnt(7)
    v_mfma_f32_32x32x16_bf16 v[128:143], a[0:3], v[52:55], v[128:143]
    v_mfma_f32_32x32x16_bf16 v[144:159], a[0:3], v[56:59], v[144:159]
    v_mfma_f32_32x32x16_bf16 v[160:175], a[0:3], v[60:63], v[160:175]
    v_mfma_f32_32x32x16_bf16 v[176:191], a[0:3], v[64:67], v[176:191]
    ds_read_b128 v[52:55], v5 offset:12288
    ds_read_b128 v[56:59], v5 offset:13312
    ds_read_b128 v[60:63], v5 offset:14336
    ds_read_b128 v[64:67], v5 offset:15360
    s_waitcnt lgkmcnt(8)
    s_waitcnt vmcnt(6)
    v_mfma_f32_32x32x16_bf16 v[128:143], a[4:7], v[20:23], v[128:143]
    v_mfma_f32_32x32x16_bf16 v[144:159], a[4:7], v[24:27], v[144:159]
    v_mfma_f32_32x32x16_bf16 v[160:175], a[4:7], v[28:31], v[160:175]
    v_mfma_f32_32x32x16_bf16 v[176:191], a[4:7], v[32:35], v[176:191]
    ds_read_b128 v[20:23], v5 offset:16384
    ds_read_b128 v[24:27], v5 offset:17408
    ds_read_b128 v[28:31], v5 offset:18432
    ds_read_b128 v[32:35], v5 offset:19456
    s_waitcnt lgkmcnt(8)
    s_waitcnt vmcnt(5)
    v_mfma_f32_32x32x16_bf16 v[128:143], a[8:11], v[36:39], v[128:143]
    v_mfma_f32_32x32x16_bf16 v[144:159], a[8:11], v[40:43], v[144:159]
    v_mfma_f32_32x32x16_bf16 v[160:175], a[8:11], v[44:47], v[160:175]
    v_mfma_f32_32x32x16_bf16 v[176:191], a[8:11], v[48:51], v[176:191]
    ds_read_b128 v[36:39], v5 offset:20480
    ds_read_b128 v[40:43], v5 offset:21504
    ds_read_b128 v[44:47], v5 offset:22528
    ds_read_b128 v[48:51], v5 offset:23552
    s_waitcnt lgkmcnt(8)
    s_waitcnt vmcnt(4)
    v_mfma_f32_32x32x16_bf16 v[128:143], a[12:15], v[52:55], v[128:143]
    v_mfma_f32_32x32x16_bf16 v[144:159], a[12:15], v[56:59], v[144:159]
    v_mfma_f32_32x32x16_bf16 v[160:175], a[12:15], v[60:63], v[160:175]
    v_mfma_f32_32x32x16_bf16 v[176:191], a[12:15], v[64:67], v[176:191]
    ds_read_b128 v[52:55], v5 offset:24576
    ds_read_b128 v[56:59], v5 offset:25600
    ds_read_b128 v[60:63], v5 offset:26624
    ds_read_b128 v[64:67], v5 offset:27648
    s_waitcnt lgkmcnt(8)
    s_waitcnt vmcnt(3)
    v_mfma_f32_32x32x16_bf16 v[128:143], a[16:19], v[20:23], v[128:143]
    v_mfma_f32_32x32x16_bf16 v[144:159], a[16:19], v[24:27], v[144:159]
    v_mfma_f32_32x32x16_bf16 v[160:175], a[16:19], v[28:31], v[160:175]
    v_mfma_f32_32x32x16_bf16 v[176:191], a[16:19], v[32:35], v[176:191]
    ds_read_b128 v[20:23], v5 offset:28672
    ds_read_b128 v[24:27], v5 offset:29696
    ds_read_b128 v[28:31], v5 offset:30720
    ds_read_b128 v[32:35], v5 offset:31744
    s_waitcnt lgkmcnt(8)
    s_waitcnt vmcnt(2)
    v_mfma_f32_32x32x16_bf16 v[128:143], a[20:23], v[36:39], v[128:143]
    v_mfma_f32_32x32x16_bf16 v[144:159], a[20:23], v[40:43], v[144:159]
    v_mfma_f32_32x32x16_bf16 v[160:175], a[20:23], v[44:47], v[160:175]
    v_mfma_f32_32x32x16_bf16 v[176:191], a[20:23], v[48:51], v[176:191]
    s_waitcnt lgkmcnt(4)
    s_waitcnt vmcnt(1)
    v_mfma_f32_32x32x16_bf16 v[128:143], a[24:27], v[52:55], v[128:143]
    v_mfma_f32_32x32x16_bf16 v[144:159], a[24:27], v[56:59], v[144:159]
    v_mfma_f32_32x32x16_bf16 v[160:175], a[24:27], v[60:63], v[160:175]
    v_mfma_f32_32x32x16_bf16 v[176:191], a[24:27], v[64:67], v[176:191]
    s_waitcnt lgkmcnt(0)
    s_waitcnt vmcnt(0)
    v_mfma_f32_32x32x16_bf16 v[128:143], a[28:31], v[20:23], v[128:143]
    v_mfma_f32_32x32x16_bf16 v[144:159], a[28:31], v[24:27], v[144:159]
    v_mfma_f32_32x32x16_bf16 v[160:175], a[28:31], v[28:31], v[160:175]
    v_mfma_f32_32x32x16_bf16 v[176:191], a[28:31], v[32:35], v[176:191]
    s_waitcnt vmcnt(0)
    v_lshlrev_b32 v17, 2, v1
    ds_read_b32 v100, v17 offset:0
    ds_read_b32 v104, v17 offset:512
    ds_read_b32 v101, v17 offset:128
    ds_read_b32 v105, v17 offset:640
    ds_read_b32 v102, v17 offset:256
    ds_read_b32 v106, v17 offset:768
    ds_read_b32 v103, v17 offset:384
    ds_read_b32 v107, v17 offset:896
    s_cmp_eq_u32 s44, 0
    s_cselect_b32 s48, 0x3ea52b5c, 1.0
    v_lshlrev_b32 v24, 4, v1
    s_add_u32 s49, s45, 0
    v_lshl_add_u32 v25, v2, 2, s49
    v_mul_u32_u24 v26, 3277, v25
    v_lshrrev_b32 v26, 16, v26
    v_mul_u32_u24 v27, 20, v26
    v_sub_u32 v27, v25, v27
    v_lshrrev_b32 v27, 2, v27
    v_mul_u32_u24 v28, 0x14000, v26
    v_and_b32 v29, 1, v27
    v_lshl_add_u32 v30, v29, 9, v24
    v_bfe_u32 v29, v27, 1, 1
    v_lshl_add_u32 v30, v29, 3, v30
    v_lshrrev_b32 v29, 1, v24
    v_add_u32 v29, 1024, v29
    v_cmp_eq_u32 vcc, 4, v27
    s_nop 1
    v_cndmask_b32 v30, v30, v29, vcc
    v_add_u32 v20, v28, v30
    s_add_u32 s49, s45, 8
    v_lshl_add_u32 v25, v2, 2, s49
    v_mul_u32_u24 v26, 3277, v25
    v_lshrrev_b32 v26, 16, v26
    v_mul_u32_u24 v27, 20, v26
    v_sub_u32 v27, v25, v27
    v_lshrrev_b32 v27, 2, v27
    v_mul_u32_u24 v28, 0x14000, v26
    v_and_b32 v29, 1, v27
    v_lshl_add_u32 v30, v29, 9, v24
    v_bfe_u32 v29, v27, 1, 1
    v_lshl_add_u32 v30, v29, 3, v30
    v_lshrrev_b32 v29, 1, v24
    v_add_u32 v29, 1024, v29
    v_cmp_eq_u32 vcc, 4, v27
    s_nop 1
    v_cndmask_b32 v30, v30, v29, vcc
    v_add_u32 v21, v28, v30
    s_add_u32 s49, s45, 16
    v_lshl_add_u32 v25, v2, 2, s49
    v_mul_u32_u24 v26, 3277, v25
    v_lshrrev_b32 v26, 16, v26
    v_mul_u32_u24 v27, 20, v26
    v_sub_u32 v27, v25, v27
    v_lshrrev_b32 v27, 2, v27
    v_mul_u32_u24 v28, 0x14000, v26
    v_and_b32 v29, 1, v27
    v_lshl_add_u32 v30, v29, 9, v24
    v_bfe_u32 v29, v27, 1, 1
    v_lshl_add_u32 v30, v29, 3, v30
    v_lshrrev_b32 v29, 1, v24
    v_add_u32 v29, 1024, v29
    v_cmp_eq_u32 vcc, 4, v27
    s_nop 1
    v_cndmask_b32 v30, v30, v29, vcc
    v_add_u32 v22, v28, v30
    s_add_u32 s49, s45, 24
    v_lshl_add_u32 v25, v2, 2, s49
    v_mul_u32_u24 v26, 3277, v25
    v_lshrrev_b32 v26, 16, v26
    v_mul_u32_u24 v27, 20, v26
    v_sub_u32 v27, v25, v27
    v_lshrrev_b32 v27, 2, v27
    v_mul_u32_u24 v28, 0x14000, v26
    v_and_b32 v29, 1, v27
    v_lshl_add_u32 v30, v29, 9, v24
    v_bfe_u32 v29, v27, 1, 1
    v_lshl_add_u32 v30, v29, 3, v30
    v_lshrrev_b32 v29, 1, v24
    v_add_u32 v29, 1024, v29
    v_cmp_eq_u32 vcc, 4, v27
    s_nop 1
    v_cndmask_b32 v30, v30, v29, vcc
    v_add_u32 v23, v28, v30
    s_waitcnt lgkmcnt(0)
    v_mul_f32 v56, s48, v100
    v_mul_f32 v57, s48, v104
    v_mul_f32 v128, v128, v56
    v_fma_f32 v128, v57, v68, v128
    v_mul_f32 v129, v129, v56
    v_fma_f32 v129, v57, v69, v129
    v_mul_f32 v130, v130, v56
    v_fma_f32 v130, v57, v70, v130
    v_mul_f32 v131, v131, v56
    v_fma_f32 v131, v57, v71, v131
    v_mul_f32 v132, v132, v56
    v_fma_f32 v132, v57, v72, v132
    v_mul_f32 v133, v133, v56
    v_fma_f32 v133, v57, v73, v133
    v_mul_f32 v134, v134, v56
    v_fma_f32 v134, v57, v74, v134
    v_mul_f32 v135, v135, v56
    v_fma_f32 v135, v57, v75, v135
    v_mul_f32 v136, v136, v56
    v_fma_f32 v136, v57, v76, v136
    v_mul_f32 v137, v137, v56
    v_fma_f32 v137, v57, v77, v137
    v_mul_f32 v138, v138, v56
    v_fma_f32 v138, v57, v78, v138
    v_mul_f32 v139, v139, v56
    v_fma_f32 v139, v57, v79, v139
    v_mul_f32 v140, v140, v56
    v_fma_f32 v140, v57, v80, v140
    v_mul_f32 v141, v141, v56
    v_fma_f32 v141, v57, v81, v141
    v_mul_f32 v142, v142, v56
    v_fma_f32 v142, v57, v82, v142
    v_mul_f32 v143, v143, v56
    v_fma_f32 v143, v57, v83, v143
    v_cvt_pk_bf16_f32 v128, v128, v129
    v_cvt_pk_bf16_f32 v129, v130, v131
    v_cvt_pk_bf16_f32 v130, v132, v133
    v_cvt_pk_bf16_f32 v131, v134, v135
    v_cvt_pk_bf16_f32 v132, v136, v137
    v_cvt_pk_bf16_f32 v133, v138, v139
    v_cvt_pk_bf16_f32 v134, v140, v141
    v_cvt_pk_bf16_f32 v135, v142, v143
    s_add_u32 s49, s46, 0
    buffer_store_dwordx2 v[128:129], v20, s[28:31], s49 offen
    buffer_store_dwordx2 v[130:131], v21, s[28:31], s49 offen
    buffer_store_dwordx2 v[132:133], v22, s[28:31], s49 offen
    buffer_store_dwordx2 v[134:135], v23, s[28:31], s49 offen
    v_mul_f32 v56, s48, v101
    v_mul_f32 v57, s48, v105
    v_mul_f32 v144, v144, v56
    v_fma_f32 v144, v57, v68, v144
    v_mul_f32 v145, v145, v56
    v_fma_f32 v145, v57, v69, v145
    v_mul_f32 v146, v146, v56
    v_fma_f32 v146, v57, v70, v146
    v_mul_f32 v147, v147, v56
    v_fma_f32 v147, v57, v71, v147
    v_mul_f32 v148, v148, v56
    v_fma_f32 v148, v57, v72, v148
    v_mul_f32 v149, v149, v56
    v_fma_f32 v149, v57, v73, v149
    v_mul_f32 v150, v150, v56
    v_fma_f32 v150, v57, v74, v150
    v_mul_f32 v151, v151, v56
    v_fma_f32 v151, v57, v75, v151
    v_mul_f32 v152, v152, v56
    v_fma_f32 v152, v57, v76, v152
    v_mul_f32 v153, v153, v56
    v_fma_f32 v153, v57, v77, v153
    v_mul_f32 v154, v154, v56
    v_fma_f32 v154, v57, v78, v154
    v_mul_f32 v155, v155, v56
    v_fma_f32 v155, v57, v79, v155
    v_mul_f32 v156, v156, v56
    v_fma_f32 v156, v57, v80, v156
    v_mul_f32 v157, v157, v56
    v_fma_f32 v157, v57, v81, v157
    v_mul_f32 v158, v158, v56
    v_fma_f32 v158, v57, v82, v158
    v_mul_f32 v159, v159, v56
    v_fma_f32 v159, v57, v83, v159
    v_cvt_pk_bf16_f32 v144, v144, v145
    v_cvt_pk_bf16_f32 v145, v146, v147
    v_cvt_pk_bf16_f32 v146, v148, v149
    v_cvt_pk_bf16_f32 v147, v150, v151
    v_cvt_pk_bf16_f32 v148, v152, v153
    v_cvt_pk_bf16_f32 v149, v154, v155
    v_cvt_pk_bf16_f32 v150, v156, v157
    v_cvt_pk_bf16_f32 v151, v158, v159
    s_add_u32 s49, s46, 1280
    buffer_store_dwordx2 v[144:145], v20, s[28:31], s49 offen
    buffer_store_dwordx2 v[146:147], v21, s[28:31], s49 offen
    buffer_store_dwordx2 v[148:149], v22, s[28:31], s49 offen
    buffer_store_dwordx2 v[150:151], v23, s[28:31], s49 offen
    v_mul_f32 v56, s48, v102
    v_mul_f32 v57, s48, v106
    v_mul_f32 v160, v160, v56
    v_fma_f32 v160, v57, v68, v160
    v_mul_f32 v161, v161, v56
    v_fma_f32 v161, v57, v69, v161
    v_mul_f32 v162, v162, v56
    v_fma_f32 v162, v57, v70, v162
    v_mul_f32 v163, v163, v56
    v_fma_f32 v163, v57, v71, v163
    v_mul_f32 v164, v164, v56
    v_fma_f32 v164, v57, v72, v164
    v_mul_f32 v165, v165, v56
    v_fma_f32 v165, v57, v73, v165
    v_mul_f32 v166, v166, v56
    v_fma_f32 v166, v57, v74, v166
    v_mul_f32 v167, v167, v56
    v_fma_f32 v167, v57, v75, v167
    v_mul_f32 v168, v168, v56
    v_fma_f32 v168, v57, v76, v168
    v_mul_f32 v169, v169, v56
    v_fma_f32 v169, v57, v77, v169
    v_mul_f32 v170, v170, v56
    v_fma_f32 v170, v57, v78, v170
    v_mul_f32 v171, v171, v56
    v_fma_f32 v171, v57, v79, v171
    v_mul_f32 v172, v172, v56
    v_fma_f32 v172, v57, v80, v172
    v_mul_f32 v173, v173, v56
    v_fma_f32 v173, v57, v81, v173
    v_mul_f32 v174, v174, v56
    v_fma_f32 v174, v57, v82, v174
    v_mul_f32 v175, v175, v56
    v_fma_f32 v175, v57, v83, v175
    v_cvt_pk_bf16_f32 v160, v160, v161
    v_cvt_pk_bf16_f32 v161, v162, v163
    v_cvt_pk_bf16_f32 v162, v164, v165
    v_cvt_pk_bf16_f32 v163, v166, v167
    v_cvt_pk_bf16_f32 v164, v168, v169
    v_cvt_pk_bf16_f32 v165, v170, v171
    v_cvt_pk_bf16_f32 v166, v172, v173
    v_cvt_pk_bf16_f32 v167, v174, v175
    s_add_u32 s49, s46, 2560
    buffer_store_dwordx2 v[160:161], v20, s[28:31], s49 offen
    buffer_store_dwordx2 v[162:163], v21, s[28:31], s49 offen
    buffer_store_dwordx2 v[164:165], v22, s[28:31], s49 offen
    buffer_store_dwordx2 v[166:167], v23, s[28:31], s49 offen
    v_mul_f32 v56, s48, v103
    v_mul_f32 v57, s48, v107
    v_mul_f32 v176, v176, v56
    v_fma_f32 v176, v57, v68, v176
    v_mul_f32 v177, v177, v56
    v_fma_f32 v177, v57, v69, v177
    v_mul_f32 v178, v178, v56
    v_fma_f32 v178, v57, v70, v178
    v_mul_f32 v179, v179, v56
    v_fma_f32 v179, v57, v71, v179
    v_mul_f32 v180, v180, v56
    v_fma_f32 v180, v57, v72, v180
    v_mul_f32 v181, v181, v56
    v_fma_f32 v181, v57, v73, v181
    v_mul_f32 v182, v182, v56
    v_fma_f32 v182, v57, v74, v182
    v_mul_f32 v183, v183, v56
    v_fma_f32 v183, v57, v75, v183
    v_mul_f32 v184, v184, v56
    v_fma_f32 v184, v57, v76, v184
    v_mul_f32 v185, v185, v56
    v_fma_f32 v185, v57, v77, v185
    v_mul_f32 v186, v186, v56
    v_fma_f32 v186, v57, v78, v186
    v_mul_f32 v187, v187, v56
    v_fma_f32 v187, v57, v79, v187
    v_mul_f32 v188, v188, v56
    v_fma_f32 v188, v57, v80, v188
    v_mul_f32 v189, v189, v56
    v_fma_f32 v189, v57, v81, v189
    v_mul_f32 v190, v190, v56
    v_fma_f32 v190, v57, v82, v190
    v_mul_f32 v191, v191, v56
    v_fma_f32 v191, v57, v83, v191
    v_cvt_pk_bf16_f32 v176, v176, v177
    v_cvt_pk_bf16_f32 v177, v178, v179
    v_cvt_pk_bf16_f32 v178, v180, v181
    v_cvt_pk_bf16_f32 v179, v182, v183
    v_cvt_pk_bf16_f32 v180, v184, v185
    v_cvt_pk_bf16_f32 v181, v186, v187
    v_cvt_pk_bf16_f32 v182, v188, v189
    v_cvt_pk_bf16_f32 v183, v190, v191
    s_add_u32 s49, s46, 3840
    buffer_store_dwordx2 v[176:177], v20, s[28:31], s49 offen
    buffer_store_dwordx2 v[178:179], v21, s[28:31], s49 offen
    buffer_store_dwordx2 v[180:181], v22, s[28:31], s49 offen
    buffer_store_dwordx2 v[182:183], v23, s[28:31], s49 offen
    s_branch L_qkv_end
L_qkv_v:
    s_add_u32 s42, s35, 0x0
    s_mov_b32 m0, s42
    s_add_u32 s43, s34, 0x0
    buffer_load_dwordx4 v3, s[12:15], s43 offen lds
    s_mov_b32 s40, 0x0
    buffer_load_dwordx4 a[0:3], v6, s[16:19], s40 offen offset:0
    s_add_u32 s42, s35, 0x1000
    s_mov_b32 m0, s42
    s_add_u32 s43, s34, 0x400
    buffer_load_dwordx4 v3, s[12:15], s43 offen lds
    buffer_load_dwordx4 a[4:7], v6, s[16:19], s40 offen offset:1024
    s_add_u32 s42, s35, 0x2000
    s_mov_b32 m0, s42
    s_add_u32 s43, s34, 0x800
    buffer_load_dwordx4 v3, s[12:15], s43 offen lds
    buffer_load_dwordx4 a[8:11], v6, s[16:19], s40 offen offset:2048
    s_add_u32 s42, s35, 0x3000
    s_mov_b32 m0, s42
    s_add_u32 s43, s34, 0xc00
    buffer_load_dwordx4 v3, s[12:15], s43 offen lds
    buffer_load_dwordx4 a[12:15], v6, s[16:19], s40 offen offset:3072
    s_add_u32 s42, s35, 0x4000
    s_mov_b32 m0, s42
    s_add_u32 s43, s34, 0x1000
    buffer_load_dwordx4 v3, s[12:15], s43 offen lds
    s_mov_b32 s40, 0x1000
    buffer_load_dwordx4 a[16:19], v6, s[16:19], s40 offen offset:0
    s_add_u32 s42, s35, 0x5000
    s_mov_b32 m0, s42
    s_add_u32 s43, s34, 0x1400
    buffer_load_dwordx4 v3, s[12:15], s43 offen lds
    buffer_load_dwordx4 a[20:23], v6, s[16:19], s40 offen offset:1024
    s_add_u32 s42, s35, 0x6000
    s_mov_b32 m0, s42
    s_add_u32 s43, s34, 0x1800
    buffer_load_dwordx4 v3, s[12:15], s43 offen lds
    buffer_load_dwordx4 a[24:27], v6, s[16:19], s40 offen offset:2048
    s_add_u32 s42, s35, 0x7000
    s_mov_b32 m0, s42
    s_add_u32 s43, s34, 0x1c00
    buffer_load_dwordx4 v3, s[12:15], s43 offen lds
    buffer_load_dwordx4 a[28:31], v6, s[16:19], s40 offen offset:3072
    s_add_u32 s42, s35, 0x8000
    s_mov_b32 m0, s42
    s_add_u32 s43, s34, 0x2000
    buffer_load_dwordx4 v3, s[12:15], s43 offen lds
    s_mov_b32 s40, 0x2000
    buffer_load_dwordx4 a[32:35], v6, s[16:19], s40 offen offset:0
    s_add_u32 s42, s35, 0x9000
    s_mov_b32 m0, s42
    s_add_u32 s43, s34, 0x2400
    buffer_load_dwordx4 v3, s[12:15], s43 offen lds
    buffer_load_dwordx4 a[36:39], v6, s[16:19], s40 offen offset:1024
    buffer_load_dwordx4 a[40:43], v6, s[16:19], s40 offen offset:2048
    buffer_load_dwordx4 a[44:47], v6, s[16:19], s40 offen offset:3072
    s_mov_b32 s40, 0x3000
    buffer_load_dwordx4 a[48:51], v6, s[16:19], s40 offen offset:0
    buffer_load_dwordx4 a[52:55], v6, s[16:19], s40 offen offset:1024
    buffer_load_dwordx4 a[56:59], v6, s[16:19], s40 offen offset:2048
    buffer_load_dwordx4 a[60:63], v6, s[16:19], s40 offen offset:3072
    s_waitcnt vmcnt(7)
    s_barrier
    ds_read_b128 v[20:23], v3 offset:0
    ds_read_b128 v[24:27], v3 offset:1024
    ds_read_b128 v[28:31], v3 offset:2048
    ds_read_b128 v[32:35], v3 offset:3072
    ds_read_b128 v[36:39], v3 offset:4096
    ds_read_b128 v[40:43], v3 offset:5120
    ds_read_b128 v[44:47], v3 offset:6144
    ds_read_b128 v[48:51], v3 offset:7168
    ds_read_b128 v[52:55], v3 offset:8192
    ds_read_b128 v[56:59], v3 offset:9216
    ds_read_b128 v[60:63], v3 offset:10240
    ds_read_b128 v[64:67], v3 offset:11264
    s_waitcnt lgkmcnt(8)
    v_mfma_f32_32x32x16_bf16 v[128:143], v[20:23], a[0:3], 0
    v_mfma_f32_32x32x16_bf16 v[144:159], v[24:27], a[0:3], 0
    v_mfma_f32_32x32x16_bf16 v[160:175], v[28:31], a[0:3], 0
    v_mfma_f32_32x32x16_bf16 v[176:191], v[32:35], a[0:3], 0
    s_add_u32 s42, s35, 0xa000
    s_mov_b32 m0, s42
    s_add_u32 s43, s34, 0x2800
    buffer_load_dwordx4 v3, s[12:15], s43 offen lds
    s_add_u32 s42, s35, 0xb000
    s_mov_b32 m0, s42
    s_add_u32 s43, s34, 0x2c00
    buffer_load_dwordx4 v3, s[12:15], s43 offen lds
    s_mov_b32 s40, 0x4000
    buffer_load_dwordx4 a[0:3], v6, s[16:19], s40 offen offset:0
    ds_read_b128 v[20:23], v3 offset:12288
    ds_read_b128 v[24:27], v3 offset:13312
    ds_read_b128 v[28:31], v3 offset:14336
    ds_read_b128 v[32:35], v3 offset:15360
    s_waitcnt lgkmcnt(8)
    v_mfma_f32_32x32x16_bf16 v[128:143], v[36:39], a[4:7], v[128:143]
    v_mfma_f32_32x32x16_bf16 v[144:159], v[40:43], a[4:7], v[144:159]
    v_mfma_f32_32x32x16_bf16 v[160:175], v[44:47], a[4:7], v[160:175]
    v_mfma_f32_32x32x16_bf16 v[176:191], v[48:51], a[4:7], v[176:191]
    s_add_u32 s42, s35, 0xc000
    s_mov_b32 m0, s42
    s_add_u32 s43, s34, 0x3000
    buffer_load_dwordx4 v3, s[12:15], s43 offen lds
    s_add_u32 s42, s35, 0xd000
    s_mov_b32 m0, s42
    s_add_u32 s43, s34, 0x3400
    buffer_load_dwordx4 v3, s[12:15], s43 offen lds
    buffer_load_dwordx4 a[4:7], v6, s[16:19], s40 offen offset:1024
    s_mov_b32 s41, 0x0
    buffer_load_dwordx2 v[100:101], v9, s[20:23], s41 offen
    s_mov_b32 s41, 0x4000
    buffer_load_dwordx2 v[102:103], v9, s[20:23], s41 offen
    s_mov_b32 s41, 0x8000
    buffer_load_dwordx2 v[104:105], v9, s[20:23], s41 offen
    s_mov_b32 s41, 0xc000
    buffer_load_dwordx2 v[106:107], v9, s[20:23], s41 offen
    ds_read_b128 v[36:39], v3 offset:16384
    ds_read_b128 v[40:43], v3 offset:17408
    ds_read_b128 v[44:47], v3 offset:18432
    ds_read_b128 v[48:51], v3 offset:19456
    s_waitcnt lgkmcnt(8)
    v_mfma_f32_32x32x16_bf16 v[128:143], v[52:55], a[8:11], v[128:143]
    v_mfma_f32_32x32x16_bf16 v[144:159], v[56:59], a[8:11], v[144:159]
    v_mfma_f32_32x32x16_bf16 v[160:175], v[60:63], a[8:11], v[160:175]
    v_mfma_f32_32x32x16_bf16 v[176:191], v[64:67], a[8:11], v[176:191]
    s_add_u32 s42, s35, 0xe000
    s_mov_b32 m0, s42
    s_add_u32 s43, s34, 0x3800
    buffer_load_dwordx4 v3, s[12:15], s43 offen lds
    s_add_u32 s42, s35, 0xf000
    s_mov_b32 m0, s42
    s_add_u32 s43, s34, 0x3c00
    buffer_load_dwordx4 v3, s[12:15], s43 offen lds
    buffer_load_dwordx4 a[8:11], v6, s[16:19], s40 offen offset:2048
    ds_read_b128 v[52:55], v3 offset:20480
    ds_read_b128 v[56:59], v3 offset:21504
    ds_read_b128 v[60:63], v3 offset:22528
    ds_read_b128 v[64:67], v3 offset:23552
    s_waitcnt lgkmcnt(8)
    v_mfma_f32_32x32x16_bf16 v[128:143], v[20:23], a[12:15], v[128:143]
    v_mfma_f32_32x32x16_bf16 v[144:159], v[24:27], a[12:15], v[144:159]
    v_mfma_f32_32x32x16_bf16 v[160:175], v[28:31], a[12:15], v[160:175]
    v_mfma_f32_32x32x16_bf16 v[176:191], v[32:35], a[12:15], v[176:191]
    s_add_u32 s42, s35, 0x10000
    s_mov_b32 m0, s42
    s_add_u32 s43, s34, 0x4000
    buffer_load_dwordx4 v3, s[12:15], s43 offen lds
    s_add_u32 s42, s35, 0x11000
    s_mov_b32 m0, s42
    s_add_u32 s43, s34, 0x4400
    buffer_load_dwordx4 v3, s[12:15], s43 offen lds
    buffer_load_dwordx4 a[12:15], v6, s[16:19], s40 offen offset:3072
    s_mov_b32 s41, 0x10000
    buffer_load_dwordx2 v[108:109], v9, s[20:23], s41 offen
    s_mov_b32 s41, 0x14000
    buffer_load_dwordx2 v[110:111], v9, s[20:23], s41 offen
    s_mov_b32 s41, 0x18000
    buffer_load_dwordx2 v[112:113], v9, s[20:23], s41 offen
    s_mov_b32 s41, 0x1c000
    buffer_load_dwordx2 v[114:115], v9, s[20:23], s41 offen
    ds_read_b128 v[20:23], v3 offset:24576
    ds_read_b128 v[24:27], v3 offset:25600
    ds_read_b128 v[28:31], v3 offset:26624
    ds_read_b128 v[32:35], v3 offset:27648
    s_waitcnt lgkmcnt(8)
    v_mfma_f32_32x32x16_bf16 v[128:143], v[36:39], a[16:19], v[128:143]
    v_mfma_f32_32x32x16_bf16 v[144:159], v[40:43], a[16:19], v[144:159]
    v_mfma_f32_32x32x16_bf16 v[160:175], v[44:47], a[16:19], v[160:175]
    v_mfma_f32_32x32x16_bf16 v[176:191], v[48:51], a[16:19], v[176:191]
    s_add_u32 s42, s35, 0x12000
    s_mov_b32 m0, s42
    s_add_u32 s43, s34, 0x4800
    buffer_load_dwordx4 v3, s[12:15], s43 offen lds
    s_add_u32 s42, s35, 0x13000
    s_mov_b32 m0, s42
    s_add_u32 s43, s34, 0x4c00
    buffer_load_dwordx4 v3, s[12:15], s43 offen lds
    s_mov_b32 s40, 0x5000
    buffer_load_dwordx4 a[16:19], v6, s[16:19], s40 offen offset:0
    ds_read_b128 v[36:39], v3 offset:28672
    ds_read_b128 v[40:43], v3 offset:29696
    ds_read_b128 v[44:47], v3 offset:30720
    ds_read_b128 v[48:51], v3 offset:31744
    s_waitcnt lgkmcnt(8)
    v_mfma_f32_32x32x16_bf16 v[128:143], v[52:55], a[20:23], v[128:143]
    v_mfma_f32_32x32x16_bf16 v[144:159], v[56:59], a[20:23], v[144:159]
    v_mfma_f32_32x32x16_bf16 v[160:175], v[60:63], a[20:23], v[160:175]
    v_mfma_f32_32x32x16_bf16 v[176:191], v[64:67], a[20:23], v[176:191]
    s_add_u32 s42, s35, 0x14000
    s_mov_b32 m0, s42
    s_add_u32 s43, s34, 0x5000
    buffer_load_dwordx4 v3, s[12:15], s43 offen lds
    s_add_u32 s42, s35, 0x15000
    s_mov_b32 m0, s42
    s_add_u32 s43, s34, 0x5400
    buffer_load_dwordx4 v3, s[12:15], s43 offen lds
    buffer_load_dwordx4 a[20:23], v6, s[16:19], s40 offen offset:1024
    s_mov_b32 s41, 0x20000
    buffer_load_dwordx2 v[116:117], v9, s[20:23], s41 offen
    s_mov_b32 s41, 0x24000
    buffer_load_dwordx2 v[118:119], v9, s[20:23], s41 offen
    s_mov_b32 s41, 0x28000
    buffer_load_dwordx2 v[120:121], v9, s[20:23], s41 offen
    s_mov_b32 s41, 0x2c000
    buffer_load_dwordx2 v[122:123], v9, s[20:23], s41 offen
    ds_read_b128 v[52:55], v3 offset:32768
    ds_read_b128 v[56:59], v3 offset:33792
    ds_read_b128 v[60:63], v3 offset:34816
    ds_read_b128 v[64:67], v3 offset:35840
    s_waitcnt lgkmcnt(8)
    v_mfma_f32_32x32x16_bf16 v[128:143], v[20:23], a[24:27], v[128:143]
    v_mfma_f32_32x32x16_bf16 v[144:159], v[24:27], a[24:27], v[144:159]
    v_mfma_f32_32x32x16_bf16 v[160:175], v[28:31], a[24:27], v[160:175]
    v_mfma_f32_32x32x16_bf16 v[176:191], v[32:35], a[24:27], v[176:191]
    s_add_u32 s42, s35, 0x16000
    s_mov_b32 m0, s42
    s_add_u32 s43, s34, 0x5800
    buffer_load_dwordx4 v3, s[12:15], s43 offen lds
    s_add_u32 s42, s35, 0x17000
    s_mov_b32 m0, s42
    s_add_u32 s43, s34, 0x5c00
    buffer_load_dwordx4 v3, s[12:15], s43 offen lds
    buffer_load_dwordx4 a[24:27], v6, s[16:19], s40 offen offset:2048
    buffer_load_dword v68, v11, s[24:27], 0 offen
    ds_read_b128 v[20:23], v3 offset:36864
    ds_read_b128 v[24:27], v3 offset:37888
    ds_read_b128 v[28:31], v3 offset:38912
    ds_read_b128 v[32:35], v3 offset:39936
    s_waitcnt lgkmcnt(8)
    v_mfma_f32_32x32x16_bf16 v[128:143], v[36:39], a[28:31], v[128:143]
    v_mfma_f32_32x32x16_bf16 v[144:159], v[40:43], a[28:31], v[144:159]
    v_mfma_f32_32x32x16_bf16 v[160:175], v[44:47], a[28:31], v[160:175]
    v_mfma_f32_32x32x16_bf16 v[176:191], v[48:51], a[28:31], v[176:191]
    s_add_u32 s42, s35, 0x18000
    s_mov_b32 m0, s42
    s_add_u32 s43, s34, 0x6000
    buffer_load_dwordx4 v3, s[12:15], s43 offen lds
    s_add_u32 s42, s35, 0x19000
    s_mov_b32 m0, s42
    s_add_u32 s43, s34, 0x6400
    buffer_load_dwordx4 v3, s[12:15], s43 offen lds
    buffer_load_dwordx4 a[28:31], v6, s[16:19], s40 offen offset:3072
    s_waitcnt vmcnt(27)
    v_mov_b32 v124, v100
    v_mov_b32 v125, v101
    v_add_f32 v124, v124, v102
    v_add_f32 v125, v125, v103
    v_add_f32 v124, v124, v104
    v_add_f32 v125, v125, v105
    v_add_f32 v124, v124, v106
    v_add_f32 v125, v125, v107
    s_mov_b32 s41, 0x30000
    buffer_load_dwordx2 v[100:101], v9, s[20:23], s41 offen
    s_mov_b32 s41, 0x34000
    buffer_load_dwordx2 v[102:103], v9, s[20:23], s41 offen
    s_mov_b32 s41, 0x38000
    buffer_load_dwordx2 v[104:105], v9, s[20:23], s41 offen
    s_mov_b32 s41, 0x3c000
    buffer_load_dwordx2 v[106:107], v9, s[20:23], s41 offen
    s_waitcnt lgkmcnt(4)
    v_mfma_f32_32x32x16_bf16 v[128:143], v[52:55], a[32:35], v[128:143]
    v_mfma_f32_32x32x16_bf16 v[144:159], v[56:59], a[32:35], v[144:159]
    v_mfma_f32_32x32x16_bf16 v[160:175], v[60:63], a[32:35], v[160:175]
    v_mfma_f32_32x32x16_bf16 v[176:191], v[64:67], a[32:35], v[176:191]
    s_add_u32 s42, s35, 0x1a000
    s_mov_b32 m0, s42
    s_add_u32 s43, s34, 0x6800
    buffer_load_dwordx4 v3, s[12:15], s43 offen lds
    s_add_u32 s42, s35, 0x1b000
    s_mov_b32 m0, s42
    s_add_u32 s43, s34, 0x6c00
    buffer_load_dwordx4 v3, s[12:15], s43 offen lds
    s_mov_b32 s40, 0x6000
    buffer_load_dwordx4 a[32:35], v6, s[16:19], s40 offen offset:0
    s_waitcnt lgkmcnt(0)
    v_mfma_f32_32x32x16_bf16 v[128:143], v[20:23], a[36:39], v[128:143]
    v_mfma_f32_32x32x16_bf16 v[144:159], v[24:27], a[36:39], v[144:159]
    v_mfma_f32_32x32x16_bf16 v[160:175], v[28:31], a[36:39], v[160:175]
    v_mfma_f32_32x32x16_bf16 v[176:191], v[32:35], a[36:39], v[176:191]
    s_add_u32 s42, s35, 0x1c000
    s_mov_b32 m0, s42
    s_add_u32 s43, s34, 0x7000
    buffer_load_dwordx4 v3, s[12:15], s43 offen lds
    s_add_u32 s42, s35, 0x1d000
    s_mov_b32 m0, s42
    s_add_u32 s43, s34, 0x7400
    buffer_load_dwordx4 v3, s[12:15], s43 offen lds
    buffer_load_dwordx4 a[36:39], v6, s[16:19], s40 offen offset:1024
    s_waitcnt vmcnt(27)
    v_add_f32 v124, v124, v108
    v_add_f32 v125, v125, v109
    v_add_f32 v124, v124, v110
    v_add_f32 v125, v125, v111
    v_add_f32 v124, v124, v112
    v_add_f32 v125, v125, v113
    v_add_f32 v124, v124, v114
    v_add_f32 v125, v125, v115
    s_mov_b32 s41, 0x40000
    buffer_load_dwordx2 v[108:109], v9, s[20:23], s41 offen
    s_mov_b32 s41, 0x44000
    buffer_load_dwordx2 v[110:111], v9, s[20:23], s41 offen
    s_mov_b32 s41, 0x48000
    buffer_load_dwordx2 v[112:113], v9, s[20:23], s41 offen
    s_mov_b32 s41, 0x4c000
    buffer_load_dwordx2 v[114:115], v9, s[20:23], s41 offen
    s_waitcnt vmcnt(29)
    s_barrier
    ds_read_b128 v[36:39], v3 offset:40960
    ds_read_b128 v[40:43], v3 offset:41984
    ds_read_b128 v[44:47], v3 offset:43008
    ds_read_b128 v[48:51], v3 offset:44032
    ds_read_b128 v[52:55], v3 offset:45056
    ds_read_b128 v[56:59], v3 offset:46080
    ds_read_b128 v[60:63], v3 offset:47104
    ds_read_b128 v[64:67], v3 offset:48128
    ds_read_b128 v[20:23], v3 offset:49152
    ds_read_b128 v[24:27], v3 offset:50176
    ds_read_b128 v[28:31], v3 offset:51200
    ds_read_b128 v[32:35], v3 offset:52224
    s_waitcnt lgkmcnt(8)
    v_mfma_f32_32x32x16_bf16 v[128:143], v[36:39], a[40:43], v[128:143]
    v_mfma_f32_32x32x16_bf16 v[144:159], v[40:43], a[40:43], v[144:159]
    v_mfma_f32_32x32x16_bf16 v[160:175], v[44:47], a[40:43], v[160:175]
    v_mfma_f32_32x32x16_bf16 v[176:191], v[48:51], a[40:43], v[176:191]
    s_add_u32 s42, s35, 0x1e000
    s_mov_b32 m0, s42
    s_add_u32 s43, s34, 0x7800
    buffer_load_dwordx4 v3, s[12:15], s43 offen lds
    s_add_u32 s42, s35, 0x1f000
    s_mov_b32 m0, s42
    s_add_u32 s43, s34, 0x7c00
    buffer_load_dwordx4 v3, s[12:15], s43 offen lds
    buffer_load_dwordx4 a[40:43], v6, s[16:19], s40 offen offset:2048
    ds_read_b128 v[36:39], v3 offset:53248
    ds_read_b128 v[40:43], v3 offset:54272
    ds_read_b128 v[44:47], v3 offset:55296
    ds_read_b128 v[48:51], v3 offset:56320
    s_waitcnt lgkmcnt(8)
    v_mfma_f32_32x32x16_bf16 v[128:143], v[52:55], a[44:47], v[128:143]
    v_mfma_f32_32x32x16_bf16 v[144:159], v[56:59], a[44:47], v[144:159]
    v_mfma_f32_32x32x16_bf16 v[160:175], v[60:63], a[44:47], v[160:175]
    v_mfma_f32_32x32x16_bf16 v[176:191], v[64:67], a[44:47], v[176:191]
    s_add_u32 s42, s35, 0x20000
    s_mov_b32 m0, s42
    s_add_u32 s43, s34, 0x8000
    buffer_load_dwordx4 v3, s[12:15], s43 offen lds
    s_add_u32 s42, s35, 0x21000
    s_mov_b32 m0, s42
    s_add_u32 s43, s34, 0x8400
    buffer_load_dwordx4 v3, s[12:15], s43 offen lds
    buffer_load_dwordx4 a[44:47], v6, s[16:19], s40 offen offset:3072
    s_waitcnt vmcnt(27)
    v_add_f32 v124, v124, v116
    v_add_f32 v125, v125, v117
    v_add_f32 v124, v124, v118
    v_add_f32 v125, v125, v119
    v_add_f32 v124, v124, v120
    v_add_f32 v125, v125, v121
    v_add_f32 v124, v124, v122
    v_add_f32 v125, v125, v123
    ds_read_b128 v[52:55], v3 offset:57344
    ds_read_b128 v[56:59], v3 offset:58368
    ds_read_b128 v[60:63], v3 offset:59392
    ds_read_b128 v[64:67], v3 offset:60416
    s_waitcnt lgkmcnt(8)
    v_mfma_f32_32x32x16_bf16 v[128:143], v[20:23], a[48:51], v[128:143]
    v_mfma_f32_32x32x16_bf16 v[144:159], v[24:27], a[48:51], v[144:159]
    v_mfma_f32_32x32x16_bf16 v[160:175], v[28:31], a[48:51], v[160:175]
    v_mfma_f32_32x32x16_bf16 v[176:191], v[32:35], a[48:51], v[176:191]
    s_add_u32 s42, s35, 0x22000
    s_mov_b32 m0, s42
    s_add_u32 s43, s34, 0x8800
    buffer_load_dwordx4 v3, s[12:15], s43 offen lds
    s_add_u32 s42, s35, 0x23000
    s_mov_b32 m0, s42
    s_add_u32 s43, s34, 0x8c00
    buffer_load_dwordx4 v3, s[12:15], s43 offen lds
    s_mov_b32 s40, 0x7000
    buffer_load_dwordx4 a[48:51], v6, s[16:19], s40 offen offset:0
    ds_read_b128 v[20:23], v3 offset:61440
    ds_read_b128 v[24:27], v3 offset:62464
    ds_read_b128 v[28:31], v3 offset:63488
    ds_read_b128 v[32:35], v3 offset:64512
    s_waitcnt lgkmcnt(8)
    v_mfma_f32_32x32x16_bf16 v[128:143], v[36:39], a[52:55], v[128:143]
    v_mfma_f32_32x32x16_bf16 v[144:159], v[40:43], a[52:55], v[144:159]
    v_mfma_f32_32x32x16_bf16 v[160:175], v[44:47], a[52:55], v[160:175]
    v_mfma_f32_32x32x16_bf16 v[176:191], v[48:51], a[52:55], v[176:191]
    s_add_u32 s42, s35, 0x24000
    s_mov_b32 m0, s42
    s_add_u32 s43, s34, 0x9000
    buffer_load_dwordx4 v3, s[12:15], s43 offen lds
    s_add_u32 s42, s35, 0x25000
    s_mov_b32 m0, s42
    s_add_u32 s43, s34, 0x9400
    buffer_load_dwordx4 v3, s[12:15], s43 offen lds
    buffer_load_dwordx4 a[52:55], v6, s[16:19], s40 offen offset:1024
    s_waitcnt vmcnt(22)
    v_add_f32 v124, v124, v100
    v_add_f32 v125, v125, v101
    v_add_f32 v124, v124, v102
    v_add_f32 v125, v125, v103
    v_add_f32 v124, v124, v104
    v_add_f32 v125, v125, v105
    v_add_f32 v124, v124, v106
    v_add_f32 v125, v125, v107
    ds_read_b128 v[36:39], v4 offset:0
    ds_read_b128 v[40:43], v4 offset:1024
    ds_read_b128 v[44:47], v4 offset:2048
    ds_read_b128 v[48:51], v4 offset:3072
    s_waitcnt lgkmcnt(8)
    v_mfma_f32_32x32x16_bf16 v[128:143], v[52:55], a[56:59], v[128:143]
    v_mfma_f32_32x32x16_bf16 v[144:159], v[56:59], a[56:59], v[144:159]
    v_mfma_f32_32x32x16_bf16 v[160:175], v[60:63], a[56:59], v[160:175]
    v_mfma_f32_32x32x16_bf16 v[176:191], v[64:67], a[56:59], v[176:191]
    s_add_u32 s42, s35, 0x26000
    s_mov_b32 m0, s42
    s_add_u32 s43, s34, 0x9800
    buffer_load_dwordx4 v3, s[12:15], s43 offen lds
    s_add_u32 s42, s35, 0x27000
    s_mov_b32 m0, s42
    s_add_u32 s43, s34, 0x9c00
    buffer_load_dwordx4 v3, s[12:15], s43 offen lds
    buffer_load_dwordx4 a[56:59], v6, s[16:19], s40 offen offset:2048
    ds_read_b128 v[52:55], v4 offset:4096
    ds_read_b128 v[56:59], v4 offset:5120
    ds_read_b128 v[60:63], v4 offset:6144
    ds_read_b128 v[64:67], v4 offset:7168
    s_waitcnt lgkmcnt(8)
    v_mfma_f32_32x32x16_bf16 v[128:143], v[20:23], a[60:63], v[128:143]
    v_mfma_f32_32x32x16_bf16 v[144:159], v[24:27], a[60:63], v[144:159]
    v_mfma_f32_32x32x16_bf16 v[160:175], v[28:31], a[60:63], v[160:175]
    v_mfma_f32_32x32x16_bf16 v[176:191], v[32:35], a[60:63], v[176:191]
    buffer_load_dwordx4 a[60:63], v6, s[16:19], s40 offen offset:3072
    s_waitcnt vmcnt(16)
    v_add_f32 v124, v124, v108
    v_add_f32 v125, v125, v109
    v_add_f32 v124, v124, v110
    v_add_f32 v125, v125, v111
    v_add_f32 v124, v124, v112
    v_add_f32 v125, v125, v113
    v_add_f32 v124, v124, v114
    v_add_f32 v125, v125, v115
    ds_read_b128 v[20:23], v4 offset:8192
    ds_read_b128 v[24:27], v4 offset:9216
    ds_read_b128 v[28:31], v4 offset:10240
    ds_read_b128 v[32:35], v4 offset:11264
    s_waitcnt lgkmcnt(8)
    v_mfma_f32_32x32x16_bf16 v[128:143], v[36:39], a[0:3], v[128:143]
    v_mfma_f32_32x32x16_bf16 v[144:159], v[40:43], a[0:3], v[144:159]
    v_mfma_f32_32x32x16_bf16 v[160:175], v[44:47], a[0:3], v[160:175]
    v_mfma_f32_32x32x16_bf16 v[176:191], v[48:51], a[0:3], v[176:191]
    s_mov_b32 s40, 0x8000
    buffer_load_dwordx4 a[0:3], v6, s[16:19], s40 offen offset:0
    ds_read_b128 v[36:39], v4 offset:12288
    ds_read_b128 v[40:43], v4 offset:13312
    ds_read_b128 v[44:47], v4 offset:14336
    ds_read_b128 v[48:51], v4 offset:15360
    s_waitcnt lgkmcnt(8)
    v_mfma_f32_32x32x16_bf16 v[128:143], v[52:55], a[4:7], v[128:143]
    v_mfma_f32_32x32x16_bf16 v[144:159], v[56:59], a[4:7], v[144:159]
    v_mfma_f32_32x32x16_bf16 v[160:175], v[60:63], a[4:7], v[160:175]
    v_mfma_f32_32x32x16_bf16 v[176:191], v[64:67], a[4:7], v[176:191]
    buffer_load_dwordx4 a[4:7], v6, s[16:19], s40 offen offset:1024
    v_mul_f32 v102, 0x3acccccd, v124
    v_mul_f32 v103, 0x3acccccd, v125
    v_fma_f32 v103, -v102, v102, v103
    v_max_f32 v103, 0, v103
    v_cvt_pk_bf16_f32 v102, v102, v102
    v_lshlrev_b32 v102, 16, v102
    v_cvt_pk_bf16_f32 v103, v103, v103
    v_lshlrev_b32 v103, 16, v103
    v_add_f32 v103, 0x3727c5ac, v103
    v_cvt_pk_bf16_f32 v103, v103, v103
    v_lshlrev_b32 v103, 16, v103
    v_sqrt_f32 v103, v103
    s_nop 0
    v_cvt_pk_bf16_f32 v103, v103, v103
    v_lshlrev_b32 v103, 16, v103
    v_rcp_f32 v18, v103
    s_nop 0
    v_mul_f32 v19, v102, v18
    v_sub_f32 v19, 0, v19
    s_waitcnt lgkmcnt(4)
    v_mfma_f32_32x32x16_bf16 v[128:143], v[20:23], a[8:11], v[128:143]
    v_mfma_f32_32x32x16_bf16 v[144:159], v[24:27], a[8:11], v[144:159]
    v_mfma_f32_32x32x16_bf16 v[160:175], v[28:31], a[8:11], v[160:175]
    v_mfma_f32_32x32x16_bf16 v[176:191], v[32:35], a[8:11], v[176:191]
    buffer_load_dwordx4 a[8:11], v6, s[16:19], s40 offen offset:2048
    s_waitcnt lgkmcnt(0)
    v_mfma_f32_32x32x16_bf16 v[128:143], v[36:39], a[12:15], v[128:143]
    v_mfma_f32_32x32x16_bf16 v[144:159], v[40:43], a[12:15], v[144:159]
    v_mfma_f32_32x32x16_bf16 v[160:175], v[44:47], a[12:15], v[160:175]
    v_mfma_f32_32x32x16_bf16 v[176:191], v[48:51], a[12:15], v[176:191]
    buffer_load_dwordx4 a[12:15], v6, s[16:19], s40 offen offset:3072
    s_barrier
    ds_write_b32 v16, v18
    ds_write_b32 v16, v19 offset:512
    s_waitcnt lgkmcnt(0)
    ds_read_b128 v[52:55], v4 offset:16384
    ds_read_b128 v[56:59], v4 offset:17408
    ds_read_b128 v[60:63], v4 offset:18432
    ds_read_b128 v[64:67], v4 offset:19456
    ds_read_b128 v[20:23], v4 offset:20480
    ds_read_b128 v[24:27], v4 offset:21504
    ds_read_b128 v[28:31], v4 offset:22528
    ds_read_b128 v[32:35], v4 offset:23552
    ds_read_b128 v[36:39], v4 offset:24576
    ds_read_b128 v[40:43], v4 offset:25600
    ds_read_b128 v[44:47], v4 offset:26624
    ds_read_b128 v[48:51], v4 offset:27648
    s_waitcnt lgkmcnt(8)
    v_mfma_f32_32x32x16_bf16 v[128:143], v[52:55], a[16:19], v[128:143]
    v_mfma_f32_32x32x16_bf16 v[144:159], v[56:59], a[16:19], v[144:159]
    v_mfma_f32_32x32x16_bf16 v[160:175], v[60:63], a[16:19], v[160:175]
    v_mfma_f32_32x32x16_bf16 v[176:191], v[64:67], a[16:19], v[176:191]
    s_mov_b32 s40, 0x9000
    buffer_load_dwordx4 a[16:19], v6, s[16:19], s40 offen offset:0
    ds_read_b128 v[52:55], v4 offset:28672
    ds_read_b128 v[56:59], v4 offset:29696
    ds_read_b128 v[60:63], v4 offset:30720
    ds_read_b128 v[64:67], v4 offset:31744
    s_waitcnt lgkmcnt(8)
    v_mfma_f32_32x32x16_bf16 v[128:143], v[20:23], a[20:23], v[128:143]
    v_mfma_f32_32x32x16_bf16 v[144:159], v[24:27], a[20:23], v[144:159]
    v_mfma_f32_32x32x16_bf16 v[160:175], v[28:31], a[20:23], v[160:175]
    v_mfma_f32_32x32x16_bf16 v[176:191], v[32:35], a[20:23], v[176:191]
    buffer_load_dwordx4 a[20:23], v6, s[16:19], s40 offen offset:1024
    ds_read_b128 v[20:23], v4 offset:32768
    ds_read_b128 v[24:27], v4 offset:33792
    ds_read_b128 v[28:31], v4 offset:34816
    ds_read_b128 v[32:35], v4 offset:35840
    s_waitcnt lgkmcnt(8)
    v_mfma_f32_32x32x16_bf16 v[128:143], v[36:39], a[24:27], v[128:143]
    v_mfma_f32_32x32x16_bf16 v[144:159], v[40:43], a[24:27], v[144:159]
    v_mfma_f32_32x32x16_bf16 v[160:175], v[44:47], a[24:27], v[160:175]
    v_mfma_f32_32x32x16_bf16 v[176:191], v[48:51], a[24:27], v[176:191]
    buffer_load_dwordx4 a[24:27], v6, s[16:19], s40 offen offset:2048
    ds_read_b128 v[36:39], v4 offset:36864
    ds_read_b128 v[40:43], v4 offset:37888
    ds_read_b128 v[44:47], v4 offset:38912
    ds_read_b128 v[48:51], v4 offset:39936
    s_waitcnt lgkmcnt(8)
    v_mfma_f32_32x32x16_bf16 v[128:143], v[52:55], a[28:31], v[128:143]
    v_mfma_f32_32x32x16_bf16 v[144:159], v[56:59], a[28:31], v[144:159]
    v_mfma_f32_32x32x16_bf16 v[160:175], v[60:63], a[28:31], v[160:175]
    v_mfma_f32_32x32x16_bf16 v[176:191], v[64:67], a[28:31], v[176:191]
    buffer_load_dwordx4 a[28:31], v6, s[16:19], s40 offen offset:3072
    ds_read_b128 v[52:55], v4 offset:40960
    ds_read_b128 v[56:59], v4 offset:41984
    ds_read_b128 v[60:63], v4 offset:43008
    ds_read_b128 v[64:67], v4 offset:44032
    s_waitcnt lgkmcnt(8)
    v_mfma_f32_32x32x16_bf16 v[128:143], v[20:23], a[32:35], v[128:143]
    v_mfma_f32_32x32x16_bf16 v[144:159], v[24:27], a[32:35], v[144:159]
    v_mfma_f32_32x32x16_bf16 v[160:175], v[28:31], a[32:35], v[160:175]
    v_mfma_f32_32x32x16_bf16 v[176:191], v[32:35], a[32:35], v[176:191]
    ds_read_b128 v[20:23], v4 offset:45056
    ds_read_b128 v[24:27], v4 offset:46080
    ds_read_b128 v[28:31], v4 offset:47104
    ds_read_b128 v[32:35], v4 offset:48128
    s_waitcnt lgkmcnt(8)
    v_mfma_f32_32x32x16_bf16 v[128:143], v[36:39], a[36:39], v[128:143]
    v_mfma_f32_32x32x16_bf16 v[144:159], v[40:43], a[36:39], v[144:159]
    v_mfma_f32_32x32x16_bf16 v[160:175], v[44:47], a[36:39], v[160:175]
    v_mfma_f32_32x32x16_bf16 v[176:191], v[48:51], a[36:39], v[176:191]
    ds_read_b128 v[36:39], v4 offset:49152
    ds_read_b128 v[40:43], v4 offset:50176
    ds_read_b128 v[44:47], v4 offset:51200
    ds_read_b128 v[48:51], v4 offset:52224
    s_waitcnt lgkmcnt(8)
    s_waitcnt vmcnt(21)
    v_mfma_f32_32x32x16_bf16 v[128:143], v[52:55], a[40:43], v[128:143]
    v_mfma_f32_32x32x16_bf16 v[144:159], v[56:59], a[40:43], v[144:159]
    v_mfma_f32_32x32x16_bf16 v[160:175], v[60:63], a[40:43], v[160:175]
    v_mfma_f32_32x32x16_bf16 v[176:191], v[64:67], a[40:43], v[176:191]
    ds_read_b128 v[52:55], v4 offset:53248
    ds_read_b128 v[56:59], v4 offset:54272
    ds_read_b128 v[60:63], v4 offset:55296
    ds_read_b128 v[64:67], v4 offset:56320
    s_waitcnt lgkmcnt(8)
    s_waitcnt vmcnt(18)
    v_mfma_f32_32x32x16_bf16 v[128:143], v[20:23], a[44:47], v[128:143]
    v_mfma_f32_32x32x16_bf16 v[144:159], v[24:27], a[44:47], v[144:159]
    v_mfma_f32_32x32x16_bf16 v[160:175], v[28:31], a[44:47], v[160:175]
    v_mfma_f32_32x32x16_bf16 v[176:191], v[32:35], a[44:47], v[176:191]
    s_waitcnt lgkmcnt(4)
    s_waitcnt vmcnt(15)
    v_mfma_f32_32x32x16_bf16 v[128:143], v[36:39], a[48:51], v[128:143]
    v_mfma_f32_32x32x16_bf16 v[144:159], v[40:43], a[48:51], v[144:159]
    v_mfma_f32_32x32x16_bf16 v[160:175], v[44:47], a[48:51], v[160:175]
    v_mfma_f32_32x32x16_bf16 v[176:191], v[48:51], a[48:51], v[176:191]
    s_waitcnt lgkmcnt(0)
    s_waitcnt vmcnt(12)
    v_mfma_f32_32x32x16_bf16 v[128:143], v[52:55], a[52:55], v[128:143]
    v_mfma_f32_32x32x16_bf16 v[144:159], v[56:59], a[52:55], v[144:159]
    v_mfma_f32_32x32x16_bf16 v[160:175], v[60:63], a[52:55], v[160:175]
    v_mfma_f32_32x32x16_bf16 v[176:191], v[64:67], a[52:55], v[176:191]
    s_waitcnt vmcnt(10)
    s_barrier
    ds_read_b128 v[20:23], v4 offset:57344
    ds_read_b128 v[24:27], v4 offset:58368
    ds_read_b128 v[28:31], v4 offset:59392
    ds_read_b128 v[32:35], v4 offset:60416
    ds_read_b128 v[36:39], v4 offset:61440
    ds_read_b128 v[40:43], v4 offset:62464
    ds_read_b128 v[44:47], v4 offset:63488
    ds_read_b128 v[48:51], v4 offset:64512
    ds_read_b128 v[52:55], v5 offset:0
    ds_read_b128 v[56:59], v5 offset:1024
    ds_read_b128 v[60:63], v5 offset:2048
    ds_read_b128 v[64:67], v5 offset:3072
    s_waitcnt lgkmcnt(8)
    s_waitcnt vmcnt(9)
    v_mfma_f32_32x32x16_bf16 v[128:143], v[20:23], a[56:59], v[128:143]
    v_mfma_f32_32x32x16_bf16 v[144:159], v[24:27], a[56:59], v[144:159]
    v_mfma_f32_32x32x16_bf16 v[160:175], v[28:31], a[56:59], v[160:175]
    v_mfma_f32_32x32x16_bf16 v[176:191], v[32:35], a[56:59], v[176:191]
    ds_read_b128 v[20:23], v5 offset:4096
    ds_read_b128 v[24:27], v5 offset:5120
    ds_read_b128 v[28:31], v5 offset:6144
    ds_read_b128 v[32:35], v5 offset:7168
    s_waitcnt lgkmcnt(8)
    s_waitcnt vmcnt(8)
    v_mfma_f32_32x32x16_bf16 v[128:143], v[36:39], a[60:63], v[128:143]
    v_mfma_f32_32x32x16_bf16 v[144:159], v[40:43], a[60:63], v[144:159]
    v_mfma_f32_32x32x16_bf16 v[160:175], v[44:47], a[60:63], v[160:175]
    v_mfma_f32_32x32x16_bf16 v[176:191], v[48:51], a[60:63], v[176:191]
    ds_read_b128 v[36:39], v5 offset:8192
    ds_read_b128 v[40:43], v5 offset:9216
    ds_read_b128 v[44:47], v5 offset:10240
    ds_read_b128 v[48:51], v5 offset:11264
    s_waitcnt lgkmcnt(8)
    s_waitcnt vmcnt(7)
    v_mfma_f32_32x32x16_bf16 v[128:143], v[52:55], a[0:3], v[128:143]
    v_mfma_f32_32x32x16_bf16 v[144:159], v[56:59], a[0:3], v[144:159]
    v_mfma_f32_32x32x16_bf16 v[160:175], v[60:63], a[0:3], v[160:175]
    v_mfma_f32_32x32x16_bf16 v[176:191], v[64:67], a[0:3], v[176:191]
    ds_read_b128 v[52:55], v5 offset:12288
    ds_read_b128 v[56:59], v5 offset:13312
    ds_read_b128 v[60:63], v5 offset:14336
    ds_read_b128 v[64:67], v5 offset:15360
    s_waitcnt lgkmcnt(8)
    s_waitcnt vmcnt(6)
    v_mfma_f32_32x32x16_bf16 v[128:143], v[20:23], a[4:7], v[128:143]
    v_mfma_f32_32x32x16_bf16 v[144:159], v[24:27], a[4:7], v[144:159]
    v_mfma_f32_32x32x16_bf16 v[160:175], v[28:31], a[4:7], v[160:175]
    v_mfma_f32_32x32x16_bf16 v[176:191], v[32:35], a[4:7], v[176:191]
    ds_read_b128 v[20:23], v5 offset:16384
    ds_read_b128 v[24:27], v5 offset:17408
    ds_read_b128 v[28:31], v5 offset:18432
    ds_read_b128 v[32:35], v5 offset:19456
    s_waitcnt lgkmcnt(8)
    s_waitcnt vmcnt(5)
    v_mfma_f32_32x32x16_bf16 v[128:143], v[36:39], a[8:11], v[128:143]
    v_mfma_f32_32x32x16_bf16 v[144:159], v[40:43], a[8:11], v[144:159]
    v_mfma_f32_32x32x16_bf16 v[160:175], v[44:47], a[8:11], v[160:175]
    v_mfma_f32_32x32x16_bf16 v[176:191], v[48:51], a[8:11], v[176:191]
    ds_read_b128 v[36:39], v5 offset:20480
    ds_read_b128 v[40:43], v5 offset:21504
    ds_read_b128 v[44:47], v5 offset:22528
    ds_read_b128 v[48:51], v5 offset:23552
    s_waitcnt lgkmcnt(8)
    s_waitcnt vmcnt(4)
    v_mfma_f32_32x32x16_bf16 v[128:143], v[52:55], a[12:15], v[128:143]
    v_mfma_f32_32x32x16_bf16 v[144:159], v[56:59], a[12:15], v[144:159]
    v_mfma_f32_32x32x16_bf16 v[160:175], v[60:63], a[12:15], v[160:175]
    v_mfma_f32_32x32x16_bf16 v[176:191], v[64:67], a[12:15], v[176:191]
    ds_read_b128 v[52:55], v5 offset:24576
    ds_read_b128 v[56:59], v5 offset:25600
    ds_read_b128 v[60:63], v5 offset:26624
    ds_read_b128 v[64:67], v5 offset:27648
    s_waitcnt lgkmcnt(8)
    s_waitcnt vmcnt(3)
    v_mfma_f32_32x32x16_bf16 v[128:143], v[20:23], a[16:19], v[128:143]
    v_mfma_f32_32x32x16_bf16 v[144:159], v[24:27], a[16:19], v[144:159]
    v_mfma_f32_32x32x16_bf16 v[160:175], v[28:31], a[16:19], v[160:175]
    v_mfma_f32_32x32x16_bf16 v[176:191], v[32:35], a[16:19], v[176:191]
    ds_read_b128 v[20:23], v5 offset:28672
    ds_read_b128 v[24:27], v5 offset:29696
    ds_read_b128 v[28:31], v5 offset:30720
    ds_read_b128 v[32:35], v5 offset:31744
    s_waitcnt lgkmcnt(8)
    s_waitcnt vmcnt(2)
    v_mfma_f32_32x32x16_bf16 v[128:143], v[36:39], a[20:23], v[128:143]
    v_mfma_f32_32x32x16_bf16 v[144:159], v[40:43], a[20:23], v[144:159]
    v_mfma_f32_32x32x16_bf16 v[160:175], v[44:47], a[20:23], v[160:175]
    v_mfma_f32_32x32x16_bf16 v[176:191], v[48:51], a[20:23], v[176:191]
    s_waitcnt lgkmcnt(4)
    s_waitcnt vmcnt(1)
    v_mfma_f32_32x32x16_bf16 v[128:143], v[52:55], a[24:27], v[128:143]
    v_mfma_f32_32x32x16_bf16 v[144:159], v[56:59], a[24:27], v[144:159]
    v_mfma_f32_32x32x16_bf16 v[160:175], v[60:63], a[24:27], v[160:175]
    v_mfma_f32_32x32x16_bf16 v[176:191], v[64:67], a[24:27], v[176:191]
    s_waitcnt lgkmcnt(0)
    s_waitcnt vmcnt(0)
    v_mfma_f32_32x32x16_bf16 v[128:143], v[20:23], a[28:31], v[128:143]
    v_mfma_f32_32x32x16_bf16 v[144:159], v[24:27], a[28:31], v[144:159]
    v_mfma_f32_32x32x16_bf16 v[160:175], v[28:31], a[28:31], v[160:175]
    v_mfma_f32_32x32x16_bf16 v[176:191], v[32:35], a[28:31], v[176:191]
    s_waitcnt vmcnt(0)
    v_add_u32 v25, s45, v1
    v_mul_u32_u24 v26, 3277, v25
    v_lshrrev_b32 v26, 16, v26
    v_mul_u32_u24 v27, 20, v26
    v_sub_u32 v27, v25, v27
    v_mul_u32_u24 v28, 0x14000, v26
    v_lshl_add_u32 v28, v27, 4, v28
    v_mul_u32_u24 v29, 320, v2
    v_add_u32 v20, v28, v29
    v_lshlrev_b32 v17, 4, v2
    ds_read_b128 v[24:27], v17 offset:0
    ds_read_b128 v[40:43], v17 offset:512
    ds_read_b128 v[28:31], v17 offset:32
    ds_read_b128 v[44:47], v17 offset:544
    ds_read_b128 v[32:35], v17 offset:64
    ds_read_b128 v[48:51], v17 offset:576
    ds_read_b128 v[36:39], v17 offset:96
    ds_read_b128 v[52:55], v17 offset:608
    s_waitcnt lgkmcnt(0)
    v_mul_f32 v128, v128, v24
    v_fma_f32 v128, v40, v68, v128
    v_mul_f32 v129, v129, v25
    v_fma_f32 v129, v41, v68, v129
    v_mul_f32 v130, v130, v26
    v_fma_f32 v130, v42, v68, v130
    v_mul_f32 v131, v131, v27
    v_fma_f32 v131, v43, v68, v131
    v_mul_f32 v132, v132, v28
    v_fma_f32 v132, v44, v68, v132
    v_mul_f32 v133, v133, v29
    v_fma_f32 v133, v45, v68, v133
    v_mul_f32 v134, v134, v30
    v_fma_f32 v134, v46, v68, v134
    v_mul_f32 v135, v135, v31
    v_fma_f32 v135, v47, v68, v135
    v_mul_f32 v136, v136, v32
    v_fma_f32 v136, v48, v68, v136
    v_mul_f32 v137, v137, v33
    v_fma_f32 v137, v49, v68, v137
    v_mul_f32 v138, v138, v34
    v_fma_f32 v138, v50, v68, v138
    v_mul_f32 v139, v139, v35
    v_fma_f32 v139, v51, v68, v139
    v_mul_f32 v140, v140, v36
    v_fma_f32 v140, v52, v68, v140
    v_mul_f32 v141, v141, v37
    v_fma_f32 v141, v53, v68, v141
    v_mul_f32 v142, v142, v38
    v_fma_f32 v142, v54, v68, v142
    v_mul_f32 v143, v143, v39
    v_fma_f32 v143, v55, v68, v143
    v_cvt_pk_bf16_f32 v128, v128, v129
    v_cvt_pk_bf16_f32 v129, v130, v131
    v_cvt_pk_bf16_f32 v130, v132, v133
    v_cvt_pk_bf16_f32 v131, v134, v135
    v_cvt_pk_bf16_f32 v132, v136, v137
    v_cvt_pk_bf16_f32 v133, v138, v139
    v_cvt_pk_bf16_f32 v134, v140, v141
    v_cvt_pk_bf16_f32 v135, v142, v143
    s_add_u32 s49, s46, 0
    buffer_store_dwordx4 v[128:131], v20, s[28:31], s49 offen
    buffer_store_dwordx4 v[132:135], v20, s[28:31], s49 offen offset:640
    ds_read_b128 v[24:27], v17 offset:128
    ds_read_b128 v[40:43], v17 offset:640
    ds_read_b128 v[28:31], v17 offset:160
    ds_read_b128 v[44:47], v17 offset:672
    ds_read_b128 v[32:35], v17 offset:192
    ds_read_b128 v[48:51], v17 offset:704
    ds_read_b128 v[36:39], v17 offset:224
    ds_read_b128 v[52:55], v17 offset:736
    s_waitcnt lgkmcnt(0)
    v_mul_f32 v144, v144, v24
    v_fma_f32 v144, v40, v68, v144
    v_mul_f32 v145, v145, v25
    v_fma_f32 v145, v41, v68, v145
    v_mul_f32 v146, v146, v26
    v_fma_f32 v146, v42, v68, v146
    v_mul_f32 v147, v147, v27
    v_fma_f32 v147, v43, v68, v147
    v_mul_f32 v148, v148, v28
    v_fma_f32 v148, v44, v68, v148
    v_mul_f32 v149, v149, v29
    v_fma_f32 v149, v45, v68, v149
    v_mul_f32 v150, v150, v30
    v_fma_f32 v150, v46, v68, v150
    v_mul_f32 v151, v151, v31
    v_fma_f32 v151, v47, v68, v151
    v_mul_f32 v152, v152, v32
    v_fma_f32 v152, v48, v68, v152
    v_mul_f32 v153, v153, v33
    v_fma_f32 v153, v49, v68, v153
    v_mul_f32 v154, v154, v34
    v_fma_f32 v154, v50, v68, v154
    v_mul_f32 v155, v155, v35
    v_fma_f32 v155, v51, v68, v155
    v_mul_f32 v156, v156, v36
    v_fma_f32 v156, v52, v68, v156
    v_mul_f32 v157, v157, v37
    v_fma_f32 v157, v53, v68, v157
    v_mul_f32 v158, v158, v38
    v_fma_f32 v158, v54, v68, v158
    v_mul_f32 v159, v159, v39
    v_fma_f32 v159, v55, v68, v159
    v_cvt_pk_bf16_f32 v144, v144, v145
    v_cvt_pk_bf16_f32 v145, v146, v147
    v_cvt_pk_bf16_f32 v146, v148, v149
    v_cvt_pk_bf16_f32 v147, v150, v151
    v_cvt_pk_bf16_f32 v148, v152, v153
    v_cvt_pk_bf16_f32 v149, v154, v155
    v_cvt_pk_bf16_f32 v150, v156, v157
    v_cvt_pk_bf16_f32 v151, v158, v159
    s_add_u32 s49, s46, 1280
    buffer_store_dwordx4 v[144:147], v20, s[28:31], s49 offen
    buffer_store_dwordx4 v[148:151], v20, s[28:31], s49 offen offset:640
    ds_read_b128 v[24:27], v17 offset:256
    ds_read_b128 v[40:43], v17 offset:768
    ds_read_b128 v[28:31], v17 offset:288
    ds_read_b128 v[44:47], v17 offset:800
    ds_read_b128 v[32:35], v17 offset:320
    ds_read_b128 v[48:51], v17 offset:832
    ds_read_b128 v[36:39], v17 offset:352
    ds_read_b128 v[52:55], v17 offset:864
    s_waitcnt lgkmcnt(0)
    v_mul_f32 v160, v160, v24
    v_fma_f32 v160, v40, v68, v160
    v_mul_f32 v161, v161, v25
    v_fma_f32 v161, v41, v68, v161
    v_mul_f32 v162, v162, v26
    v_fma_f32 v162, v42, v68, v162
    v_mul_f32 v163, v163, v27
    v_fma_f32 v163, v43, v68, v163
    v_mul_f32 v164, v164, v28
    v_fma_f32 v164, v44, v68, v164
    v_mul_f32 v165, v165, v29
    v_fma_f32 v165, v45, v68, v165
    v_mul_f32 v166, v166, v30
    v_fma_f32 v166, v46, v68, v166
    v_mul_f32 v167, v167, v31
    v_fma_f32 v167, v47, v68, v167
    v_mul_f32 v168, v168, v32
    v_fma_f32 v168, v48, v68, v168
    v_mul_f32 v169, v169, v33
    v_fma_f32 v169, v49, v68, v169
    v_mul_f32 v170, v170, v34
    v_fma_f32 v170, v50, v68, v170
    v_mul_f32 v171, v171, v35
    v_fma_f32 v171, v51, v68, v171
    v_mul_f32 v172, v172, v36
    v_fma_f32 v172, v52, v68, v172
    v_mul_f32 v173, v173, v37
    v_fma_f32 v173, v53, v68, v173
    v_mul_f32 v174, v174, v38
    v_fma_f32 v174, v54, v68, v174
    v_mul_f32 v175, v175, v39
    v_fma_f32 v175, v55, v68, v175
    v_cvt_pk_bf16_f32 v160, v160, v161
    v_cvt_pk_bf16_f32 v161, v162, v163
    v_cvt_pk_bf16_f32 v162, v164, v165
    v_cvt_pk_bf16_f32 v163, v166, v167
    v_cvt_pk_bf16_f32 v164, v168, v169
    v_cvt_pk_bf16_f32 v165, v170, v171
    v_cvt_pk_bf16_f32 v166, v172, v173
    v_cvt_pk_bf16_f32 v167, v174, v175
    s_add_u32 s49, s46, 2560
    buffer_store_dwordx4 v[160:163], v20, s[28:31], s49 offen
    buffer_store_dwordx4 v[164:167], v20, s[28:31], s49 offen offset:640
    ds_read_b128 v[24:27], v17 offset:384
    ds_read_b128 v[40:43], v17 offset:896
    ds_read_b128 v[28:31], v17 offset:416
    ds_read_b128 v[44:47], v17 offset:928
    ds_read_b128 v[32:35], v17 offset:448
    ds_read_b128 v[48:51], v17 offset:960
    ds_read_b128 v[36:39], v17 offset:480
    ds_read_b128 v[52:55], v17 offset:992
    s_waitcnt lgkmcnt(0)
    v_mul_f32 v176, v176, v24
    v_fma_f32 v176, v40, v68, v176
    v_mul_f32 v177, v177, v25
    v_fma_f32 v177, v41, v68, v177
    v_mul_f32 v178, v178, v26
    v_fma_f32 v178, v42, v68, v178
    v_mul_f32 v179, v179, v27
    v_fma_f32 v179, v43, v68, v179
    v_mul_f32 v180, v180, v28
    v_fma_f32 v180, v44, v68, v180
    v_mul_f32 v181, v181, v29
    v_fma_f32 v181, v45, v68, v181
    v_mul_f32 v182, v182, v30
    v_fma_f32 v182, v46, v68, v182
    v_mul_f32 v183, v183, v31
    v_fma_f32 v183, v47, v68, v183
    v_mul_f32 v184, v184, v32
    v_fma_f32 v184, v48, v68, v184
    v_mul_f32 v185, v185, v33
    v_fma_f32 v185, v49, v68, v185
    v_mul_f32 v186, v186, v34
    v_fma_f32 v186, v50, v68, v186
    v_mul_f32 v187, v187, v35
    v_fma_f32 v187, v51, v68, v187
    v_mul_f32 v188, v188, v36
    v_fma_f32 v188, v52, v68, v188
    v_mul_f32 v189, v189, v37
    v_fma_f32 v189, v53, v68, v189
    v_mul_f32 v190, v190, v38
    v_fma_f32 v190, v54, v68, v190
    v_mul_f32 v191, v191, v39
    v_fma_f32 v191, v55, v68, v191
    v_cvt_pk_bf16_f32 v176, v176, v177
    v_cvt_pk_bf16_f32 v177, v178, v179
    v_cvt_pk_bf16_f32 v178, v180, v181
    v_cvt_pk_bf16_f32 v179, v182, v183
    v_cvt_pk_bf16_f32 v180, v184, v185
    v_cvt_pk_bf16_f32 v181, v186, v187
    v_cvt_pk_bf16_f32 v182, v188, v189
    v_cvt_pk_bf16_f32 v183, v190, v191
    s_add_u32 s49, s46, 3840
    buffer_store_dwordx4 v[176:179], v20, s[28:31], s49 offen
    buffer_store_dwordx4 v[180:183], v20, s[28:31], s49 offen offset:640
    s_branch L_qkv_end
L_qkv_end:
    s_endpgm
.globl attn_kernel
.p2align 8
.type attn_kernel,@function
attn_kernel:
    s_load_dwordx2 s[4:5], s[0:1], 72
    s_cmp_ge_u32 s2, 256
    s_cbranch_scc1 L_att_end
    s_and_b32 s6, s2, 31
    s_lshr_b32 s7, s2, 5
    v_lshrrev_b32 v1, 6, v0
    s_nop 0
    v_readfirstlane_b32 s8, v1
    v_and_b32 v2, 63, v0
    v_lshlrev_b32 v3, 4, v2
    s_waitcnt lgkmcnt(0)
    s_add_u32 s12, s4, 0x1400000
    s_addc_u32 s13, s5, 0
    s_and_b32 s13, s13, 0xffff
    s_mov_b32 s14, 0x400000
    s_mov_b32 s15, 0x00020000
    s_add_u32 s16, s4, 0x1800000
    s_addc_u32 s17, s5, 0
    s_and_b32 s17, s17, 0xffff
    s_mov_b32 s18, 0x400000
    s_mov_b32 s19, 0x00020000
    s_add_u32 s20, s4, 0x1c00000
    s_addc_u32 s21, s5, 0
    s_and_b32 s21, s21, 0xffff
    s_mov_b32 s22, 0x400000
    s_mov_b32 s23, 0x00020000
    s_add_u32 s24, s4, 0x2000000
    s_addc_u32 s25, s5, 0
    s_and_b32 s25, s25, 0xffff
    s_mov_b32 s26, 0x400000
    s_mov_b32 s27, 0x00020000
    s_mul_i32 s9, s6, 81920
    s_lshl_b32 s10, s7, 3
    s_add_u32 s10, s10, s8
    s_mul_i32 s11, s10, 1280
    s_add_u32 s11, s11, s9
    s_mov_b32 s40, -1
    s_mov_b32 s41, 0
    s_mov_b32 s42, 0x000fffff
    s_mov_b32 s43, 0x000fffff
    v_mov_b32 v12, 0
    v_mov_b32 v13, 0
    v_mov_b32 v14, 0
    v_mov_b32 v15, 0
    v_lshlrev_b32 v4, 3, v2
    buffer_load_dwordx4 v[8:11], v3, s[12:15], s11 offen
    s_mov_b64 exec, s[40:41]
    buffer_load_dwordx2 v[12:13], v4, s[12:15], s11 offen offset:1024
    s_mov_b64 exec, -1
    s_lshl_b32 s33, s8, 10
    s_add_u32 s34, s9, s33
    s_add_u32 s35, s33, 0x0
    s_mov_b32 m0, s35
    s_add_u32 s36, s34, 0x0
    buffer_load_dwordx4 v3, s[16:19], s36 offen lds
    s_add_u32 s35, s33, 0x2000
    s_mov_b32 m0, s35
    s_add_u32 s36, s34, 0x2000
    buffer_load_dwordx4 v3, s[16:19], s36 offen lds
    s_add_u32 s35, s33, 0x4000
    s_mov_b32 m0, s35
    s_add_u32 s36, s34, 0x4000
    buffer_load_dwordx4 v3, s[16:19], s36 offen lds
    s_add_u32 s35, s33, 0x6000
    s_mov_b32 m0, s35
    s_add_u32 s36, s34, 0x6000
    buffer_load_dwordx4 v3, s[16:19], s36 offen lds
    s_add_u32 s35, s33, 0x8000
    s_mov_b32 m0, s35
    s_add_u32 s36, s34, 0x8000
    buffer_load_dwordx4 v3, s[16:19], s36 offen lds
    s_add_u32 s35, s33, 0xa000
    s_mov_b32 m0, s35
    s_add_u32 s36, s34, 0xa000
    buffer_load_dwordx4 v3, s[16:19], s36 offen lds
    s_add_u32 s35, s33, 0xc000
    s_mov_b32 m0, s35
    s_add_u32 s36, s34, 0xc000
    buffer_load_dwordx4 v3, s[16:19], s36 offen lds
    s_add_u32 s35, s33, 0xe000
    s_mov_b32 m0, s35
    s_add_u32 s36, s34, 0xe000
    buffer_load_dwordx4 v3, s[16:19], s36 offen lds
    s_add_u32 s35, s33, 0x10000
    s_mov_b32 m0, s35
    s_add_u32 s36, s34, 0x10000
    buffer_load_dwordx4 v3, s[16:19], s36 offen lds
    s_add_u32 s35, s33, 0x12000
    s_mov_b32 m0, s35
    s_add_u32 s36, s34, 0x12000
    buffer_load_dwordx4 v3, s[16:19], s36 offen lds
    s_add_u32 s35, s33, 0x14000
    s_mov_b32 m0, s35
    s_add_u32 s36, s34, 0x0
    buffer_load_dwordx4 v3, s[20:23], s36 offen lds
    s_add_u32 s35, s33, 0x16000
    s_mov_b32 m0, s35
    s_add_u32 s36, s34, 0x2000
    buffer_load_dwordx4 v3, s[20:23], s36 offen lds
    s_add_u32 s35, s33, 0x18000
    s_mov_b32 m0, s35
    s_add_u32 s36, s34, 0x4000
    buffer_load_dwordx4 v3, s[20:23], s36 offen lds
    s_add_u32 s35, s33, 0x1a000
    s_mov_b32 m0, s35
    s_add_u32 s36, s34, 0x6000
    buffer_load_dwordx4 v3, s[20:23], s36 offen lds
    s_add_u32 s35, s33, 0x1c000
    s_mov_b32 m0, s35
    s_add_u32 s36, s34, 0x8000
    buffer_load_dwordx4 v3, s[20:23], s36 offen lds
    s_add_u32 s35, s33, 0x1e000
    s_mov_b32 m0, s35
    s_add_u32 s36, s34, 0xa000
    buffer_load_dwordx4 v3, s[20:23], s36 offen lds
    s_add_u32 s35, s33, 0x20000
    s_mov_b32 m0, s35
    s_add_u32 s36, s34, 0xc000
    buffer_load_dwordx4 v3, s[20:23], s36 offen lds
    s_add_u32 s35, s33, 0x22000
    s_mov_b32 m0, s35
    s_add_u32 s36, s34, 0xe000
    buffer_load_dwordx4 v3, s[20:23], s36 offen lds
    s_add_u32 s35, s33, 0x24000
    s_mov_b32 m0, s35
    s_add_u32 s36, s34, 0x10000
    buffer_load_dwordx4 v3, s[20:23], s36 offen lds
    s_add_u32 s35, s33, 0x26000
    s_mov_b32 m0, s35
    s_add_u32 s36, s34, 0x12000
    buffer_load_dwordx4 v3, s[20:23], s36 offen lds
    v_mov_b32 v160, 0xff800000
    v_mov_b32 v161, 0xff800000
    v_mov_b32 v6, v3
    v_add_u32 v5, 40960, v3
    v_add_u32 v1, 40960, v4
    v_and_b32 v7, 31, v2
    v_lshrrev_b32 v162, 5, v2
    v_mul_u32_u24 v162, 320, v162
    v_lshl_add_u32 v162, v7, 4, v162
    v_add_u32 v162, 81920, v162
    v_add_u32 v163, 40960, v162
    v_mov_b32 v116, 0
    v_mov_b32 v117, 0
    v_mov_b32 v118, 0
    v_mov_b32 v119, 0
    v_mov_b32 v124, 0
    v_mov_b32 v125, 0
    v_mov_b32 v126, 0
    v_mov_b32 v127, 0
    v_mov_b32 v132, 0
    v_mov_b32 v133, 0
    v_mov_b32 v134, 0
    v_mov_b32 v135, 0
    v_mov_b32 v140, 0
    v_mov_b32 v141, 0
    v_mov_b32 v142, 0
    v_mov_b32 v143, 0
    v_cmp_eq_u32 vcc, 20, v7
    v_cmp_eq_u32 s[44:45], 24, v7
    s_or_b64 vcc, vcc, s[44:45]
    v_mov_b32 v7, 0x3f803f80
    s_nop 1
    v_cndmask_b32 v144, 0, v7, vcc
    v_cndmask_b32 v145, 0, v7, vcc
    v_cndmask_b32 v146, 0, v7, vcc
    v_cndmask_b32 v147, 0, v7, vcc
    v_cndmask_b32 v148, 0, v7, vcc
    v_cndmask_b32 v149, 0, v7, vcc
    v_cndmask_b32 v150, 0, v7, vcc
    v_cndmask_b32 v151, 0, v7, vcc
    v_cndmask_b32 v152, 0, v7, vcc
    v_cndmask_b32 v153, 0, v7, vcc
    v_cndmask_b32 v154, 0, v7, vcc
    v_cndmask_b32 v155, 0, v7, vcc
    v_cndmask_b32 v156, 0, v7, vcc
    v_cndmask_b32 v157, 0, v7, vcc
    v_cndmask_b32 v158, 0, v7, vcc
    v_cndmask_b32 v159, 0, v7, vcc
    s_waitcnt vmcnt(17)
    s_barrier
    ds_read_b128 v[112:115], v6 offset:0
    s_mov_b64 exec, s[40:41]
    ds_read_b64 v[116:117], v4 offset:1024
    s_mov_b64 exec, -1
    ds_read_b128 v[120:123], v6 offset:1280
    s_mov_b64 exec, s[40:41]
    ds_read_b64 v[124:125], v4 offset:2304
    s_mov_b64 exec, -1
    ds_read_b128 v[128:131], v6 offset:2560
    s_mov_b64 exec, s[40:41]
    ds_read_b64 v[132:133], v4 offset:3584
    s_mov_b64 exec, -1
    s_waitcnt lgkmcnt(4)
    ds_read_b128 v[136:139], v6 offset:3840
    s_mov_b64 exec, s[40:41]
    ds_read_b64 v[140:141], v4 offset:4864
    s_mov_b64 exec, -1
    v_mfma_f32_32x32x16_bf16 v[32:47], v[112:115], v[8:11], 0
    v_mfma_f32_32x32x16_bf16 v[32:47], v[116:119], v[12:15], v[32:47]
    s_waitcnt lgkmcnt(4)
    ds_read_b128 v[112:115], v6 offset:5120
    s_mov_b64 exec, s[40:41]
    ds_read_b64 v[116:117], v4 offset:6144
    s_mov_b64 exec, -1
    v_mfma_f32_32x32x16_bf16 v[48:63], v[120:123], v[8:11], 0
    v_mfma_f32_32x32x16_bf16 v[48:63], v[124:127], v[12:15], v[48:63]
    s_waitcnt lgkmcnt(4)
    ds_read_b128 v[120:123], v6 offset:6400
    s_mov_b64 exec, s[40:41]
    ds_read_b64 v[124:125], v4 offset:7424
    s_mov_b64 exec, -1
    v_mfma_f32_32x32x16_bf16 v[64:79], v[128:131], v[8:11], 0
    v_max3_f32 v160, v32, v33, v160
    v_max3_f32 v161, v34, v35, v161
    v_max3_f32 v160, v36, v37, v160
    v_max3_f32 v161, v38, v39, v161
    v_mfma_f32_32x32x16_bf16 v[64:79], v[132:135], v[12:15], v[64:79]
    v_max3_f32 v160, v40, v41, v160
    v_max3_f32 v161, v42, v43, v161
    v_max3_f32 v160, v44, v45, v160
    v_max3_f32 v161, v46, v47, v161
    s_waitcnt lgkmcnt(4)
    ds_read_b128 v[128:131], v6 offset:7680
    s_mov_b64 exec, s[40:41]
    ds_read_b64 v[132:133], v4 offset:8704
    s_mov_b64 exec, -1
    v_mfma_f32_32x32x16_bf16 v[32:47], v[136:139], v[8:11], 0
    v_max3_f32 v160, v48, v49, v160
    v_max3_f32 v161, v50, v51, v161
    v_max3_f32 v160, v52, v53, v160
    v_max3_f32 v161, v54, v55, v161
    v_mfma_f32_32x32x16_bf16 v[32:47], v[140:143], v[12:15], v[32:47]
    v_max3_f32 v160, v56, v57, v160
    v_max3_f32 v161, v58, v59, v161
    v_max3_f32 v160, v60, v61, v160
    v_max3_f32 v161, v62, v63, v161
    s_waitcnt lgkmcnt(4)
    ds_read_b128 v[136:139], v6 offset:8960
    s_mov_b64 exec, s[40:41]
    ds_read_b64 v[140:141], v4 offset:9984
    s_mov_b64 exec, -1
    v_mfma_f32_32x32x16_bf16 v[48:63], v[112:115], v[8:11], 0
    v_max3_f32 v160, v64, v65, v160
    v_max3_f32 v161, v66, v67, v161
    v_max3_f32 v160, v68, v69, v160
    v_max3_f32 v161, v70, v71, v161
    v_mfma_f32_32x32x16_bf16 v[48:63], v[116:119], v[12:15], v[48:63]
    v_max3_f32 v160, v72, v73, v160
    v_max3_f32 v161, v74, v75, v161
    v_max3_f32 v160, v76, v77, v160
    v_max3_f32 v161, v78, v79, v161
    s_waitcnt lgkmcnt(4)
    ds_read_b128 v[112:115], v6 offset:10240
    s_mov_b64 exec, s[40:41]
    ds_read_b64 v[116:117], v4 offset:11264
    s_mov_b64 exec, -1
    v_mfma_f32_32x32x16_bf16 v[64:79], v[120:123], v[8:11], 0
    v_max3_f32 v160, v32, v33, v160
    v_max3_f32 v161, v34, v35, v161
    v_max3_f32 v160, v36, v37, v160
    v_max3_f32 v161, v38, v39, v161
    v_mfma_f32_32x32x16_bf16 v[64:79], v[124:127], v[12:15], v[64:79]
    v_max3_f32 v160, v40, v41, v160
    v_max3_f32 v161, v42, v43, v161
    v_max3_f32 v160, v44, v45, v160
    v_max3_f32 v161, v46, v47, v161
    s_waitcnt lgkmcnt(4)
    ds_read_b128 v[120:123], v6 offset:11520
    s_mov_b64 exec, s[40:41]
    ds_read_b64 v[124:125], v4 offset:12544
    s_mov_b64 exec, -1
    v_mfma_f32_32x32x16_bf16 v[32:47], v[128:131], v[8:11], 0
    v_max3_f32 v160, v48, v49, v160
    v_max3_f32 v161, v50, v51, v161
    v_max3_f32 v160, v52, v53, v160
    v_max3_f32 v161, v54, v55, v161
    v_mfma_f32_32x32x16_bf16 v[32:47], v[132:135], v[12:15], v[32:47]
    v_max3_f32 v160, v56, v57, v160
    v_max3_f32 v161, v58, v59, v161
    v_max3_f32 v160, v60, v61, v160
    v_max3_f32 v161, v62, v63, v161
    s_waitcnt lgkmcnt(4)
    ds_read_b128 v[128:131], v6 offset:12800
    s_mov_b64 exec, s[40:41]
    ds_read_b64 v[132:133], v4 offset:13824
    s_mov_b64 exec, -1
    v_mfma_f32_32x32x16_bf16 v[48:63], v[136:139], v[8:11], 0
    v_max3_f32 v160, v64, v65, v160
    v_max3_f32 v161, v66, v67, v161
    v_max3_f32 v160, v68, v69, v160
    v_max3_f32 v161, v70, v71, v161
    v_mfma_f32_32x32x16_bf16 v[48:63], v[140:143], v[12:15], v[48:63]
    v_max3_f32 v160, v72, v73, v160
    v_max3_f32 v161, v74, v75, v161
    v_max3_f32 v160, v76, v77, v160
    v_max3_f32 v161, v78, v79, v161
    s_waitcnt lgkmcnt(4)
    ds_read_b128 v[136:139], v6 offset:14080
    s_mov_b64 exec, s[40:41]
    ds_read_b64 v[140:141], v4 offset:15104
    s_mov_b64 exec, -1
    v_mfma_f32_32x32x16_bf16 v[64:79], v[112:115], v[8:11], 0
    v_max3_f32 v160, v32, v33, v160
    v_max3_f32 v161, v34, v35, v161
    v_max3_f32 v160, v36, v37, v160
    v_max3_f32 v161, v38, v39, v161
    v_mfma_f32_32x32x16_bf16 v[64:79], v[116:119], v[12:15], v[64:79]
    v_max3_f32 v160, v40, v41, v160
    v_max3_f32 v161, v42, v43, v161
    v_max3_f32 v160, v44, v45, v160
    v_max3_f32 v161, v46, v47, v161
    s_waitcnt lgkmcnt(4)
    ds_read_b128 v[112:115], v6 offset:15360
    s_mov_b64 exec, s[40:41]
    ds_read_b64 v[116:117], v4 offset:16384
    s_mov_b64 exec, -1
    v_mfma_f32_32x32x16_bf16 v[32:47], v[120:123], v[8:11], 0
    v_max3_f32 v160, v48, v49, v160
    v_max3_f32 v161, v50, v51, v161
    v_max3_f32 v160, v52, v53, v160
    v_max3_f32 v161, v54, v55, v161
    v_mfma_f32_32x32x16_bf16 v[32:47], v[124:127], v[12:15], v[32:47]
    v_max3_f32 v160, v56, v57, v160
    v_max3_f32 v161, v58, v59, v161
    v_max3_f32 v160, v60, v61, v160
    v_max3_f32 v161, v62, v63, v161
    s_waitcnt lgkmcnt(4)
    ds_read_b128 v[120:123], v6 offset:16640
    s_mov_b64 exec, s[40:41]
    ds_read_b64 v[124:125], v4 offset:17664
    s_mov_b64 exec, -1
    v_mfma_f32_32x32x16_bf16 v[48:63], v[128:131], v[8:11], 0
    v_max3_f32 v160, v64, v65, v160
    v_max3_f32 v161, v66, v67, v161
    v_max3_f32 v160, v68, v69, v160
    v_max3_f32 v161, v70, v71, v161
    v_mfma_f32_32x32x16_bf16 v[48:63], v[132:135], v[12:15], v[48:63]
    v_max3_f32 v160, v72, v73, v160
    v_max3_f32 v161, v74, v75, v161
    v_max3_f32 v160, v76, v77, v160
    v_max3_f32 v161, v78, v79, v161
    s_waitcnt lgkmcnt(4)
    ds_read_b128 v[128:131], v6 offset:17920
    s_mov_b64 exec, s[40:41]
    ds_read_b64 v[132:133], v4 offset:18944
    s_mov_b64 exec, -1
    v_mfma_f32_32x32x16_bf16 v[64:79], v[136:139], v[8:11], 0
    v_max3_f32 v160, v32, v33, v160
    v_max3_f32 v161, v34, v35, v161
    v_max3_f32 v160, v36, v37, v160
    v_max3_f32 v161, v38, v39, v161
    v_mfma_f32_32x32x16_bf16 v[64:79], v[140:143], v[12:15], v[64:79]
    v_max3_f32 v160, v40, v41, v160
    v_max3_f32 v161, v42, v43, v161
    v_max3_f32 v160, v44, v45, v160
    v_max3_f32 v161, v46, v47, v161
    s_waitcnt lgkmcnt(4)
    ds_read_b128 v[136:139], v6 offset:19200
    s_mov_b64 exec, s[40:41]
    ds_read_b64 v[140:141], v4 offset:20224
    s_mov_b64 exec, -1
    v_mfma_f32_32x32x16_bf16 v[32:47], v[112:115], v[8:11], 0
    v_max3_f32 v160, v48, v49, v160
    v_max3_f32 v161, v50, v51, v161
    v_max3_f32 v160, v52, v53, v160
    v_max3_f32 v161, v54, v55, v161
    v_mfma_f32_32x32x16_bf16 v[32:47], v[116:119], v[12:15], v[32:47]
    v_max3_f32 v160, v56, v57, v160
    v_max3_f32 v161, v58, v59, v161
    v_max3_f32 v160, v60, v61, v160
    v_max3_f32 v161, v62, v63, v161
    s_waitcnt lgkmcnt(4)
    v_mfma_f32_32x32x16_bf16 v[48:63], v[120:123], v[8:11], 0
    v_max3_f32 v160, v64, v65, v160
    v_max3_f32 v161, v66, v67, v161
    v_max3_f32 v160, v68, v69, v160
    v_max3_f32 v161, v70, v71, v161
    v_mfma_f32_32x32x16_bf16 v[48:63], v[124:127], v[12:15], v[48:63]
    v_max3_f32 v160, v72, v73, v160
    v_max3_f32 v161, v74, v75, v161
    v_max3_f32 v160, v76, v77, v160
    v_max3_f32 v161, v78, v79, v161
    s_waitcnt lgkmcnt(2)
    v_mfma_f32_32x32x16_bf16 v[64:79], v[128:131], v[8:11], 0
    v_max3_f32 v160, v32, v33, v160
    v_max3_f32 v161, v34, v35, v161
    v_max3_f32 v160, v36, v37, v160
    v_max3_f32 v161, v38, v39, v161
    v_mfma_f32_32x32x16_bf16 v[64:79], v[132:135], v[12:15], v[64:79]
    v_max3_f32 v160, v40, v41, v160
    v_max3_f32 v161, v42, v43, v161
    v_max3_f32 v160, v44, v45, v160
    v_max3_f32 v161, v46, v47, v161
    s_waitcnt lgkmcnt(0)
    v_mfma_f32_32x32x16_bf16 v[32:47], v[136:139], v[8:11], 0
    v_max3_f32 v160, v48, v49, v160
    v_max3_f32 v161, v50, v51, v161
    v_max3_f32 v160, v52, v53, v160
    v_max3_f32 v161, v54, v55, v161
    v_mfma_f32_32x32x16_bf16 v[32:47], v[140:143], v[12:15], v[32:47]
    v_max3_f32 v160, v56, v57, v160
    v_max3_f32 v161, v58, v59, v161
    v_max3_f32 v160, v60, v61, v160
    v_max3_f32 v161, v62, v63, v161
    s_nop 7
    v_max3_f32 v160, v64, v65, v160
    v_max3_f32 v161, v66, v67, v161
    v_max3_f32 v160, v68, v69, v160
    v_max3_f32 v161, v70, v71, v161
    s_nop 7
    v_max3_f32 v160, v72, v73, v160
    v_max3_f32 v161, v74, v75, v161
    v_max3_f32 v160, v76, v77, v160
    v_max3_f32 v161, v78, v79, v161
    s_nop 7
    v_max3_f32 v160, v32, v33, v160
    v_max3_f32 v161, v34, v35, v161
    v_max3_f32 v160, v36, v37, v160
    v_max3_f32 v161, v38, v39, v161
    v_max3_f32 v160, v40, v41, v160
    v_max3_f32 v161, v42, v43, v161
    v_max3_f32 v160, v44, v45, v160
    v_max3_f32 v161, v46, v47, v161
    s_waitcnt vmcnt(0)
    s_barrier
    ds_read_b128 v[112:115], v6 offset:20480
    s_mov_b64 exec, s[40:41]
    ds_read_b64 v[116:117], v4 offset:21504
    s_mov_b64 exec, -1
    ds_read_b128 v[120:123], v6 offset:21760
    s_mov_b64 exec, s[40:41]
    ds_read_b64 v[124:125], v4 offset:22784
    s_mov_b64 exec, -1
    ds_read_b128 v[128:131], v6 offset:23040
    s_mov_b64 exec, s[40:41]
    ds_read_b64 v[132:133], v4 offset:24064
    s_mov_b64 exec, -1
    s_waitcnt lgkmcnt(4)
    ds_read_b128 v[136:139], v6 offset:24320
    s_mov_b64 exec, s[40:41]
    ds_read_b64 v[140:141], v4 offset:25344
    s_mov_b64 exec, -1
    v_mfma_f32_32x32x16_bf16 v[48:63], v[112:115], v[8:11], 0
    v_mfma_f32_32x32x16_bf16 v[48:63], v[116:119], v[12:15], v[48:63]
    s_waitcnt lgkmcnt(4)
    ds_read_b128 v[112:115], v6 offset:25600
    s_mov_b64 exec, s[40:41]
    ds_read_b64 v[116:117], v4 offset:26624
    s_mov_b64 exec, -1
    v_mfma_f32_32x32x16_bf16 v[64:79], v[120:123], v[8:11], 0
    v_mfma_f32_32x32x16_bf16 v[64:79], v[124:127], v[12:15], v[64:79]
    s_waitcnt lgkmcnt(4)
    ds_read_b128 v[120:123], v6 offset:26880
    s_mov_b64 exec, s[40:41]
    ds_read_b64 v[124:125], v4 offset:27904
    s_mov_b64 exec, -1
    v_mfma_f32_32x32x16_bf16 v[32:47], v[128:131], v[8:11], 0
    v_max3_f32 v160, v48, v49, v160
    v_max3_f32 v161, v50, v51, v161
    v_max3_f32 v160, v52, v53, v160
    v_max3_f32 v161, v54, v55, v161
    v_mfma_f32_32x32x16_bf16 v[32:47], v[132:135], v[12:15], v[32:47]
    v_max3_f32 v160, v56, v57, v160
    v_max3_f32 v161, v58, v59, v161
    v_max3_f32 v160, v60, v61, v160
    v_max3_f32 v161, v62, v63, v161
    s_waitcnt lgkmcnt(4)
    ds_read_b128 v[128:131], v6 offset:28160
    s_mov_b64 exec, s[40:41]
    ds_read_b64 v[132:133], v4 offset:29184
    s_mov_b64 exec, -1
    v_mfma_f32_32x32x16_bf16 v[48:63], v[136:139], v[8:11], 0
    v_max3_f32 v160, v64, v65, v160
    v_max3_f32 v161, v66, v67, v161
    v_max3_f32 v160, v68, v69, v160
    v_max3_f32 v161, v70, v71, v161
    v_mfma_f32_32x32x16_bf16 v[48:63], v[140:143], v[12:15], v[48:63]
    v_max3_f32 v160, v72, v73, v160
    v_max3_f32 v161, v74, v75, v161
    v_max3_f32 v160, v76, v77, v160
    v_max3_f32 v161, v78, v79, v161
    s_waitcnt lgkmcnt(4)
    ds_read_b128 v[136:139], v6 offset:29440
    s_mov_b64 exec, s[40:41]
    ds_read_b64 v[140:141], v4 offset:30464
    s_mov_b64 exec, -1
    v_mfma_f32_32x32x16_bf16 v[64:79], v[112:115], v[8:11], 0
    v_max3_f32 v160, v32, v33, v160
    v_max3_f32 v161, v34, v35, v161
    v_max3_f32 v160, v36, v37, v160
    v_max3_f32 v161, v38, v39, v161
    v_mfma_f32_32x32x16_bf16 v[64:79], v[116:119], v[12:15], v[64:79]
    v_max3_f32 v160, v40, v41, v160
    v_max3_f32 v161, v42, v43, v161
    v_max3_f32 v160, v44, v45, v160
    v_max3_f32 v161, v46, v47, v161
    s_waitcnt lgkmcnt(4)
    ds_read_b128 v[112:115], v6 offset:30720
    s_mov_b64 exec, s[40:41]
    ds_read_b64 v[116:117], v4 offset:31744
    s_mov_b64 exec, -1
    v_mfma_f32_32x32x16_bf16 v[32:47], v[120:123], v[8:11], 0
    v_max3_f32 v160, v48, v49, v160
    v_max3_f32 v161, v50, v51, v161
    v_max3_f32 v160, v52, v53, v160
    v_max3_f32 v161, v54, v55, v161
    v_mfma_f32_32x32x16_bf16 v[32:47], v[124:127], v[12:15], v[32:47]
    v_max3_f32 v160, v56, v57, v160
    v_max3_f32 v161, v58, v59, v161
    v_max3_f32 v160, v60, v61, v160
    v_max3_f32 v161, v62, v63, v161
    s_waitcnt lgkmcnt(4)
    ds_read_b128 v[120:123], v6 offset:32000
    s_mov_b64 exec, s[40:41]
    ds_read_b64 v[124:125], v4 offset:33024
    s_mov_b64 exec, -1
    v_mfma_f32_32x32x16_bf16 v[48:63], v[128:131], v[8:11], 0
    v_max3_f32 v160, v64, v65, v160
    v_max3_f32 v161, v66, v67, v161
    v_max3_f32 v160, v68, v69, v160
    v_max3_f32 v161, v70, v71, v161
    v_mfma_f32_32x32x16_bf16 v[48:63], v[132:135], v[12:15], v[48:63]
    v_max3_f32 v160, v72, v73, v160
    v_max3_f32 v161, v74, v75, v161
    v_max3_f32 v160, v76, v77, v160
    v_max3_f32 v161, v78, v79, v161
    s_waitcnt lgkmcnt(4)
    ds_read_b128 v[128:131], v6 offset:33280
    s_mov_b64 exec, s[40:41]
    ds_read_b64 v[132:133], v4 offset:34304
    s_mov_b64 exec, -1
    v_mfma_f32_32x32x16_bf16 v[64:79], v[136:139], v[8:11], 0
    v_max3_f32 v160, v32, v33, v160
    v_max3_f32 v161, v34, v35, v161
    v_max3_f32 v160, v36, v37, v160
    v_max3_f32 v161, v38, v39, v161
    v_mfma_f32_32x32x16_bf16 v[64:79], v[140:143], v[12:15], v[64:79]
    v_max3_f32 v160, v40, v41, v160
    v_max3_f32 v161, v42, v43, v161
    v_max3_f32 v160, v44, v45, v160
    v_max3_f32 v161, v46, v47, v161
    s_waitcnt lgkmcnt(4)
    ds_read_b128 v[136:139], v6 offset:34560
    s_mov_b64 exec, s[40:41]
    ds_read_b64 v[140:141], v4 offset:35584
    s_mov_b64 exec, -1
    v_mfma_f32_32x32x16_bf16 v[32:47], v[112:115], v[8:11], 0
    v_max3_f32 v160, v48, v49, v160
    v_max3_f32 v161, v50, v51, v161
    v_max3_f32 v160, v52, v53, v160
    v_max3_f32 v161, v54, v55, v161
    v_mfma_f32_32x32x16_bf16 v[32:47], v[116:119], v[12:15], v[32:47]
    v_max3_f32 v160, v56, v57, v160
    v_max3_f32 v161, v58, v59, v161
    v_max3_f32 v160, v60, v61, v160
    v_max3_f32 v161, v62, v63, v161
    s_waitcnt lgkmcnt(4)
    ds_read_b128 v[112:115], v6 offset:35840
    s_mov_b64 exec, s[40:41]
    ds_read_b64 v[116:117], v4 offset:36864
    s_mov_b64 exec, -1
    v_mfma_f32_32x32x16_bf16 v[48:63], v[120:123], v[8:11], 0
    v_max3_f32 v160, v64, v65, v160
    v_max3_f32 v161, v66, v67, v161
    v_max3_f32 v160, v68, v69, v160
    v_max3_f32 v161, v70, v71, v161
    v_mfma_f32_32x32x16_bf16 v[48:63], v[124:127], v[12:15], v[48:63]
    v_max3_f32 v160, v72, v73, v160
    v_max3_f32 v161, v74, v75, v161
    v_max3_f32 v160, v76, v77, v160
    v_max3_f32 v161, v78, v79, v161
    s_waitcnt lgkmcnt(4)
    ds_read_b128 v[120:123], v6 offset:37120
    s_mov_b64 exec, s[40:41]
    ds_read_b64 v[124:125], v4 offset:38144
    s_mov_b64 exec, -1
    v_mfma_f32_32x32x16_bf16 v[64:79], v[128:131], v[8:11], 0
    v_max3_f32 v160, v32, v33, v160
    v_max3_f32 v161, v34, v35, v161
    v_max3_f32 v160, v36, v37, v160
    v_max3_f32 v161, v38, v39, v161
    v_mfma_f32_32x32x16_bf16 v[64:79], v[132:135], v[12:15], v[64:79]
    v_max3_f32 v160, v40, v41, v160
    v_max3_f32 v161, v42, v43, v161
    v_max3_f32 v160, v44, v45, v160
    v_max3_f32 v161, v46, v47, v161
    s_waitcnt lgkmcnt(4)
    ds_read_b128 v[128:131], v6 offset:38400
    s_mov_b64 exec, s[40:41]
    ds_read_b64 v[132:133], v4 offset:39424
    s_mov_b64 exec, -1
    v_mfma_f32_32x32x16_bf16 v[32:47], v[136:139], v[8:11], 0
    v_max3_f32 v160, v48, v49, v160
    v_max3_f32 v161, v50, v51, v161
    v_max3_f32 v160, v52, v53, v160
    v_max3_f32 v161, v54, v55, v161
    v_mfma_f32_32x32x16_bf16 v[32:47], v[140:143], v[12:15], v[32:47]
    v_max3_f32 v160, v56, v57, v160
    v_max3_f32 v161, v58, v59, v161
    v_max3_f32 v160, v60, v61, v160
    v_max3_f32 v161, v62, v63, v161
    s_waitcnt lgkmcnt(4)
    ds_read_b128 v[136:139], v6 offset:39680
    s_mov_b64 exec, s[40:41]
    ds_read_b64 v[140:141], v4 offset:40704
    s_mov_b64 exec, -1
    v_mfma_f32_32x32x16_bf16 v[48:63], v[112:115], v[8:11], 0
    v_max3_f32 v160, v64, v65, v160
    v_max3_f32 v161, v66, v67, v161
    v_max3_f32 v160, v68, v69, v160
    v_max3_f32 v161, v70, v71, v161
    v_mfma_f32_32x32x16_bf16 v[48:63], v[116:119], v[12:15], v[48:63]
    v_max3_f32 v160, v72, v73, v160
    v_max3_f32 v161, v74, v75, v161
    v_max3_f32 v160, v76, v77, v160
    v_max3_f32 v161, v78, v79, v161
    s_waitcnt lgkmcnt(4)
    ds_read_b128 v[112:115], v5 offset:0
    s_mov_b64 exec, s[40:41]
    ds_read_b64 v[116:117], v1 offset:1024
    s_mov_b64 exec, -1
    v_mfma_f32_32x32x16_bf16 v[64:79], v[120:123], v[8:11], 0
    v_max3_f32 v160, v32, v33, v160
    v_max3_f32 v161, v34, v35, v161
    v_max3_f32 v160, v36, v37, v160
    v_max3_f32 v161, v38, v39, v161
    v_mfma_f32_32x32x16_bf16 v[64:79], v[124:127], v[12:15], v[64:79]
    v_max3_f32 v160, v40, v41, v160
    v_max3_f32 v161, v42, v43, v161
    v_max3_f32 v160, v44, v45, v160
    v_max3_f32 v161, v46, v47, v161
    s_waitcnt lgkmcnt(4)
    ds_read_b128 v[120:123], v5 offset:1280
    s_mov_b64 exec, s[40:41]
    ds_read_b64 v[124:125], v1 offset:2304
    s_mov_b64 exec, -1
    v_mfma_f32_32x32x16_bf16 v[32:47], v[128:131], v[8:11], 0
    v_max3_f32 v160, v48, v49, v160
    v_max3_f32 v161, v50, v51, v161
    v_max3_f32 v160, v52, v53, v160
    v_max3_f32 v161, v54, v55, v161
    v_mfma_f32_32x32x16_bf16 v[32:47], v[132:135], v[12:15], v[32:47]
    v_max3_f32 v160, v56, v57, v160
    v_max3_f32 v161, v58, v59, v161
    v_max3_f32 v160, v60, v61, v160
    v_max3_f32 v161, v62, v63, v161
    s_waitcnt lgkmcnt(4)
    ds_read_b128 v[128:131], v5 offset:2560
    s_mov_b64 exec, s[40:41]
    ds_read_b64 v[132:133], v1 offset:3584
    s_mov_b64 exec, -1
    v_mfma_f32_32x32x16_bf16 v[48:63], v[136:139], v[8:11], 0
    v_max3_f32 v160, v64, v65, v160
    v_max3_f32 v161, v66, v67, v161
    v_max3_f32 v160, v68, v69, v160
    v_max3_f32 v161, v70, v71, v161
    v_mfma_f32_32x32x16_bf16 v[48:63], v[140:143], v[12:15], v[48:63]
    v_max3_f32 v160, v72, v73, v160
    v_max3_f32 v161, v74, v75, v161
    v_max3_f32 v160, v76, v77, v160
    v_max3_f32 v161, v78, v79, v161
    s_waitcnt lgkmcnt(4)
    ds_read_b128 v[136:139], v5 offset:3840
    s_mov_b64 exec, s[40:41]
    ds_read_b64 v[140:141], v1 offset:4864
    s_mov_b64 exec, -1
    v_mfma_f32_32x32x16_bf16 v[64:79], v[112:115], v[8:11], 0
    v_max3_f32 v160, v32, v33, v160
    v_max3_f32 v161, v34, v35, v161
    v_max3_f32 v160, v36, v37, v160
    v_max3_f32 v161, v38, v39, v161
    v_mfma_f32_32x32x16_bf16 v[64:79], v[116:119], v[12:15], v[64:79]
    v_max3_f32 v160, v40, v41, v160
    v_max3_f32 v161, v42, v43, v161
    v_max3_f32 v160, v44, v45, v160
    v_max3_f32 v161, v46, v47, v161
    s_waitcnt lgkmcnt(4)
    ds_read_b128 v[112:115], v5 offset:5120
    s_mov_b64 exec, s[40:41]
    ds_read_b64 v[116:117], v1 offset:6144
    s_mov_b64 exec, -1
    v_mfma_f32_32x32x16_bf16 v[32:47], v[120:123], v[8:11], 0
    v_max3_f32 v160, v48, v49, v160
    v_max3_f32 v161, v50, v51, v161
    v_max3_f32 v160, v52, v53, v160
    v_max3_f32 v161, v54, v55, v161
    v_mfma_f32_32x32x16_bf16 v[32:47], v[124:127], v[12:15], v[32:47]
    v_max3_f32 v160, v56, v57, v160
    v_max3_f32 v161, v58, v59, v161
    v_max3_f32 v160, v60, v61, v160
    v_max3_f32 v161, v62, v63, v161
    s_waitcnt lgkmcnt(4)
    ds_read_b128 v[120:123], v5 offset:6400
    s_mov_b64 exec, s[40:41]
    ds_read_b64 v[124:125], v1 offset:7424
    s_mov_b64 exec, -1
    v_mfma_f32_32x32x16_bf16 v[48:63], v[128:131], v[8:11], 0
    v_max3_f32 v160, v64, v65, v160
    v_max3_f32 v161, v66, v67, v161
    v_max3_f32 v160, v68, v69, v160
    v_max3_f32 v161, v70, v71, v161
    v_mfma_f32_32x32x16_bf16 v[48:63], v[132:135], v[12:15], v[48:63]
    v_max3_f32 v160, v72, v73, v160
    v_max3_f32 v161, v74, v75, v161
    v_max3_f32 v160, v76, v77, v160
    v_max3_f32 v161, v78, v79, v161
    s_waitcnt lgkmcnt(4)
    ds_read_b128 v[128:131], v5 offset:7680
    s_mov_b64 exec, s[40:41]
    ds_read_b64 v[132:133], v1 offset:8704
    s_mov_b64 exec, -1
    v_mfma_f32_32x32x16_bf16 v[64:79], v[136:139], v[8:11], 0
    v_max3_f32 v160, v32, v33, v160
    v_max3_f32 v161, v34, v35, v161
    v_max3_f32 v160, v36, v37, v160
    v_max3_f32 v161, v38, v39, v161
    v_mfma_f32_32x32x16_bf16 v[64:79], v[140:143], v[12:15], v[64:79]
    v_max3_f32 v160, v40, v41, v160
    v_max3_f32 v161, v42, v43, v161
    v_max3_f32 v160, v44, v45, v160
    v_max3_f32 v161, v46, v47, v161
    s_waitcnt lgkmcnt(4)
    ds_read_b128 v[136:139], v5 offset:8960
    s_mov_b64 exec, s[40:41]
    ds_read_b64 v[140:141], v1 offset:9984
    s_mov_b64 exec, -1
    v_mfma_f32_32x32x16_bf16 v[32:47], v[112:115], v[8:11], 0
    v_max3_f32 v160, v48, v49, v160
    v_max3_f32 v161, v50, v51, v161
    v_max3_f32 v160, v52, v53, v160
    v_max3_f32 v161, v54, v55, v161
    v_mfma_f32_32x32x16_bf16 v[32:47], v[116:119], v[12:15], v[32:47]
    v_max3_f32 v160, v56, v57, v160
    v_max3_f32 v161, v58, v59, v161
    v_max3_f32 v160, v60, v61, v160
    v_max3_f32 v161, v62, v63, v161
    s_waitcnt lgkmcnt(4)
    ds_read_b128 v[112:115], v5 offset:10240
    s_mov_b64 exec, s[40:41]
    ds_read_b64 v[116:117], v1 offset:11264
    s_mov_b64 exec, -1
    v_mfma_f32_32x32x16_bf16 v[48:63], v[120:123], v[8:11], 0
    v_max3_f32 v160, v64, v65, v160
    v_max3_f32 v161, v66, v67, v161
    v_max3_f32 v160, v68, v69, v160
    v_max3_f32 v161, v70, v71, v161
    v_mfma_f32_32x32x16_bf16 v[48:63], v[124:127], v[12:15], v[48:63]
    v_max3_f32 v160, v72, v73, v160
    v_max3_f32 v161, v74, v75, v161
    v_max3_f32 v160, v76, v77, v160
    v_max3_f32 v161, v78, v79, v161
    s_waitcnt lgkmcnt(4)
    ds_read_b128 v[120:123], v5 offset:11520
    s_mov_b64 exec, s[40:41]
    ds_read_b64 v[124:125], v1 offset:12544
    s_mov_b64 exec, -1
    v_mfma_f32_32x32x16_bf16 v[64:79], v[128:131], v[8:11], 0
    v_max3_f32 v160, v32, v33, v160
    v_max3_f32 v161, v34, v35, v161
    v_max3_f32 v160, v36, v37, v160
    v_max3_f32 v161, v38, v39, v161
    v_mfma_f32_32x32x16_bf16 v[64:79], v[132:135], v[12:15], v[64:79]
    v_max3_f32 v160, v40, v41, v160
    v_max3_f32 v161, v42, v43, v161
    v_max3_f32 v160, v44, v45, v160
    v_max3_f32 v161, v46, v47, v161
    s_waitcnt lgkmcnt(4)
    ds_read_b128 v[128:131], v5 offset:12800
    s_mov_b64 exec, s[40:41]
    ds_read_b64 v[132:133], v1 offset:13824
    s_mov_b64 exec, -1
    v_mfma_f32_32x32x16_bf16 v[32:47], v[136:139], v[8:11], 0
    v_max3_f32 v160, v48, v49, v160
    v_max3_f32 v161, v50, v51, v161
    v_max3_f32 v160, v52, v53, v160
    v_max3_f32 v161, v54, v55, v161
    v_mfma_f32_32x32x16_bf16 v[32:47], v[140:143], v[12:15], v[32:47]
    v_max3_f32 v160, v56, v57, v160
    v_max3_f32 v161, v58, v59, v161
    v_max3_f32 v160, v60, v61, v160
    v_max3_f32 v161, v62, v63, v161
    s_waitcnt lgkmcnt(4)
    ds_read_b128 v[136:139], v5 offset:14080
    s_mov_b64 exec, s[40:41]
    ds_read_b64 v[140:141], v1 offset:15104
    s_mov_b64 exec, -1
    v_mfma_f32_32x32x16_bf16 v[48:63], v[112:115], v[8:11], 0
    v_max3_f32 v160, v64, v65, v160
    v_max3_f32 v161, v66, v67, v161
    v_max3_f32 v160, v68, v69, v160
    v_max3_f32 v161, v70, v71, v161
    v_mfma_f32_32x32x16_bf16 v[48:63], v[116:119], v[12:15], v[48:63]
    v_max3_f32 v160, v72, v73, v160
    v_max3_f32 v161, v74, v75, v161
    v_max3_f32 v160, v76, v77, v160
    v_max3_f32 v161, v78, v79, v161
    s_waitcnt lgkmcnt(4)
    ds_read_b128 v[112:115], v5 offset:15360
    s_mov_b64 exec, s[40:41]
    ds_read_b64 v[116:117], v1 offset:16384
    s_mov_b64 exec, -1
    v_mfma_f32_32x32x16_bf16 v[64:79], v[120:123], v[8:11], 0
    v_max3_f32 v160, v32, v33, v160
    v_max3_f32 v161, v34, v35, v161
    v_max3_f32 v160, v36, v37, v160
    v_max3_f32 v161, v38, v39, v161
    v_mfma_f32_32x32x16_bf16 v[64:79], v[124:127], v[12:15], v[64:79]
    v_max3_f32 v160, v40, v41, v160
    v_max3_f32 v161, v42, v43, v161
    v_max3_f32 v160, v44, v45, v160
    v_max3_f32 v161, v46, v47, v161
    s_waitcnt lgkmcnt(4)
    ds_read_b128 v[120:123], v5 offset:16640
    s_mov_b64 exec, s[40:41]
    ds_read_b64 v[124:125], v1 offset:17664
    s_mov_b64 exec, -1
    v_mfma_f32_32x32x16_bf16 v[32:47], v[128:131], v[8:11], 0
    v_max3_f32 v160, v48, v49, v160
    v_max3_f32 v161, v50, v51, v161
    v_max3_f32 v160, v52, v53, v160
    v_max3_f32 v161, v54, v55, v161
    v_mfma_f32_32x32x16_bf16 v[32:47], v[132:135], v[12:15], v[32:47]
    v_max3_f32 v160, v56, v57, v160
    v_max3_f32 v161, v58, v59, v161
    v_max3_f32 v160, v60, v61, v160
    v_max3_f32 v161, v62, v63, v161
    s_waitcnt lgkmcnt(4)
    ds_read_b128 v[128:131], v5 offset:17920
    s_mov_b64 exec, s[40:41]
    ds_read_b64 v[132:133], v1 offset:18944
    s_mov_b64 exec, -1
    v_mfma_f32_32x32x16_bf16 v[48:63], v[136:139], v[8:11], 0
    v_max3_f32 v160, v64, v65, v160
    v_max3_f32 v161, v66, v67, v161
    v_max3_f32 v160, v68, v69, v160
    v_max3_f32 v161, v70, v71, v161
    v_mfma_f32_32x32x16_bf16 v[48:63], v[140:143], v[12:15], v[48:63]
    v_max3_f32 v160, v72, v73, v160
    v_max3_f32 v161, v74, v75, v161
    v_max3_f32 v160, v76, v77, v160
    v_max3_f32 v161, v78, v79, v161
    s_waitcnt lgkmcnt(4)
    ds_read_b128 v[136:139], v5 offset:19200
    s_mov_b64 exec, s[40:41]
    ds_read_b64 v[140:141], v1 offset:20224
    s_mov_b64 exec, -1
    v_mfma_f32_32x32x16_bf16 v[64:79], v[112:115], v[8:11], 0
    v_max3_f32 v160, v32, v33, v160
    v_max3_f32 v161, v34, v35, v161
    v_max3_f32 v160, v36, v37, v160
    v_max3_f32 v161, v38, v39, v161
    v_mfma_f32_32x32x16_bf16 v[64:79], v[116:119], v[12:15], v[64:79]
    v_max3_f32 v160, v40, v41, v160
    v_max3_f32 v161, v42, v43, v161
    v_max3_f32 v160, v44, v45, v160
    v_max3_f32 v161, v46, v47, v161
    s_waitcnt lgkmcnt(4)
    ds_read_b128 v[112:115], v5 offset:20480
    s_mov_b64 exec, s[40:41]
    ds_read_b64 v[116:117], v1 offset:21504
    s_mov_b64 exec, -1
    v_mfma_f32_32x32x16_bf16 v[32:47], v[120:123], v[8:11], 0
    v_max3_f32 v160, v48, v49, v160
    v_max3_f32 v161, v50, v51, v161
    v_max3_f32 v160, v52, v53, v160
    v_max3_f32 v161, v54, v55, v161
    v_mfma_f32_32x32x16_bf16 v[32:47], v[124:127], v[12:15], v[32:47]
    v_max3_f32 v160, v56, v57, v160
    v_max3_f32 v161, v58, v59, v161
    v_max3_f32 v160, v60, v61, v160
    v_max3_f32 v161, v62, v63, v161
    s_waitcnt lgkmcnt(4)
    ds_read_b128 v[120:123], v5 offset:21760
    s_mov_b64 exec, s[40:41]
    ds_read_b64 v[124:125], v1 offset:22784
    s_mov_b64 exec, -1
    v_mfma_f32_32x32x16_bf16 v[48:63], v[128:131], v[8:11], 0
    v_max3_f32 v160, v64, v65, v160
    v_max3_f32 v161, v66, v67, v161
    v_max3_f32 v160, v68, v69, v160
    v_max3_f32 v161, v70, v71, v161
    v_mfma_f32_32x32x16_bf16 v[48:63], v[132:135], v[12:15], v[48:63]
    v_max3_f32 v160, v72, v73, v160
    v_max3_f32 v161, v74, v75, v161
    v_max3_f32 v160, v76, v77, v160
    v_max3_f32 v161, v78, v79, v161
    s_waitcnt lgkmcnt(4)
    ds_read_b128 v[128:131], v5 offset:23040
    s_mov_b64 exec, s[40:41]
    ds_read_b64 v[132:133], v1 offset:24064
    s_mov_b64 exec, -1
    v_mfma_f32_32x32x16_bf16 v[64:79], v[136:139], v[8:11], 0
    v_max3_f32 v160, v32, v33, v160
    v_max3_f32 v161, v34, v35, v161
    v_max3_f32 v160, v36, v37, v160
    v_max3_f32 v161, v38, v39, v161
    v_mfma_f32_32x32x16_bf16 v[64:79], v[140:143], v[12:15], v[64:79]
    v_max3_f32 v160, v40, v41, v160
    v_max3_f32 v161, v42, v43, v161
    v_max3_f32 v160, v44, v45, v160
    v_max3_f32 v161, v46, v47, v161
    s_waitcnt lgkmcnt(4)
    ds_read_b128 v[136:139], v5 offset:24320
    s_mov_b64 exec, s[40:41]
    ds_read_b64 v[140:141], v1 offset:25344
    s_mov_b64 exec, -1
    v_mfma_f32_32x32x16_bf16 v[32:47], v[112:115], v[8:11], 0
    v_max3_f32 v160, v48, v49, v160
    v_max3_f32 v161, v50, v51, v161
    v_max3_f32 v160, v52, v53, v160
    v_max3_f32 v161, v54, v55, v161
    v_mfma_f32_32x32x16_bf16 v[32:47], v[116:119], v[12:15], v[32:47]
    v_max3_f32 v160, v56, v57, v160
    v_max3_f32 v161, v58, v59, v161
    v_max3_f32 v160, v60, v61, v160
    v_max3_f32 v161, v62, v63, v161
    s_waitcnt lgkmcnt(4)
    ds_read_b128 v[112:115], v5 offset:25600
    s_mov_b64 exec, s[40:41]
    ds_read_b64 v[116:117], v1 offset:26624
    s_mov_b64 exec, -1
    v_mfma_f32_32x32x16_bf16 v[48:63], v[120:123], v[8:11], 0
    v_max3_f32 v160, v64, v65, v160
    v_max3_f32 v161, v66, v67, v161
    v_max3_f32 v160, v68, v69, v160
    v_max3_f32 v161, v70, v71, v161
    v_mfma_f32_32x32x16_bf16 v[48:63], v[124:127], v[12:15], v[48:63]
    v_max3_f32 v160, v72, v73, v160
    v_max3_f32 v161, v74, v75, v161
    v_max3_f32 v160, v76, v77, v160
    v_max3_f32 v161, v78, v79, v161
    s_waitcnt lgkmcnt(4)
    ds_read_b128 v[120:123], v5 offset:26880
    s_mov_b64 exec, s[40:41]
    ds_read_b64 v[124:125], v1 offset:27904
    s_mov_b64 exec, -1
    v_mfma_f32_32x32x16_bf16 v[64:79], v[128:131], v[8:11], 0
    v_max3_f32 v160, v32, v33, v160
    v_max3_f32 v161, v34, v35, v161
    v_max3_f32 v160, v36, v37, v160
    v_max3_f32 v161, v38, v39, v161
    v_mfma_f32_32x32x16_bf16 v[64:79], v[132:135], v[12:15], v[64:79]
    v_max3_f32 v160, v40, v41, v160
    v_max3_f32 v161, v42, v43, v161
    v_max3_f32 v160, v44, v45, v160
    v_max3_f32 v161, v46, v47, v161
    s_waitcnt lgkmcnt(4)
    ds_read_b128 v[128:131], v5 offset:28160
    s_mov_b64 exec, s[40:41]
    ds_read_b64 v[132:133], v1 offset:29184
    s_mov_b64 exec, -1
    v_mfma_f32_32x32x16_bf16 v[32:47], v[136:139], v[8:11], 0
    v_max3_f32 v160, v48, v49, v160
    v_max3_f32 v161, v50, v51, v161
    v_max3_f32 v160, v52, v53, v160
    v_max3_f32 v161, v54, v55, v161
    v_mfma_f32_32x32x16_bf16 v[32:47], v[140:143], v[12:15], v[32:47]
    v_max3_f32 v160, v56, v57, v160
    v_max3_f32 v161, v58, v59, v161
    v_max3_f32 v160, v60, v61, v160
    v_max3_f32 v161, v62, v63, v161
    s_waitcnt lgkmcnt(4)
    ds_read_b128 v[136:139], v5 offset:29440
    s_mov_b64 exec, s[40:41]
    ds_read_b64 v[140:141], v1 offset:30464
    s_mov_b64 exec, -1
    v_mfma_f32_32x32x16_bf16 v[48:63], v[112:115], v[8:11], 0
    v_max3_f32 v160, v64, v65, v160
    v_max3_f32 v161, v66, v67, v161
    v_max3_f32 v160, v68, v69, v160
    v_max3_f32 v161, v70, v71, v161
    v_mfma_f32_32x32x16_bf16 v[48:63], v[116:119], v[12:15], v[48:63]
    v_max3_f32 v160, v72, v73, v160
    v_max3_f32 v161, v74, v75, v161
    v_max3_f32 v160, v76, v77, v160
    v_max3_f32 v161, v78, v79, v161
    s_waitcnt lgkmcnt(4)
    ds_read_b128 v[112:115], v5 offset:30720
    s_mov_b64 exec, s[40:41]
    ds_read_b64 v[116:117], v1 offset:31744
    s_mov_b64 exec, -1
    v_mfma_f32_32x32x16_bf16 v[64:79], v[120:123], v[8:11], 0
    v_max3_f32 v160, v32, v33, v160
    v_max3_f32 v161, v34, v35, v161
    v_max3_f32 v160, v36, v37, v160
    v_max3_f32 v161, v38, v39, v161
    v_mfma_f32_32x32x16_bf16 v[64:79], v[124:127], v[12:15], v[64:79]
    v_max3_f32 v160, v40, v41, v160
    v_max3_f32 v161, v42, v43, v161
    v_max3_f32 v160, v44, v45, v160
    v_max3_f32 v161, v46, v47, v161
    s_waitcnt lgkmcnt(4)
    ds_read_b128 v[120:123], v5 offset:32000
    s_mov_b64 exec, s[40:41]
    ds_read_b64 v[124:125], v1 offset:33024
    s_mov_b64 exec, -1
    v_mfma_f32_32x32x16_bf16 v[32:47], v[128:131], v[8:11], 0
    v_max3_f32 v160, v48, v49, v160
    v_max3_f32 v161, v50, v51, v161
    v_max3_f32 v160, v52, v53, v160
    v_max3_f32 v161, v54, v55, v161
    v_mfma_f32_32x32x16_bf16 v[32:47], v[132:135], v[12:15], v[32:47]
    v_max3_f32 v160, v56, v57, v160
    v_max3_f32 v161, v58, v59, v161
    v_max3_f32 v160, v60, v61, v160
    v_max3_f32 v161, v62, v63, v161
    s_waitcnt lgkmcnt(4)
    ds_read_b128 v[128:131], v5 offset:33280
    s_mov_b64 exec, s[40:41]
    ds_read_b64 v[132:133], v1 offset:34304
    s_mov_b64 exec, -1
    v_mfma_f32_32x32x16_bf16 v[48:63], v[136:139], v[8:11], 0
    v_max3_f32 v160, v64, v65, v160
    v_max3_f32 v161, v66, v67, v161
    v_max3_f32 v160, v68, v69, v160
    v_max3_f32 v161, v70, v71, v161
    v_mfma_f32_32x32x16_bf16 v[48:63], v[140:143], v[12:15], v[48:63]
    v_max3_f32 v160, v72, v73, v160
    v_max3_f32 v161, v74, v75, v161
    v_max3_f32 v160, v76, v77, v160
    v_max3_f32 v161, v78, v79, v161
    s_waitcnt lgkmcnt(4)
    ds_read_b128 v[136:139], v5 offset:34560
    s_mov_b64 exec, s[40:41]
    ds_read_b64 v[140:141], v1 offset:35584
    s_mov_b64 exec, -1
    v_mfma_f32_32x32x16_bf16 v[64:79], v[112:115], v[8:11], 0
    v_max3_f32 v160, v32, v33, v160
    v_max3_f32 v161, v34, v35, v161
    v_max3_f32 v160, v36, v37, v160
    v_max3_f32 v161, v38, v39, v161
    v_mfma_f32_32x32x16_bf16 v[64:79], v[116:119], v[12:15], v[64:79]
    v_max3_f32 v160, v40, v41, v160
    v_max3_f32 v161, v42, v43, v161
    v_max3_f32 v160, v44, v45, v160
    v_max3_f32 v161, v46, v47, v161
    s_waitcnt lgkmcnt(4)
    ds_read_b128 v[112:115], v5 offset:35840
    s_mov_b64 exec, s[40:41]
    ds_read_b64 v[116:117], v1 offset:36864
    s_mov_b64 exec, -1
    v_mfma_f32_32x32x16_bf16 v[32:47], v[120:123], v[8:11], 0
    v_max3_f32 v160, v48, v49, v160
    v_max3_f32 v161, v50, v51, v161
    v_max3_f32 v160, v52, v53, v160
    v_max3_f32 v161, v54, v55, v161
    v_mfma_f32_32x32x16_bf16 v[32:47], v[124:127], v[12:15], v[32:47]
    v_max3_f32 v160, v56, v57, v160
    v_max3_f32 v161, v58, v59, v161
    v_max3_f32 v160, v60, v61, v160
    v_max3_f32 v161, v62, v63, v161
    s_waitcnt lgkmcnt(4)
    ds_read_b128 v[120:123], v5 offset:37120
    s_mov_b64 exec, s[40:41]
    ds_read_b64 v[124:125], v1 offset:38144
    s_mov_b64 exec, -1
    v_mfma_f32_32x32x16_bf16 v[48:63], v[128:131], v[8:11], 0
    v_max3_f32 v160, v64, v65, v160
    v_max3_f32 v161, v66, v67, v161
    v_max3_f32 v160, v68, v69, v160
    v_max3_f32 v161, v70, v71, v161
    v_mfma_f32_32x32x16_bf16 v[48:63], v[132:135], v[12:15], v[48:63]
    v_max3_f32 v160, v72, v73, v160
    v_max3_f32 v161, v74, v75, v161
    v_max3_f32 v160, v76, v77, v160
    v_max3_f32 v161, v78, v79, v161
    s_waitcnt lgkmcnt(4)
    ds_read_b128 v[128:131], v5 offset:38400
    s_mov_b64 exec, s[40:41]
    ds_read_b64 v[132:133], v1 offset:39424
    s_mov_b64 exec, -1
    v_mfma_f32_32x32x16_bf16 v[64:79], v[136:139], v[8:11], 0
    v_max3_f32 v160, v32, v33, v160
    v_max3_f32 v161, v34, v35, v161
    v_max3_f32 v160, v36, v37, v160
    v_max3_f32 v161, v38, v39, v161
    v_mfma_f32_32x32x16_bf16 v[64:79], v[140:143], v[12:15], v[64:79]
    v_max3_f32 v160, v40, v41, v160
    v_max3_f32 v161, v42, v43, v161
    v_max3_f32 v160, v44, v45, v160
    v_max3_f32 v161, v46, v47, v161
    s_waitcnt lgkmcnt(4)
    ds_read_b128 v[136:139], v5 offset:39680
    s_mov_b64 exec, s[40:41]
    ds_read_b64 v[140:141], v1 offset:40704
    s_mov_b64 exec, -1
    v_mfma_f32_32x32x16_bf16 v[32:47], v[112:115], v[8:11], 0
    v_max3_f32 v160, v48, v49, v160
    v_max3_f32 v161, v50, v51, v161
    v_max3_f32 v160, v52, v53, v160
    v_max3_f32 v161, v54, v55, v161
    v_mfma_f32_32x32x16_bf16 v[32:47], v[116:119], v[12:15], v[32:47]
    v_max3_f32 v160, v56, v57, v160
    v_max3_f32 v161, v58, v59, v161
    v_max3_f32 v160, v60, v61, v160
    v_max3_f32 v161, v62, v63, v161
    s_waitcnt lgkmcnt(4)
    v_mfma_f32_32x32x16_bf16 v[48:63], v[120:123], v[8:11], 0
    v_max3_f32 v160, v64, v65, v160
    v_max3_f32 v161, v66, v67, v161
    v_max3_f32 v160, v68, v69, v160
    v_max3_f32 v161, v70, v71, v161
    v_mfma_f32_32x32x16_bf16 v[48:63], v[124:127], v[12:15], v[48:63]
    v_max3_f32 v160, v72, v73, v160
    v_max3_f32 v161, v74, v75, v161
    v_max3_f32 v160, v76, v77, v160
    v_max3_f32 v161, v78, v79, v161
    s_waitcnt lgkmcnt(2)
    v_mfma_f32_32x32x16_bf16 v[64:79], v[128:131], v[8:11], 0
    v_max3_f32 v160, v32, v33, v160
    v_max3_f32 v161, v34, v35, v161
    v_max3_f32 v160, v36, v37, v160
    v_max3_f32 v161, v38, v39, v161
    v_mfma_f32_32x32x16_bf16 v[64:79], v[132:135], v[12:15], v[64:79]
    v_max3_f32 v160, v40, v41, v160
    v_max3_f32 v161, v42, v43, v161
    v_max3_f32 v160, v44, v45, v160
    v_max3_f32 v161, v46, v47, v161
    s_waitcnt lgkmcnt(0)
    v_mfma_f32_32x32x16_bf16 v[32:47], v[136:139], v[8:11], 0
    v_max3_f32 v160, v48, v49, v160
    v_max3_f32 v161, v50, v51, v161
    v_max3_f32 v160, v52, v53, v160
    v_max3_f32 v161, v54, v55, v161
    v_mfma_f32_32x32x16_bf16 v[32:47], v[140:143], v[12:15], v[32:47]
    v_max3_f32 v160, v56, v57, v160
    v_max3_f32 v161, v58, v59, v161
    v_max3_f32 v160, v60, v61, v160
    v_max3_f32 v161, v62, v63, v161
    s_nop 7
    v_max3_f32 v160, v64, v65, v160
    v_max3_f32 v161, v66, v67, v161
    v_max3_f32 v160, v68, v69, v160
    v_max3_f32 v161, v70, v71, v161
    s_nop 7
    v_max3_f32 v160, v72, v73, v160
    v_max3_f32 v161, v74, v75, v161
    v_max3_f32 v160, v76, v77, v160
    v_max3_f32 v161, v78, v79, v161
    s_nop 7
    v_max3_f32 v160, v32, v33, v160
    v_max3_f32 v161, v34, v35, v161
    v_max3_f32 v160, v36, v37, v160
    v_max3_f32 v161, v38, v39, v161
    v_max3_f32 v160, v40, v41, v160
    v_max3_f32 v161, v42, v43, v161
    v_max3_f32 v160, v44, v45, v160
    v_max3_f32 v161, v46, v47, v161
    v_max_f32 v160, v160, v161
    v_mov_b32 v161, v160
    s_nop 1
    v_permlane32_swap_b32 v160, v161
    s_nop 1
    v_max_f32 v160, v160, v161
    v_sub_f32 v16, 0, v160
    v_mov_b32 v96, 0
    v_sub_f32 v17, 0, v160
    v_mov_b32 v97, 0
    v_sub_f32 v18, 0, v160
    v_mov_b32 v98, 0
    v_sub_f32 v19, 0, v160
    v_mov_b32 v99, 0
    v_sub_f32 v20, 0, v160
    v_mov_b32 v100, 0
    v_sub_f32 v21, 0, v160
    v_mov_b32 v101, 0
    v_sub_f32 v22, 0, v160
    v_mov_b32 v102, 0
    v_sub_f32 v23, 0, v160
    v_mov_b32 v103, 0
    v_sub_f32 v24, 0, v160
    v_mov_b32 v104, 0
    v_sub_f32 v25, 0, v160
    v_mov_b32 v105, 0
    v_sub_f32 v26, 0, v160
    v_mov_b32 v106, 0
    v_sub_f32 v27, 0, v160
    v_mov_b32 v107, 0
    v_sub_f32 v28, 0, v160
    v_mov_b32 v108, 0
    v_sub_f32 v29, 0, v160
    v_mov_b32 v109, 0
    v_sub_f32 v30, 0, v160
    v_mov_b32 v110, 0
    v_sub_f32 v31, 0, v160
    v_mov_b32 v111, 0
    ds_read_b128 v[112:115], v6 offset:0
    s_mov_b64 exec, s[40:41]
    ds_read_b64 v[116:117], v4 offset:1024
    s_mov_b64 exec, -1
    ds_read_b128 v[120:123], v6 offset:1280
    s_mov_b64 exec, s[40:41]
    ds_read_b64 v[124:125], v4 offset:2304
    s_mov_b64 exec, -1
    s_waitcnt lgkmcnt(2)
    v_mfma_f32_32x32x16_bf16 v[32:47], v[112:115], v[8:11], v[16:31]
    v_mfma_f32_32x32x16_bf16 v[32:47], v[116:119], v[12:15], v[32:47]
    s_nop 7
    s_waitcnt lgkmcnt(0)
    s_mov_b64 exec, s[42:43]
    ds_read_b128 v[144:147], v162 offset:0
    ds_read_b128 v[148:151], v162 offset:640
    s_mov_b64 exec, -1
    ds_read_b128 v[112:115], v6 offset:2560
    s_mov_b64 exec, s[40:41]
    ds_read_b64 v[116:117], v4 offset:3584
    s_mov_b64 exec, -1
    v_mfma_f32_32x32x16_bf16 v[48:63], v[120:123], v[8:11], v[16:31]
    v_exp_f32 v32, v32
    v_exp_f32 v33, v33
    v_exp_f32 v34, v34
    v_exp_f32 v35, v35
    v_mfma_f32_32x32x16_bf16 v[48:63], v[124:127], v[12:15], v[48:63]
    v_exp_f32 v36, v36
    v_exp_f32 v37, v37
    v_exp_f32 v38, v38
    v_exp_f32 v39, v39
    v_exp_f32 v40, v40
    v_exp_f32 v41, v41
    v_exp_f32 v42, v42
    v_exp_f32 v43, v43
    v_exp_f32 v44, v44
    v_exp_f32 v45, v45
    v_exp_f32 v46, v46
    v_exp_f32 v47, v47
    v_cvt_pk_bf16_f32 v80, v32, v33
    v_cvt_pk_bf16_f32 v81, v34, v35
    v_cvt_pk_bf16_f32 v82, v36, v37
    v_cvt_pk_bf16_f32 v83, v38, v39
    v_cvt_pk_bf16_f32 v84, v40, v41
    v_cvt_pk_bf16_f32 v85, v42, v43
    v_cvt_pk_bf16_f32 v86, v44, v45
    v_cvt_pk_bf16_f32 v87, v46, v47
    s_waitcnt lgkmcnt(0)
    s_mov_b64 exec, s[42:43]
    ds_read_b128 v[152:155], v162 offset:1280
    ds_read_b128 v[156:159], v162 offset:1920
    s_mov_b64 exec, -1
    ds_read_b128 v[120:123], v6 offset:3840
    s_mov_b64 exec, s[40:41]
    ds_read_b64 v[124:125], v4 offset:4864
    s_mov_b64 exec, -1
    v_mfma_f32_32x32x16_bf16 v[32:47], v[112:115], v[8:11], v[16:31]
    v_exp_f32 v48, v48
    v_exp_f32 v49, v49
    v_exp_f32 v50, v50
    v_exp_f32 v51, v51
    v_mfma_f32_32x32x16_bf16 v[32:47], v[116:119], v[12:15], v[32:47]
    v_exp_f32 v52, v52
    v_exp_f32 v53, v53
    v_exp_f32 v54, v54
    v_exp_f32 v55, v55
    v_mfma_f32_32x32x16_bf16 v[96:111], v[144:147], v[80:83], v[96:111]
    v_exp_f32 v56, v56
    v_exp_f32 v57, v57
    v_exp_f32 v58, v58
    v_exp_f32 v59, v59
    v_mfma_f32_32x32x16_bf16 v[96:111], v[148:151], v[84:87], v[96:111]
    v_exp_f32 v60, v60
    v_exp_f32 v61, v61
    v_exp_f32 v62, v62
    v_exp_f32 v63, v63
    v_cvt_pk_bf16_f32 v88, v48, v49
    v_cvt_pk_bf16_f32 v89, v50, v51
    v_cvt_pk_bf16_f32 v90, v52, v53
    v_cvt_pk_bf16_f32 v91, v54, v55
    v_cvt_pk_bf16_f32 v92, v56, v57
    v_cvt_pk_bf16_f32 v93, v58, v59
    v_cvt_pk_bf16_f32 v94, v60, v61
    v_cvt_pk_bf16_f32 v95, v62, v63
    s_waitcnt lgkmcnt(0)
    s_mov_b64 exec, s[42:43]
    ds_read_b128 v[144:147], v162 offset:2560
    ds_read_b128 v[148:151], v162 offset:3200
    s_mov_b64 exec, -1
    ds_read_b128 v[112:115], v6 offset:5120
    s_mov_b64 exec, s[40:41]
    ds_read_b64 v[116:117], v4 offset:6144
    s_mov_b64 exec, -1
    v_mfma_f32_32x32x16_bf16 v[48:63], v[120:123], v[8:11], v[16:31]
    v_exp_f32 v32, v32
    v_exp_f32 v33, v33
    v_exp_f32 v34, v34
    v_exp_f32 v35, v35
    v_mfma_f32_32x32x16_bf16 v[48:63], v[124:127], v[12:15], v[48:63]
    v_exp_f32 v36, v36
    v_exp_f32 v37, v37
    v_exp_f32 v38, v38
    v_exp_f32 v39, v39
    v_mfma_f32_32x32x16_bf16 v[96:111], v[152:155], v[88:91], v[96:111]
    v_exp_f32 v40, v40
    v_exp_f32 v41, v41
    v_exp_f32 v42, v42
    v_exp_f32 v43, v43
    v_mfma_f32_32x32x16_bf16 v[96:111], v[156:159], v[92:95], v[96:111]
    v_exp_f32 v44, v44
    v_exp_f32 v45, v45
    v_exp_f32 v46, v46
    v_exp_f32 v47, v47
    v_cvt_pk_bf16_f32 v80, v32, v33
    v_cvt_pk_bf16_f32 v81, v34, v35
    v_cvt_pk_bf16_f32 v82, v36, v37
    v_cvt_pk_bf16_f32 v83, v38, v39
    v_cvt_pk_bf16_f32 v84, v40, v41
    v_cvt_pk_bf16_f32 v85, v42, v43
    v_cvt_pk_bf16_f32 v86, v44, v45
    v_cvt_pk_bf16_f32 v87, v46, v47
    s_waitcnt lgkmcnt(0)
    s_mov_b64 exec, s[42:43]
    ds_read_b128 v[152:155], v162 offset:3840
    ds_read_b128 v[156:159], v162 offset:4480
    s_mov_b64 exec, -1
    ds_read_b128 v[120:123], v6 offset:6400
    s_mov_b64 exec, s[40:41]
    ds_read_b64 v[124:125], v4 offset:7424
    s_mov_b64 exec, -1
    v_mfma_f32_32x32x16_bf16 v[32:47], v[112:115], v[8:11], v[16:31]
    v_exp_f32 v48, v48
    v_exp_f32 v49, v49
    v_exp_f32 v50, v50
    v_exp_f32 v51, v51
    v_mfma_f32_32x32x16_bf16 v[32:47], v[116:119], v[12:15], v[32:47]
    v_exp_f32 v52, v52
    v_exp_f32 v53, v53
    v_exp_f32 v54, v54
    v_exp_f32 v55, v55
    v_mfma_f32_32x32x16_bf16 v[96:111], v[144:147], v[80:83], v[96:111]
    v_exp_f32 v56, v56
    v_exp_f32 v57, v57
    v_exp_f32 v58, v58
    v_exp_f32 v59, v59
    v_mfma_f32_32x32x16_bf16 v[96:111], v[148:151], v[84:87], v[96:111]
    v_exp_f32 v60, v60
    v_exp_f32 v61, v61
    v_exp_f32 v62, v62
    v_exp_f32 v63, v63
    v_cvt_pk_bf16_f32 v88, v48, v49
    v_cvt_pk_bf16_f32 v89, v50, v51
    v_cvt_pk_bf16_f32 v90, v52, v53
    v_cvt_pk_bf16_f32 v91, v54, v55
    v_cvt_pk_bf16_f32 v92, v56, v57
    v_cvt_pk_bf16_f32 v93, v58, v59
    v_cvt_pk_bf16_f32 v94, v60, v61
    v_cvt_pk_bf16_f32 v95, v62, v63
    s_waitcnt lgkmcnt(0)
    s_mov_b64 exec, s[42:43]
    ds_read_b128 v[144:147], v162 offset:5120
    ds_read_b128 v[148:151], v162 offset:5760
    s_mov_b64 exec, -1
    ds_read_b128 v[112:115], v6 offset:7680
    s_mov_b64 exec, s[40:41]
    ds_read_b64 v[116:117], v4 offset:8704
    s_mov_b64 exec, -1
    v_mfma_f32_32x32x16_bf16 v[48:63], v[120:123], v[8:11], v[16:31]
    v_exp_f32 v32, v32
    v_exp_f32 v33, v33
    v_exp_f32 v34, v34
    v_exp_f32 v35, v35
    v_mfma_f32_32x32x16_bf16 v[48:63], v[124:127], v[12:15], v[48:63]
    v_exp_f32 v36, v36
    v_exp_f32 v37, v37
    v_exp_f32 v38, v38
    v_exp_f32 v39, v39
    v_mfma_f32_32x32x16_bf16 v[96:111], v[152:155], v[88:91], v[96:111]
    v_exp_f32 v40, v40
    v_exp_f32 v41, v41
    v_exp_f32 v42, v42
    v_exp_f32 v43, v43
    v_mfma_f32_32x32x16_bf16 v[96:111], v[156:159], v[92:95], v[96:111]
    v_exp_f32 v44, v44
    v_exp_f32 v45, v45
    v_exp_f32 v46, v46
    v_exp_f32 v47, v47
    v_cvt_pk_bf16_f32 v80, v32, v33
    v_cvt_pk_bf16_f32 v81, v34, v35
    v_cvt_pk_bf16_f32 v82, v36, v37
    v_cvt_pk_bf16_f32 v83, v38, v39
    v_cvt_pk_bf16_f32 v84, v40, v41
    v_cvt_pk_bf16_f32 v85, v42, v43
    v_cvt_pk_bf16_f32 v86, v44, v45
    v_cvt_pk_bf16_f32 v87, v46, v47
    s_waitcnt lgkmcnt(0)
    s_mov_b64 exec, s[42:43]
    ds_read_b128 v[152:155], v162 offset:6400
    ds_read_b128 v[156:159], v162 offset:7040
    s_mov_b64 exec, -1
    ds_read_b128 v[120:123], v6 offset:8960
    s_mov_b64 exec, s[40:41]
    ds_read_b64 v[124:125], v4 offset:9984
    s_mov_b64 exec, -1
    v_mfma_f32_32x32x16_bf16 v[32:47], v[112:115], v[8:11], v[16:31]
    v_exp_f32 v48, v48
    v_exp_f32 v49, v49
    v_exp_f32 v50, v50
    v_exp_f32 v51, v51
    v_mfma_f32_32x32x16_bf16 v[32:47], v[116:119], v[12:15], v[32:47]
    v_exp_f32 v52, v52
    v_exp_f32 v53, v53
    v_exp_f32 v54, v54
    v_exp_f32 v55, v55
    v_mfma_f32_32x32x16_bf16 v[96:111], v[144:147], v[80:83], v[96:111]
    v_exp_f32 v56, v56
    v_exp_f32 v57, v57
    v_exp_f32 v58, v58
    v_exp_f32 v59, v59
    v_mfma_f32_32x32x16_bf16 v[96:111], v[148:151], v[84:87], v[96:111]
    v_exp_f32 v60, v60
    v_exp_f32 v61, v61
    v_exp_f32 v62, v62
    v_exp_f32 v63, v63
    v_cvt_pk_bf16_f32 v88, v48, v49
    v_cvt_pk_bf16_f32 v89, v50, v51
    v_cvt_pk_bf16_f32 v90, v52, v53
    v_cvt_pk_bf16_f32 v91, v54, v55
    v_cvt_pk_bf16_f32 v92, v56, v57
    v_cvt_pk_bf16_f32 v93, v58, v59
    v_cvt_pk_bf16_f32 v94, v60, v61
    v_cvt_pk_bf16_f32 v95, v62, v63
    s_waitcnt lgkmcnt(0)
    s_mov_b64 exec, s[42:43]
    ds_read_b128 v[144:147], v162 offset:7680
    ds_read_b128 v[148:151], v162 offset:8320
    s_mov_b64 exec, -1
    ds_read_b128 v[112:115], v6 offset:10240
    s_mov_b64 exec, s[40:41]
    ds_read_b64 v[116:117], v4 offset:11264
    s_mov_b64 exec, -1
    v_mfma_f32_32x32x16_bf16 v[48:63], v[120:123], v[8:11], v[16:31]
    v_exp_f32 v32, v32
    v_exp_f32 v33, v33
    v_exp_f32 v34, v34
    v_exp_f32 v35, v35
    v_mfma_f32_32x32x16_bf16 v[48:63], v[124:127], v[12:15], v[48:63]
    v_exp_f32 v36, v36
    v_exp_f32 v37, v37
    v_exp_f32 v38, v38
    v_exp_f32 v39, v39
    v_mfma_f32_32x32x16_bf16 v[96:111], v[152:155], v[88:91], v[96:111]
    v_exp_f32 v40, v40
    v_exp_f32 v41, v41
    v_exp_f32 v42, v42
    v_exp_f32 v43, v43
    v_mfma_f32_32x32x16_bf16 v[96:111], v[156:159], v[92:95], v[96:111]
    v_exp_f32 v44, v44
    v_exp_f32 v45, v45
    v_exp_f32 v46, v46
    v_exp_f32 v47, v47
    v_cvt_pk_bf16_f32 v80, v32, v33
    v_cvt_pk_bf16_f32 v81, v34, v35
    v_cvt_pk_bf16_f32 v82, v36, v37
    v_cvt_pk_bf16_f32 v83, v38, v39
    v_cvt_pk_bf16_f32 v84, v40, v41
    v_cvt_pk_bf16_f32 v85, v42, v43
    v_cvt_pk_bf16_f32 v86, v44, v45
    v_cvt_pk_bf16_f32 v87, v46, v47
    s_waitcnt lgkmcnt(0)
    s_mov_b64 exec, s[42:43]
    ds_read_b128 v[152:155], v162 offset:8960
    ds_read_b128 v[156:159], v162 offset:9600
    s_mov_b64 exec, -1
    ds_read_b128 v[120:123], v6 offset:11520
    s_mov_b64 exec, s[40:41]
    ds_read_b64 v[124:125], v4 offset:12544
    s_mov_b64 exec, -1
    v_mfma_f32_32x32x16_bf16 v[32:47], v[112:115], v[8:11], v[16:31]
    v_exp_f32 v48, v48
    v_exp_f32 v49, v49
    v_exp_f32 v50, v50
    v_exp_f32 v51, v51
    v_mfma_f32_32x32x16_bf16 v[32:47], v[116:119], v[12:15], v[32:47]
    v_exp_f32 v52, v52
    v_exp_f32 v53, v53
    v_exp_f32 v54, v54
    v_exp_f32 v55, v55
    v_mfma_f32_32x32x16_bf16 v[96:111], v[144:147], v[80:83], v[96:111]
    v_exp_f32 v56, v56
    v_exp_f32 v57, v57
    v_exp_f32 v58, v58
    v_exp_f32 v59, v59
    v_mfma_f32_32x32x16_bf16 v[96:111], v[148:151], v[84:87], v[96:111]
    v_exp_f32 v60, v60
    v_exp_f32 v61, v61
    v_exp_f32 v62, v62
    v_exp_f32 v63, v63
    v_cvt_pk_bf16_f32 v88, v48, v49
    v_cvt_pk_bf16_f32 v89, v50, v51
    v_cvt_pk_bf16_f32 v90, v52, v53
    v_cvt_pk_bf16_f32 v91, v54, v55
    v_cvt_pk_bf16_f32 v92, v56, v57
    v_cvt_pk_bf16_f32 v93, v58, v59
    v_cvt_pk_bf16_f32 v94, v60, v61
    v_cvt_pk_bf16_f32 v95, v62, v63
    s_waitcnt lgkmcnt(0)
    s_mov_b64 exec, s[42:43]
    ds_read_b128 v[144:147], v162 offset:10240
    ds_read_b128 v[148:151], v162 offset:10880
    s_mov_b64 exec, -1
    ds_read_b128 v[112:115], v6 offset:12800
    s_mov_b64 exec, s[40:41]
    ds_read_b64 v[116:117], v4 offset:13824
    s_mov_b64 exec, -1
    v_mfma_f32_32x32x16_bf16 v[48:63], v[120:123], v[8:11], v[16:31]
    v_exp_f32 v32, v32
    v_exp_f32 v33, v33
    v_exp_f32 v34, v34
    v_exp_f32 v35, v35
    v_mfma_f32_32x32x16_bf16 v[48:63], v[124:127], v[12:15], v[48:63]
    v_exp_f32 v36, v36
    v_exp_f32 v37, v37
    v_exp_f32 v38, v38
    v_exp_f32 v39, v39
    v_mfma_f32_32x32x16_bf16 v[96:111], v[152:155], v[88:91], v[96:111]
    v_exp_f32 v40, v40
    v_exp_f32 v41, v41
    v_exp_f32 v42, v42
    v_exp_f32 v43, v43
    v_mfma_f32_32x32x16_bf16 v[96:111], v[156:159], v[92:95], v[96:111]
    v_exp_f32 v44, v44
    v_exp_f32 v45, v45
    v_exp_f32 v46, v46
    v_exp_f32 v47, v47
    v_cvt_pk_bf16_f32 v80, v32, v33
    v_cvt_pk_bf16_f32 v81, v34, v35
    v_cvt_pk_bf16_f32 v82, v36, v37
    v_cvt_pk_bf16_f32 v83, v38, v39
    v_cvt_pk_bf16_f32 v84, v40, v41
    v_cvt_pk_bf16_f32 v85, v42, v43
    v_cvt_pk_bf16_f32 v86, v44, v45
    v_cvt_pk_bf16_f32 v87, v46, v47
    s_waitcnt lgkmcnt(0)
    s_mov_b64 exec, s[42:43]
    ds_read_b128 v[152:155], v162 offset:11520
    ds_read_b128 v[156:159], v162 offset:12160
    s_mov_b64 exec, -1
    ds_read_b128 v[120:123], v6 offset:14080
    s_mov_b64 exec, s[40:41]
    ds_read_b64 v[124:125], v4 offset:15104
    s_mov_b64 exec, -1
    v_mfma_f32_32x32x16_bf16 v[32:47], v[112:115], v[8:11], v[16:31]
    v_exp_f32 v48, v48
    v_exp_f32 v49, v49
    v_exp_f32 v50, v50
    v_exp_f32 v51, v51
    v_mfma_f32_32x32x16_bf16 v[32:47], v[116:119], v[12:15], v[32:47]
    v_exp_f32 v52, v52
    v_exp_f32 v53, v53
    v_exp_f32 v54, v54
    v_exp_f32 v55, v55
    v_mfma_f32_32x32x16_bf16 v[96:111], v[144:147], v[80:83], v[96:111]
    v_exp_f32 v56, v56
    v_exp_f32 v57, v57
    v_exp_f32 v58, v58
    v_exp_f32 v59, v59
    v_mfma_f32_32x32x16_bf16 v[96:111], v[148:151], v[84:87], v[96:111]
    v_exp_f32 v60, v60
    v_exp_f32 v61, v61
    v_exp_f32 v62, v62
    v_exp_f32 v63, v63
    v_cvt_pk_bf16_f32 v88, v48, v49
    v_cvt_pk_bf16_f32 v89, v50, v51
    v_cvt_pk_bf16_f32 v90, v52, v53
    v_cvt_pk_bf16_f32 v91, v54, v55
    v_cvt_pk_bf16_f32 v92, v56, v57
    v_cvt_pk_bf16_f32 v93, v58, v59
    v_cvt_pk_bf16_f32 v94, v60, v61
    v_cvt_pk_bf16_f32 v95, v62, v63
    s_waitcnt lgkmcnt(0)
    s_mov_b64 exec, s[42:43]
    ds_read_b128 v[144:147], v162 offset:12800
    ds_read_b128 v[148:151], v162 offset:13440
    s_mov_b64 exec, -1
    ds_read_b128 v[112:115], v6 offset:15360
    s_mov_b64 exec, s[40:41]
    ds_read_b64 v[116:117], v4 offset:16384
    s_mov_b64 exec, -1
    v_mfma_f32_32x32x16_bf16 v[48:63], v[120:123], v[8:11], v[16:31]
    v_exp_f32 v32, v32
    v_exp_f32 v33, v33
    v_exp_f32 v34, v34
    v_exp_f32 v35, v35
    v_mfma_f32_32x32x16_bf16 v[48:63], v[124:127], v[12:15], v[48:63]
    v_exp_f32 v36, v36
    v_exp_f32 v37, v37
    v_exp_f32 v38, v38
    v_exp_f32 v39, v39
    v_mfma_f32_32x32x16_bf16 v[96:111], v[152:155], v[88:91], v[96:111]
    v_exp_f32 v40, v40
    v_exp_f32 v41, v41
    v_exp_f32 v42, v42
    v_exp_f32 v43, v43
    v_mfma_f32_32x32x16_bf16 v[96:111], v[156:159], v[92:95], v[96:111]
    v_exp_f32 v44, v44
    v_exp_f32 v45, v45
    v_exp_f32 v46, v46
    v_exp_f32 v47, v47
    v_cvt_pk_bf16_f32 v80, v32, v33
    v_cvt_pk_bf16_f32 v81, v34, v35
    v_cvt_pk_bf16_f32 v82, v36, v37
    v_cvt_pk_bf16_f32 v83, v38, v39
    v_cvt_pk_bf16_f32 v84, v40, v41
    v_cvt_pk_bf16_f32 v85, v42, v43
    v_cvt_pk_bf16_f32 v86, v44, v45
    v_cvt_pk_bf16_f32 v87, v46, v47
    s_waitcnt lgkmcnt(0)
    s_mov_b64 exec, s[42:43]
    ds_read_b128 v[152:155], v162 offset:14080
    ds_read_b128 v[156:159], v162 offset:14720
    s_mov_b64 exec, -1
    ds_read_b128 v[120:123], v6 offset:16640
    s_mov_b64 exec, s[40:41]
    ds_read_b64 v[124:125], v4 offset:17664
    s_mov_b64 exec, -1
    v_mfma_f32_32x32x16_bf16 v[32:47], v[112:115], v[8:11], v[16:31]
    v_exp_f32 v48, v48
    v_exp_f32 v49, v49
    v_exp_f32 v50, v50
    v_exp_f32 v51, v51
    v_mfma_f32_32x32x16_bf16 v[32:47], v[116:119], v[12:15], v[32:47]
    v_exp_f32 v52, v52
    v_exp_f32 v53, v53
    v_exp_f32 v54, v54
    v_exp_f32 v55, v55
    v_mfma_f32_32x32x16_bf16 v[96:111], v[144:147], v[80:83], v[96:111]
    v_exp_f32 v56, v56
    v_exp_f32 v57, v57
    v_exp_f32 v58, v58
    v_exp_f32 v59, v59
    v_mfma_f32_32x32x16_bf16 v[96:111], v[148:151], v[84:87], v[96:111]
    v_exp_f32 v60, v60
    v_exp_f32 v61, v61
    v_exp_f32 v62, v62
    v_exp_f32 v63, v63
    v_cvt_pk_bf16_f32 v88, v48, v49
    v_cvt_pk_bf16_f32 v89, v50, v51
    v_cvt_pk_bf16_f32 v90, v52, v53
    v_cvt_pk_bf16_f32 v91, v54, v55
    v_cvt_pk_bf16_f32 v92, v56, v57
    v_cvt_pk_bf16_f32 v93, v58, v59
    v_cvt_pk_bf16_f32 v94, v60, v61
    v_cvt_pk_bf16_f32 v95, v62, v63
    s_waitcnt lgkmcnt(0)
    s_mov_b64 exec, s[42:43]
    ds_read_b128 v[144:147], v162 offset:15360
    ds_read_b128 v[148:151], v162 offset:16000
    s_mov_b64 exec, -1
    ds_read_b128 v[112:115], v6 offset:17920
    s_mov_b64 exec, s[40:41]
    ds_read_b64 v[116:117], v4 offset:18944
    s_mov_b64 exec, -1
    v_mfma_f32_32x32x16_bf16 v[48:63], v[120:123], v[8:11], v[16:31]
    v_exp_f32 v32, v32
    v_exp_f32 v33, v33
    v_exp_f32 v34, v34
    v_exp_f32 v35, v35
    v_mfma_f32_32x32x16_bf16 v[48:63], v[124:127], v[12:15], v[48:63]
    v_exp_f32 v36, v36
    v_exp_f32 v37, v37
    v_exp_f32 v38, v38
    v_exp_f32 v39, v39
    v_mfma_f32_32x32x16_bf16 v[96:111], v[152:155], v[88:91], v[96:111]
    v_exp_f32 v40, v40
    v_exp_f32 v41, v41
    v_exp_f32 v42, v42
    v_exp_f32 v43, v43
    v_mfma_f32_32x32x16_bf16 v[96:111], v[156:159], v[92:95], v[96:111]
    v_exp_f32 v44, v44
    v_exp_f32 v45, v45
    v_exp_f32 v46, v46
    v_exp_f32 v47, v47
    v_cvt_pk_bf16_f32 v80, v32, v33
    v_cvt_pk_bf16_f32 v81, v34, v35
    v_cvt_pk_bf16_f32 v82, v36, v37
    v_cvt_pk_bf16_f32 v83, v38, v39
    v_cvt_pk_bf16_f32 v84, v40, v41
    v_cvt_pk_bf16_f32 v85, v42, v43
    v_cvt_pk_bf16_f32 v86, v44, v45
    v_cvt_pk_bf16_f32 v87, v46, v47
    s_waitcnt lgkmcnt(0)
    s_mov_b64 exec, s[42:43]
    ds_read_b128 v[152:155], v162 offset:16640
    ds_read_b128 v[156:159], v162 offset:17280
    s_mov_b64 exec, -1
    ds_read_b128 v[120:123], v6 offset:19200
    s_mov_b64 exec, s[40:41]
    ds_read_b64 v[124:125], v4 offset:20224
    s_mov_b64 exec, -1
    v_mfma_f32_32x32x16_bf16 v[32:47], v[112:115], v[8:11], v[16:31]
    v_exp_f32 v48, v48
    v_exp_f32 v49, v49
    v_exp_f32 v50, v50
    v_exp_f32 v51, v51
    v_mfma_f32_32x32x16_bf16 v[32:47], v[116:119], v[12:15], v[32:47]
    v_exp_f32 v52, v52
    v_exp_f32 v53, v53
    v_exp_f32 v54, v54
    v_exp_f32 v55, v55
    v_mfma_f32_32x32x16_bf16 v[96:111], v[144:147], v[80:83], v[96:111]
    v_exp_f32 v56, v56
    v_exp_f32 v57, v57
    v_exp_f32 v58, v58
    v_exp_f32 v59, v59
    v_mfma_f32_32x32x16_bf16 v[96:111], v[148:151], v[84:87], v[96:111]
    v_exp_f32 v60, v60
    v_exp_f32 v61, v61
    v_exp_f32 v62, v62
    v_exp_f32 v63, v63
    v_cvt_pk_bf16_f32 v88, v48, v49
    v_cvt_pk_bf16_f32 v89, v50, v51
    v_cvt_pk_bf16_f32 v90, v52, v53
    v_cvt_pk_bf16_f32 v91, v54, v55
    v_cvt_pk_bf16_f32 v92, v56, v57
    v_cvt_pk_bf16_f32 v93, v58, v59
    v_cvt_pk_bf16_f32 v94, v60, v61
    v_cvt_pk_bf16_f32 v95, v62, v63
    s_waitcnt lgkmcnt(0)
    s_mov_b64 exec, s[42:43]
    ds_read_b128 v[144:147], v162 offset:17920
    ds_read_b128 v[148:151], v162 offset:18560
    s_mov_b64 exec, -1
    ds_read_b128 v[112:115], v6 offset:20480
    s_mov_b64 exec, s[40:41]
    ds_read_b64 v[116:117], v4 offset:21504
    s_mov_b64 exec, -1
    v_mfma_f32_32x32x16_bf16 v[48:63], v[120:123], v[8:11], v[16:31]
    v_exp_f32 v32, v32
    v_exp_f32 v33, v33
    v_exp_f32 v34, v34
    v_exp_f32 v35, v35
    v_mfma_f32_32x32x16_bf16 v[48:63], v[124:127], v[12:15], v[48:63]
    v_exp_f32 v36, v36
    v_exp_f32 v37, v37
    v_exp_f32 v38, v38
    v_exp_f32 v39, v39
    v_mfma_f32_32x32x16_bf16 v[96:111], v[152:155], v[88:91], v[96:111]
    v_exp_f32 v40, v40
    v_exp_f32 v41, v41
    v_exp_f32 v42, v42
    v_exp_f32 v43, v43
    v_mfma_f32_32x32x16_bf16 v[96:111], v[156:159], v[92:95], v[96:111]
    v_exp_f32 v44, v44
    v_exp_f32 v45, v45
    v_exp_f32 v46, v46
    v_exp_f32 v47, v47
    v_cvt_pk_bf16_f32 v80, v32, v33
    v_cvt_pk_bf16_f32 v81, v34, v35
    v_cvt_pk_bf16_f32 v82, v36, v37
    v_cvt_pk_bf16_f32 v83, v38, v39
    v_cvt_pk_bf16_f32 v84, v40, v41
    v_cvt_pk_bf16_f32 v85, v42, v43
    v_cvt_pk_bf16_f32 v86, v44, v45
    v_cvt_pk_bf16_f32 v87, v46, v47
    s_waitcnt lgkmcnt(0)
    s_mov_b64 exec, s[42:43]
    ds_read_b128 v[152:155], v162 offset:19200
    ds_read_b128 v[156:159], v162 offset:19840
    s_mov_b64 exec, -1
    ds_read_b128 v[120:123], v6 offset:21760
    s_mov_b64 exec, s[40:41]
    ds_read_b64 v[124:125], v4 offset:22784
    s_mov_b64 exec, -1
    v_mfma_f32_32x32x16_bf16 v[32:47], v[112:115], v[8:11], v[16:31]
    v_exp_f32 v48, v48
    v_exp_f32 v49, v49
    v_exp_f32 v50, v50
    v_exp_f32 v51, v51
    v_mfma_f32_32x32x16_bf16 v[32:47], v[116:119], v[12:15], v[32:47]
    v_exp_f32 v52, v52
    v_exp_f32 v53, v53
    v_exp_f32 v54, v54
    v_exp_f32 v55, v55
    v_mfma_f32_32x32x16_bf16 v[96:111], v[144:147], v[80:83], v[96:111]
    v_exp_f32 v56, v56
    v_exp_f32 v57, v57
    v_exp_f32 v58, v58
    v_exp_f32 v59, v59
    v_mfma_f32_32x32x16_bf16 v[96:111], v[148:151], v[84:87], v[96:111]
    v_exp_f32 v60, v60
    v_exp_f32 v61, v61
    v_exp_f32 v62, v62
    v_exp_f32 v63, v63
    v_cvt_pk_bf16_f32 v88, v48, v49
    v_cvt_pk_bf16_f32 v89, v50, v51
    v_cvt_pk_bf16_f32 v90, v52, v53
    v_cvt_pk_bf16_f32 v91, v54, v55
    v_cvt_pk_bf16_f32 v92, v56, v57
    v_cvt_pk_bf16_f32 v93, v58, v59
    v_cvt_pk_bf16_f32 v94, v60, v61
    v_cvt_pk_bf16_f32 v95, v62, v63
    s_waitcnt lgkmcnt(0)
    s_mov_b64 exec, s[42:43]
    ds_read_b128 v[144:147], v162 offset:20480
    ds_read_b128 v[148:151], v162 offset:21120
    s_mov_b64 exec, -1
    ds_read_b128 v[112:115], v6 offset:23040
    s_mov_b64 exec, s[40:41]
    ds_read_b64 v[116:117], v4 offset:24064
    s_mov_b64 exec, -1
    v_mfma_f32_32x32x16_bf16 v[48:63], v[120:123], v[8:11], v[16:31]
    v_exp_f32 v32, v32
    v_exp_f32 v33, v33
    v_exp_f32 v34, v34
    v_exp_f32 v35, v35
    v_mfma_f32_32x32x16_bf16 v[48:63], v[124:127], v[12:15], v[48:63]
    v_exp_f32 v36, v36
    v_exp_f32 v37, v37
    v_exp_f32 v38, v38
    v_exp_f32 v39, v39
    v_mfma_f32_32x32x16_bf16 v[96:111], v[152:155], v[88:91], v[96:111]
    v_exp_f32 v40, v40
    v_exp_f32 v41, v41
    v_exp_f32 v42, v42
    v_exp_f32 v43, v43
    v_mfma_f32_32x32x16_bf16 v[96:111], v[156:159], v[92:95], v[96:111]
    v_exp_f32 v44, v44
    v_exp_f32 v45, v45
    v_exp_f32 v46, v46
    v_exp_f32 v47, v47
    v_cvt_pk_bf16_f32 v80, v32, v33
    v_cvt_pk_bf16_f32 v81, v34, v35
    v_cvt_pk_bf16_f32 v82, v36, v37
    v_cvt_pk_bf16_f32 v83, v38, v39
    v_cvt_pk_bf16_f32 v84, v40, v41
    v_cvt_pk_bf16_f32 v85, v42, v43
    v_cvt_pk_bf16_f32 v86, v44, v45
    v_cvt_pk_bf16_f32 v87, v46, v47
    s_waitcnt lgkmcnt(0)
    s_mov_b64 exec, s[42:43]
    ds_read_b128 v[152:155], v162 offset:21760
    ds_read_b128 v[156:159], v162 offset:22400
    s_mov_b64 exec, -1
    ds_read_b128 v[120:123], v6 offset:24320
    s_mov_b64 exec, s[40:41]
    ds_read_b64 v[124:125], v4 offset:25344
    s_mov_b64 exec, -1
    v_mfma_f32_32x32x16_bf16 v[32:47], v[112:115], v[8:11], v[16:31]
    v_exp_f32 v48, v48
    v_exp_f32 v49, v49
    v_exp_f32 v50, v50
    v_exp_f32 v51, v51
    v_mfma_f32_32x32x16_bf16 v[32:47], v[116:119], v[12:15], v[32:47]
    v_exp_f32 v52, v52
    v_exp_f32 v53, v53
    v_exp_f32 v54, v54
    v_exp_f32 v55, v55
    v_mfma_f32_32x32x16_bf16 v[96:111], v[144:147], v[80:83], v[96:111]
    v_exp_f32 v56, v56
    v_exp_f32 v57, v57
    v_exp_f32 v58, v58
    v_exp_f32 v59, v59
    v_mfma_f32_32x32x16_bf16 v[96:111], v[148:151], v[84:87], v[96:111]
    v_exp_f32 v60, v60
    v_exp_f32 v61, v61
    v_exp_f32 v62, v62
    v_exp_f32 v63, v63
    v_cvt_pk_bf16_f32 v88, v48, v49
    v_cvt_pk_bf16_f32 v89, v50, v51
    v_cvt_pk_bf16_f32 v90, v52, v53
    v_cvt_pk_bf16_f32 v91, v54, v55
    v_cvt_pk_bf16_f32 v92, v56, v57
    v_cvt_pk_bf16_f32 v93, v58, v59
    v_cvt_pk_bf16_f32 v94, v60, v61
    v_cvt_pk_bf16_f32 v95, v62, v63
    s_waitcnt lgkmcnt(0)
    s_mov_b64 exec, s[42:43]
    ds_read_b128 v[144:147], v162 offset:23040
    ds_read_b128 v[148:151], v162 offset:23680
    s_mov_b64 exec, -1
    ds_read_b128 v[112:115], v6 offset:25600
    s_mov_b64 exec, s[40:41]
    ds_read_b64 v[116:117], v4 offset:26624
    s_mov_b64 exec, -1
    v_mfma_f32_32x32x16_bf16 v[48:63], v[120:123], v[8:11], v[16:31]
    v_exp_f32 v32, v32
    v_exp_f32 v33, v33
    v_exp_f32 v34, v34
    v_exp_f32 v35, v35
    v_mfma_f32_32x32x16_bf16 v[48:63], v[124:127], v[12:15], v[48:63]
    v_exp_f32 v36, v36
    v_exp_f32 v37, v37
    v_exp_f32 v38, v38
    v_exp_f32 v39, v39
    v_mfma_f32_32x32x16_bf16 v[96:111], v[152:155], v[88:91], v[96:111]
    v_exp_f32 v40, v40
    v_exp_f32 v41, v41
    v_exp_f32 v42, v42
    v_exp_f32 v43, v43
    v_mfma_f32_32x32x16_bf16 v[96:111], v[156:159], v[92:95], v[96:111]
    v_exp_f32 v44, v44
    v_exp_f32 v45, v45
    v_exp_f32 v46, v46
    v_exp_f32 v47, v47
    v_cvt_pk_bf16_f32 v80, v32, v33
    v_cvt_pk_bf16_f32 v81, v34, v35
    v_cvt_pk_bf16_f32 v82, v36, v37
    v_cvt_pk_bf16_f32 v83, v38, v39
    v_cvt_pk_bf16_f32 v84, v40, v41
    v_cvt_pk_bf16_f32 v85, v42, v43
    v_cvt_pk_bf16_f32 v86, v44, v45
    v_cvt_pk_bf16_f32 v87, v46, v47
    s_waitcnt lgkmcnt(0)
    s_mov_b64 exec, s[42:43]
    ds_read_b128 v[152:155], v162 offset:24320
    ds_read_b128 v[156:159], v162 offset:24960
    s_mov_b64 exec, -1
    ds_read_b128 v[120:123], v6 offset:26880
    s_mov_b64 exec, s[40:41]
    ds_read_b64 v[124:125], v4 offset:27904
    s_mov_b64 exec, -1
    v_mfma_f32_32x32x16_bf16 v[32:47], v[112:115], v[8:11], v[16:31]
    v_exp_f32 v48, v48
    v_exp_f32 v49, v49
    v_exp_f32 v50, v50
    v_exp_f32 v51, v51
    v_mfma_f32_32x32x16_bf16 v[32:47], v[116:119], v[12:15], v[32:47]
    v_exp_f32 v52, v52
    v_exp_f32 v53, v53
    v_exp_f32 v54, v54
    v_exp_f32 v55, v55
    v_mfma_f32_32x32x16_bf16 v[96:111], v[144:147], v[80:83], v[96:111]
    v_exp_f32 v56, v56
    v_exp_f32 v57, v57
    v_exp_f32 v58, v58
    v_exp_f32 v59, v59
    v_mfma_f32_32x32x16_bf16 v[96:111], v[148:151], v[84:87], v[96:111]
    v_exp_f32 v60, v60
    v_exp_f32 v61, v61
    v_exp_f32 v62, v62
    v_exp_f32 v63, v63
    v_cvt_pk_bf16_f32 v88, v48, v49
    v_cvt_pk_bf16_f32 v89, v50, v51
    v_cvt_pk_bf16_f32 v90, v52, v53
    v_cvt_pk_bf16_f32 v91, v54, v55
    v_cvt_pk_bf16_f32 v92, v56, v57
    v_cvt_pk_bf16_f32 v93, v58, v59
    v_cvt_pk_bf16_f32 v94, v60, v61
    v_cvt_pk_bf16_f32 v95, v62, v63
    s_waitcnt lgkmcnt(0)
    s_mov_b64 exec, s[42:43]
    ds_read_b128 v[144:147], v162 offset:25600
    ds_read_b128 v[148:151], v162 offset:26240
    s_mov_b64 exec, -1
    ds_read_b128 v[112:115], v6 offset:28160
    s_mov_b64 exec, s[40:41]
    ds_read_b64 v[116:117], v4 offset:29184
    s_mov_b64 exec, -1
    v_mfma_f32_32x32x16_bf16 v[48:63], v[120:123], v[8:11], v[16:31]
    v_exp_f32 v32, v32
    v_exp_f32 v33, v33
    v_exp_f32 v34, v34
    v_exp_f32 v35, v35
    v_mfma_f32_32x32x16_bf16 v[48:63], v[124:127], v[12:15], v[48:63]
    v_exp_f32 v36, v36
    v_exp_f32 v37, v37
    v_exp_f32 v38, v38
    v_exp_f32 v39, v39
    v_mfma_f32_32x32x16_bf16 v[96:111], v[152:155], v[88:91], v[96:111]
    v_exp_f32 v40, v40
    v_exp_f32 v41, v41
    v_exp_f32 v42, v42
    v_exp_f32 v43, v43
    v_mfma_f32_32x32x16_bf16 v[96:111], v[156:159], v[92:95], v[96:111]
    v_exp_f32 v44, v44
    v_exp_f32 v45, v45
    v_exp_f32 v46, v46
    v_exp_f32 v47, v47
    v_cvt_pk_bf16_f32 v80, v32, v33
    v_cvt_pk_bf16_f32 v81, v34, v35
    v_cvt_pk_bf16_f32 v82, v36, v37
    v_cvt_pk_bf16_f32 v83, v38, v39
    v_cvt_pk_bf16_f32 v84, v40, v41
    v_cvt_pk_bf16_f32 v85, v42, v43
    v_cvt_pk_bf16_f32 v86, v44, v45
    v_cvt_pk_bf16_f32 v87, v46, v47
    s_waitcnt lgkmcnt(0)
    s_mov_b64 exec, s[42:43]
    ds_read_b128 v[152:155], v162 offset:26880
    ds_read_b128 v[156:159], v162 offset:27520
    s_mov_b64 exec, -1
    ds_read_b128 v[120:123], v6 offset:29440
    s_mov_b64 exec, s[40:41]
    ds_read_b64 v[124:125], v4 offset:30464
    s_mov_b64 exec, -1
    v_mfma_f32_32x32x16_bf16 v[32:47], v[112:115], v[8:11], v[16:31]
    v_exp_f32 v48, v48
    v_exp_f32 v49, v49
    v_exp_f32 v50, v50
    v_exp_f32 v51, v51
    v_mfma_f32_32x32x16_bf16 v[32:47], v[116:119], v[12:15], v[32:47]
    v_exp_f32 v52, v52
    v_exp_f32 v53, v53
    v_exp_f32 v54, v54
    v_exp_f32 v55, v55
    v_mfma_f32_32x32x16_bf16 v[96:111], v[144:147], v[80:83], v[96:111]
    v_exp_f32 v56, v56
    v_exp_f32 v57, v57
    v_exp_f32 v58, v58
    v_exp_f32 v59, v59
    v_mfma_f32_32x32x16_bf16 v[96:111], v[148:151], v[84:87], v[96:111]
    v_exp_f32 v60, v60
    v_exp_f32 v61, v61
    v_exp_f32 v62, v62
    v_exp_f32 v63, v63
    v_cvt_pk_bf16_f32 v88, v48, v49
    v_cvt_pk_bf16_f32 v89, v50, v51
    v_cvt_pk_bf16_f32 v90, v52, v53
    v_cvt_pk_bf16_f32 v91, v54, v55
    v_cvt_pk_bf16_f32 v92, v56, v57
    v_cvt_pk_bf16_f32 v93, v58, v59
    v_cvt_pk_bf16_f32 v94, v60, v61
    v_cvt_pk_bf16_f32 v95, v62, v63
    s_waitcnt lgkmcnt(0)
    s_mov_b64 exec, s[42:43]
    ds_read_b128 v[144:147], v162 offset:28160
    ds_read_b128 v[148:151], v162 offset:28800
    s_mov_b64 exec, -1
    ds_read_b128 v[112:115], v6 offset:30720
    s_mov_b64 exec, s[40:41]
    ds_read_b64 v[116:117], v4 offset:31744
    s_mov_b64 exec, -1
    v_mfma_f32_32x32x16_bf16 v[48:63], v[120:123], v[8:11], v[16:31]
    v_exp_f32 v32, v32
    v_exp_f32 v33, v33
    v_exp_f32 v34, v34
    v_exp_f32 v35, v35
    v_mfma_f32_32x32x16_bf16 v[48:63], v[124:127], v[12:15], v[48:63]
    v_exp_f32 v36, v36
    v_exp_f32 v37, v37
    v_exp_f32 v38, v38
    v_exp_f32 v39, v39
    v_mfma_f32_32x32x16_bf16 v[96:111], v[152:155], v[88:91], v[96:111]
    v_exp_f32 v40, v40
    v_exp_f32 v41, v41
    v_exp_f32 v42, v42
    v_exp_f32 v43, v43
    v_mfma_f32_32x32x16_bf16 v[96:111], v[156:159], v[92:95], v[96:111]
    v_exp_f32 v44, v44
    v_exp_f32 v45, v45
    v_exp_f32 v46, v46
    v_exp_f32 v47, v47
    v_cvt_pk_bf16_f32 v80, v32, v33
    v_cvt_pk_bf16_f32 v81, v34, v35
    v_cvt_pk_bf16_f32 v82, v36, v37
    v_cvt_pk_bf16_f32 v83, v38, v39
    v_cvt_pk_bf16_f32 v84, v40, v41
    v_cvt_pk_bf16_f32 v85, v42, v43
    v_cvt_pk_bf16_f32 v86, v44, v45
    v_cvt_pk_bf16_f32 v87, v46, v47
    s_waitcnt lgkmcnt(0)
    s_mov_b64 exec, s[42:43]
    ds_read_b128 v[152:155], v162 offset:29440
    ds_read_b128 v[156:159], v162 offset:30080
    s_mov_b64 exec, -1
    ds_read_b128 v[120:123], v6 offset:32000
    s_mov_b64 exec, s[40:41]
    ds_read_b64 v[124:125], v4 offset:33024
    s_mov_b64 exec, -1
    v_mfma_f32_32x32x16_bf16 v[32:47], v[112:115], v[8:11], v[16:31]
    v_exp_f32 v48, v48
    v_exp_f32 v49, v49
    v_exp_f32 v50, v50
    v_exp_f32 v51, v51
    v_mfma_f32_32x32x16_bf16 v[32:47], v[116:119], v[12:15], v[32:47]
    v_exp_f32 v52, v52
    v_exp_f32 v53, v53
    v_exp_f32 v54, v54
    v_exp_f32 v55, v55
    v_mfma_f32_32x32x16_bf16 v[96:111], v[144:147], v[80:83], v[96:111]
    v_exp_f32 v56, v56
    v_exp_f32 v57, v57
    v_exp_f32 v58, v58
    v_exp_f32 v59, v59
    v_mfma_f32_32x32x16_bf16 v[96:111], v[148:151], v[84:87], v[96:111]
    v_exp_f32 v60, v60
    v_exp_f32 v61, v61
    v_exp_f32 v62, v62
    v_exp_f32 v63, v63
    v_cvt_pk_bf16_f32 v88, v48, v49
    v_cvt_pk_bf16_f32 v89, v50, v51
    v_cvt_pk_bf16_f32 v90, v52, v53
    v_cvt_pk_bf16_f32 v91, v54, v55
    v_cvt_pk_bf16_f32 v92, v56, v57
    v_cvt_pk_bf16_f32 v93, v58, v59
    v_cvt_pk_bf16_f32 v94, v60, v61
    v_cvt_pk_bf16_f32 v95, v62, v63
    s_waitcnt lgkmcnt(0)
    s_mov_b64 exec, s[42:43]
    ds_read_b128 v[144:147], v162 offset:30720
    ds_read_b128 v[148:151], v162 offset:31360
    s_mov_b64 exec, -1
    ds_read_b128 v[112:115], v6 offset:33280
    s_mov_b64 exec, s[40:41]
    ds_read_b64 v[116:117], v4 offset:34304
    s_mov_b64 exec, -1
    v_mfma_f32_32x32x16_bf16 v[48:63], v[120:123], v[8:11], v[16:31]
    v_exp_f32 v32, v32
    v_exp_f32 v33, v33
    v_exp_f32 v34, v34
    v_exp_f32 v35, v35
    v_mfma_f32_32x32x16_bf16 v[48:63], v[124:127], v[12:15], v[48:63]
    v_exp_f32 v36, v36
    v_exp_f32 v37, v37
    v_exp_f32 v38, v38
    v_exp_f32 v39, v39
    v_mfma_f32_32x32x16_bf16 v[96:111], v[152:155], v[88:91], v[96:111]
    v_exp_f32 v40, v40
    v_exp_f32 v41, v41
    v_exp_f32 v42, v42
    v_exp_f32 v43, v43
    v_mfma_f32_32x32x16_bf16 v[96:111], v[156:159], v[92:95], v[96:111]
    v_exp_f32 v44, v44
    v_exp_f32 v45, v45
    v_exp_f32 v46, v46
    v_exp_f32 v47, v47
    v_cvt_pk_bf16_f32 v80, v32, v33
    v_cvt_pk_bf16_f32 v81, v34, v35
    v_cvt_pk_bf16_f32 v82, v36, v37
    v_cvt_pk_bf16_f32 v83, v38, v39
    v_cvt_pk_bf16_f32 v84, v40, v41
    v_cvt_pk_bf16_f32 v85, v42, v43
    v_cvt_pk_bf16_f32 v86, v44, v45
    v_cvt_pk_bf16_f32 v87, v46, v47
    s_waitcnt lgkmcnt(0)
    s_mov_b64 exec, s[42:43]
    ds_read_b128 v[152:155], v162 offset:32000
    ds_read_b128 v[156:159], v162 offset:32640
    s_mov_b64 exec, -1
    ds_read_b128 v[120:123], v6 offset:34560
    s_mov_b64 exec, s[40:41]
    ds_read_b64 v[124:125], v4 offset:35584
    s_mov_b64 exec, -1
    v_mfma_f32_32x32x16_bf16 v[32:47], v[112:115], v[8:11], v[16:31]
    v_exp_f32 v48, v48
    v_exp_f32 v49, v49
    v_exp_f32 v50, v50
    v_exp_f32 v51, v51
    v_mfma_f32_32x32x16_bf16 v[32:47], v[116:119], v[12:15], v[32:47]
    v_exp_f32 v52, v52
    v_exp_f32 v53, v53
    v_exp_f32 v54, v54
    v_exp_f32 v55, v55
    v_mfma_f32_32x32x16_bf16 v[96:111], v[144:147], v[80:83], v[96:111]
    v_exp_f32 v56, v56
    v_exp_f32 v57, v57
    v_exp_f32 v58, v58
    v_exp_f32 v59, v59
    v_mfma_f32_32x32x16_bf16 v[96:111], v[148:151], v[84:87], v[96:111]
    v_exp_f32 v60, v60
    v_exp_f32 v61, v61
    v_exp_f32 v62, v62
    v_exp_f32 v63, v63
    v_cvt_pk_bf16_f32 v88, v48, v49
    v_cvt_pk_bf16_f32 v89, v50, v51
    v_cvt_pk_bf16_f32 v90, v52, v53
    v_cvt_pk_bf16_f32 v91, v54, v55
    v_cvt_pk_bf16_f32 v92, v56, v57
    v_cvt_pk_bf16_f32 v93, v58, v59
    v_cvt_pk_bf16_f32 v94, v60, v61
    v_cvt_pk_bf16_f32 v95, v62, v63
    s_waitcnt lgkmcnt(0)
    s_mov_b64 exec, s[42:43]
    ds_read_b128 v[144:147], v162 offset:33280
    ds_read_b128 v[148:151], v162 offset:33920
    s_mov_b64 exec, -1
    ds_read_b128 v[112:115], v6 offset:35840
    s_mov_b64 exec, s[40:41]
    ds_read_b64 v[116:117], v4 offset:36864
    s_mov_b64 exec, -1
    v_mfma_f32_32x32x16_bf16 v[48:63], v[120:123], v[8:11], v[16:31]
    v_exp_f32 v32, v32
    v_exp_f32 v33, v33
    v_exp_f32 v34, v34
    v_exp_f32 v35, v35
    v_mfma_f32_32x32x16_bf16 v[48:63], v[124:127], v[12:15], v[48:63]
    v_exp_f32 v36, v36
    v_exp_f32 v37, v37
    v_exp_f32 v38, v38
    v_exp_f32 v39, v39
    v_mfma_f32_32x32x16_bf16 v[96:111], v[152:155], v[88:91], v[96:111]
    v_exp_f32 v40, v40
    v_exp_f32 v41, v41
    v_exp_f32 v42, v42
    v_exp_f32 v43, v43
    v_mfma_f32_32x32x16_bf16 v[96:111], v[156:159], v[92:95], v[96:111]
    v_exp_f32 v44, v44
    v_exp_f32 v45, v45
    v_exp_f32 v46, v46
    v_exp_f32 v47, v47
    v_cvt_pk_bf16_f32 v80, v32, v33
    v_cvt_pk_bf16_f32 v81, v34, v35
    v_cvt_pk_bf16_f32 v82, v36, v37
    v_cvt_pk_bf16_f32 v83, v38, v39
    v_cvt_pk_bf16_f32 v84, v40, v41
    v_cvt_pk_bf16_f32 v85, v42, v43
    v_cvt_pk_bf16_f32 v86, v44, v45
    v_cvt_pk_bf16_f32 v87, v46, v47
    s_waitcnt lgkmcnt(0)
    s_mov_b64 exec, s[42:43]
    ds_read_b128 v[152:155], v162 offset:34560
    ds_read_b128 v[156:159], v162 offset:35200
    s_mov_b64 exec, -1
    ds_read_b128 v[120:123], v6 offset:37120
    s_mov_b64 exec, s[40:41]
    ds_read_b64 v[124:125], v4 offset:38144
    s_mov_b64 exec, -1
    v_mfma_f32_32x32x16_bf16 v[32:47], v[112:115], v[8:11], v[16:31]
    v_exp_f32 v48, v48
    v_exp_f32 v49, v49
    v_exp_f32 v50, v50
    v_exp_f32 v51, v51
    v_mfma_f32_32x32x16_bf16 v[32:47], v[116:119], v[12:15], v[32:47]
    v_exp_f32 v52, v52
    v_exp_f32 v53, v53
    v_exp_f32 v54, v54
    v_exp_f32 v55, v55
    v_mfma_f32_32x32x16_bf16 v[96:111], v[144:147], v[80:83], v[96:111]
    v_exp_f32 v56, v56
    v_exp_f32 v57, v57
    v_exp_f32 v58, v58
    v_exp_f32 v59, v59
    v_mfma_f32_32x32x16_bf16 v[96:111], v[148:151], v[84:87], v[96:111]
    v_exp_f32 v60, v60
    v_exp_f32 v61, v61
    v_exp_f32 v62, v62
    v_exp_f32 v63, v63
    v_cvt_pk_bf16_f32 v88, v48, v49
    v_cvt_pk_bf16_f32 v89, v50, v51
    v_cvt_pk_bf16_f32 v90, v52, v53
    v_cvt_pk_bf16_f32 v91, v54, v55
    v_cvt_pk_bf16_f32 v92, v56, v57
    v_cvt_pk_bf16_f32 v93, v58, v59
    v_cvt_pk_bf16_f32 v94, v60, v61
    v_cvt_pk_bf16_f32 v95, v62, v63
    s_waitcnt lgkmcnt(0)
    s_mov_b64 exec, s[42:43]
    ds_read_b128 v[144:147], v162 offset:35840
    ds_read_b128 v[148:151], v162 offset:36480
    s_mov_b64 exec, -1
    ds_read_b128 v[112:115], v6 offset:38400
    s_mov_b64 exec, s[40:41]
    ds_read_b64 v[116:117], v4 offset:39424
    s_mov_b64 exec, -1
    v_mfma_f32_32x32x16_bf16 v[48:63], v[120:123], v[8:11], v[16:31]
    v_exp_f32 v32, v32
    v_exp_f32 v33, v33
    v_exp_f32 v34, v34
    v_exp_f32 v35, v35
    v_mfma_f32_32x32x16_bf16 v[48:63], v[124:127], v[12:15], v[48:63]
    v_exp_f32 v36, v36
    v_exp_f32 v37, v37
    v_exp_f32 v38, v38
    v_exp_f32 v39, v39
    v_mfma_f32_32x32x16_bf16 v[96:111], v[152:155], v[88:91], v[96:111]
    v_exp_f32 v40, v40
    v_exp_f32 v41, v41
    v_exp_f32 v42, v42
    v_exp_f32 v43, v43
    v_mfma_f32_32x32x16_bf16 v[96:111], v[156:159], v[92:95], v[96:111]
    v_exp_f32 v44, v44
    v_exp_f32 v45, v45
    v_exp_f32 v46, v46
    v_exp_f32 v47, v47
    v_cvt_pk_bf16_f32 v80, v32, v33
    v_cvt_pk_bf16_f32 v81, v34, v35
    v_cvt_pk_bf16_f32 v82, v36, v37
    v_cvt_pk_bf16_f32 v83, v38, v39
    v_cvt_pk_bf16_f32 v84, v40, v41
    v_cvt_pk_bf16_f32 v85, v42, v43
    v_cvt_pk_bf16_f32 v86, v44, v45
    v_cvt_pk_bf16_f32 v87, v46, v47
    s_waitcnt lgkmcnt(0)
    s_mov_b64 exec, s[42:43]
    ds_read_b128 v[152:155], v162 offset:37120
    ds_read_b128 v[156:159], v162 offset:37760
    s_mov_b64 exec, -1
    ds_read_b128 v[120:123], v6 offset:39680
    s_mov_b64 exec, s[40:41]
    ds_read_b64 v[124:125], v4 offset:40704
    s_mov_b64 exec, -1
    v_mfma_f32_32x32x16_bf16 v[32:47], v[112:115], v[8:11], v[16:31]
    v_exp_f32 v48, v48
    v_exp_f32 v49, v49
    v_exp_f32 v50, v50
    v_exp_f32 v51, v51
    v_mfma_f32_32x32x16_bf16 v[32:47], v[116:119], v[12:15], v[32:47]
    v_exp_f32 v52, v52
    v_exp_f32 v53, v53
    v_exp_f32 v54, v54
    v_exp_f32 v55, v55
    v_mfma_f32_32x32x16_bf16 v[96:111], v[144:147], v[80:83], v[96:111]
    v_exp_f32 v56, v56
    v_exp_f32 v57, v57
    v_exp_f32 v58, v58
    v_exp_f32 v59, v59
    v_mfma_f32_32x32x16_bf16 v[96:111], v[148:151], v[84:87], v[96:111]
    v_exp_f32 v60, v60
    v_exp_f32 v61, v61
    v_exp_f32 v62, v62
    v_exp_f32 v63, v63
    v_cvt_pk_bf16_f32 v88, v48, v49
    v_cvt_pk_bf16_f32 v89, v50, v51
    v_cvt_pk_bf16_f32 v90, v52, v53
    v_cvt_pk_bf16_f32 v91, v54, v55
    v_cvt_pk_bf16_f32 v92, v56, v57
    v_cvt_pk_bf16_f32 v93, v58, v59
    v_cvt_pk_bf16_f32 v94, v60, v61
    v_cvt_pk_bf16_f32 v95, v62, v63
    s_waitcnt lgkmcnt(0)
    s_mov_b64 exec, s[42:43]
    ds_read_b128 v[144:147], v162 offset:38400
    ds_read_b128 v[148:151], v162 offset:39040
    s_mov_b64 exec, -1
    ds_read_b128 v[112:115], v5 offset:0
    s_mov_b64 exec, s[40:41]
    ds_read_b64 v[116:117], v1 offset:1024
    s_mov_b64 exec, -1
    v_mfma_f32_32x32x16_bf16 v[48:63], v[120:123], v[8:11], v[16:31]
    v_exp_f32 v32, v32
    v_exp_f32 v33, v33
    v_exp_f32 v34, v34
    v_exp_f32 v35, v35
    v_mfma_f32_32x32x16_bf16 v[48:63], v[124:127], v[12:15], v[48:63]
    v_exp_f32 v36, v36
    v_exp_f32 v37, v37
    v_exp_f32 v38, v38
    v_exp_f32 v39, v39
    v_mfma_f32_32x32x16_bf16 v[96:111], v[152:155], v[88:91], v[96:111]
    v_exp_f32 v40, v40
    v_exp_f32 v41, v41
    v_exp_f32 v42, v42
    v_exp_f32 v43, v43
    v_mfma_f32_32x32x16_bf16 v[96:111], v[156:159], v[92:95], v[96:111]
    v_exp_f32 v44, v44
    v_exp_f32 v45, v45
    v_exp_f32 v46, v46
    v_exp_f32 v47, v47
    v_cvt_pk_bf16_f32 v80, v32, v33
    v_cvt_pk_bf16_f32 v81, v34, v35
    v_cvt_pk_bf16_f32 v82, v36, v37
    v_cvt_pk_bf16_f32 v83, v38, v39
    v_cvt_pk_bf16_f32 v84, v40, v41
    v_cvt_pk_bf16_f32 v85, v42, v43
    v_cvt_pk_bf16_f32 v86, v44, v45
    v_cvt_pk_bf16_f32 v87, v46, v47
    s_waitcnt lgkmcnt(0)
    s_mov_b64 exec, s[42:43]
    ds_read_b128 v[152:155], v162 offset:39680
    ds_read_b128 v[156:159], v162 offset:40320
    s_mov_b64 exec, -1
    ds_read_b128 v[120:123], v5 offset:1280
    s_mov_b64 exec, s[40:41]
    ds_read_b64 v[124:125], v1 offset:2304
    s_mov_b64 exec, -1
    v_mfma_f32_32x32x16_bf16 v[32:47], v[112:115], v[8:11], v[16:31]
    v_exp_f32 v48, v48
    v_exp_f32 v49, v49
    v_exp_f32 v50, v50
    v_exp_f32 v51, v51
    v_mfma_f32_32x32x16_bf16 v[32:47], v[116:119], v[12:15], v[32:47]
    v_exp_f32 v52, v52
    v_exp_f32 v53, v53
    v_exp_f32 v54, v54
    v_exp_f32 v55, v55
    v_mfma_f32_32x32x16_bf16 v[96:111], v[144:147], v[80:83], v[96:111]
    v_exp_f32 v56, v56
    v_exp_f32 v57, v57
    v_exp_f32 v58, v58
    v_exp_f32 v59, v59
    v_mfma_f32_32x32x16_bf16 v[96:111], v[148:151], v[84:87], v[96:111]
    v_exp_f32 v60, v60
    v_exp_f32 v61, v61
    v_exp_f32 v62, v62
    v_exp_f32 v63, v63
    v_cvt_pk_bf16_f32 v88, v48, v49
    v_cvt_pk_bf16_f32 v89, v50, v51
    v_cvt_pk_bf16_f32 v90, v52, v53
    v_cvt_pk_bf16_f32 v91, v54, v55
    v_cvt_pk_bf16_f32 v92, v56, v57
    v_cvt_pk_bf16_f32 v93, v58, v59
    v_cvt_pk_bf16_f32 v94, v60, v61
    v_cvt_pk_bf16_f32 v95, v62, v63
    s_waitcnt lgkmcnt(0)
    s_mov_b64 exec, s[42:43]
    ds_read_b128 v[144:147], v163 offset:0
    ds_read_b128 v[148:151], v163 offset:640
    s_mov_b64 exec, -1
    ds_read_b128 v[112:115], v5 offset:2560
    s_mov_b64 exec, s[40:41]
    ds_read_b64 v[116:117], v1 offset:3584
    s_mov_b64 exec, -1
    v_mfma_f32_32x32x16_bf16 v[48:63], v[120:123], v[8:11], v[16:31]
    v_exp_f32 v32, v32
    v_exp_f32 v33, v33
    v_exp_f32 v34, v34
    v_exp_f32 v35, v35
    v_mfma_f32_32x32x16_bf16 v[48:63], v[124:127], v[12:15], v[48:63]
    v_exp_f32 v36, v36
    v_exp_f32 v37, v37
    v_exp_f32 v38, v38
    v_exp_f32 v39, v39
    v_mfma_f32_32x32x16_bf16 v[96:111], v[152:155], v[88:91], v[96:111]
    v_exp_f32 v40, v40
    v_exp_f32 v41, v41
    v_exp_f32 v42, v42
    v_exp_f32 v43, v43
    v_mfma_f32_32x32x16_bf16 v[96:111], v[156:159], v[92:95], v[96:111]
    v_exp_f32 v44, v44
    v_exp_f32 v45, v45
    v_exp_f32 v46, v46
    v_exp_f32 v47, v47
    v_cvt_pk_bf16_f32 v80, v32, v33
    v_cvt_pk_bf16_f32 v81, v34, v35
    v_cvt_pk_bf16_f32 v82, v36, v37
    v_cvt_pk_bf16_f32 v83, v38, v39
    v_cvt_pk_bf16_f32 v84, v40, v41
    v_cvt_pk_bf16_f32 v85, v42, v43
    v_cvt_pk_bf16_f32 v86, v44, v45
    v_cvt_pk_bf16_f32 v87, v46, v47
    s_waitcnt lgkmcnt(0)
    s_mov_b64 exec, s[42:43]
    ds_read_b128 v[152:155], v163 offset:1280
    ds_read_b128 v[156:159], v163 offset:1920
    s_mov_b64 exec, -1
    ds_read_b128 v[120:123], v5 offset:3840
    s_mov_b64 exec, s[40:41]
    ds_read_b64 v[124:125], v1 offset:4864
    s_mov_b64 exec, -1
    v_mfma_f32_32x32x16_bf16 v[32:47], v[112:115], v[8:11], v[16:31]
    v_exp_f32 v48, v48
    v_exp_f32 v49, v49
    v_exp_f32 v50, v50
    v_exp_f32 v51, v51
    v_mfma_f32_32x32x16_bf16 v[32:47], v[116:119], v[12:15], v[32:47]
    v_exp_f32 v52, v52
    v_exp_f32 v53, v53
    v_exp_f32 v54, v54
    v_exp_f32 v55, v55
    v_mfma_f32_32x32x16_bf16 v[96:111], v[144:147], v[80:83], v[96:111]
    v_exp_f32 v56, v56
    v_exp_f32 v57, v57
    v_exp_f32 v58, v58
    v_exp_f32 v59, v59
    v_mfma_f32_32x32x16_bf16 v[96:111], v[148:151], v[84:87], v[96:111]
    v_exp_f32 v60, v60
    v_exp_f32 v61, v61
    v_exp_f32 v62, v62
    v_exp_f32 v63, v63
    v_cvt_pk_bf16_f32 v88, v48, v49
    v_cvt_pk_bf16_f32 v89, v50, v51
    v_cvt_pk_bf16_f32 v90, v52, v53
    v_cvt_pk_bf16_f32 v91, v54, v55
    v_cvt_pk_bf16_f32 v92, v56, v57
    v_cvt_pk_bf16_f32 v93, v58, v59
    v_cvt_pk_bf16_f32 v94, v60, v61
    v_cvt_pk_bf16_f32 v95, v62, v63
    s_waitcnt lgkmcnt(0)
    s_mov_b64 exec, s[42:43]
    ds_read_b128 v[144:147], v163 offset:2560
    ds_read_b128 v[148:151], v163 offset:3200
    s_mov_b64 exec, -1
    ds_read_b128 v[112:115], v5 offset:5120
    s_mov_b64 exec, s[40:41]
    ds_read_b64 v[116:117], v1 offset:6144
    s_mov_b64 exec, -1
    v_mfma_f32_32x32x16_bf16 v[48:63], v[120:123], v[8:11], v[16:31]
    v_exp_f32 v32, v32
    v_exp_f32 v33, v33
    v_exp_f32 v34, v34
    v_exp_f32 v35, v35
    v_mfma_f32_32x32x16_bf16 v[48:63], v[124:127], v[12:15], v[48:63]
    v_exp_f32 v36, v36
    v_exp_f32 v37, v37
    v_exp_f32 v38, v38
    v_exp_f32 v39, v39
    v_mfma_f32_32x32x16_bf16 v[96:111], v[152:155], v[88:91], v[96:111]
    v_exp_f32 v40, v40
    v_exp_f32 v41, v41
    v_exp_f32 v42, v42
    v_exp_f32 v43, v43
    v_mfma_f32_32x32x16_bf16 v[96:111], v[156:159], v[92:95], v[96:111]
    v_exp_f32 v44, v44
    v_exp_f32 v45, v45
    v_exp_f32 v46, v46
    v_exp_f32 v47, v47
    v_cvt_pk_bf16_f32 v80, v32, v33
    v_cvt_pk_bf16_f32 v81, v34, v35
    v_cvt_pk_bf16_f32 v82, v36, v37
    v_cvt_pk_bf16_f32 v83, v38, v39
    v_cvt_pk_bf16_f32 v84, v40, v41
    v_cvt_pk_bf16_f32 v85, v42, v43
    v_cvt_pk_bf16_f32 v86, v44, v45
    v_cvt_pk_bf16_f32 v87, v46, v47
    s_waitcnt lgkmcnt(0)
    s_mov_b64 exec, s[42:43]
    ds_read_b128 v[152:155], v163 offset:3840
    ds_read_b128 v[156:159], v163 offset:4480
    s_mov_b64 exec, -1
    ds_read_b128 v[120:123], v5 offset:6400
    s_mov_b64 exec, s[40:41]
    ds_read_b64 v[124:125], v1 offset:7424
    s_mov_b64 exec, -1
    v_mfma_f32_32x32x16_bf16 v[32:47], v[112:115], v[8:11], v[16:31]
    v_exp_f32 v48, v48
    v_exp_f32 v49, v49
    v_exp_f32 v50, v50
    v_exp_f32 v51, v51
    v_mfma_f32_32x32x16_bf16 v[32:47], v[116:119], v[12:15], v[32:47]
    v_exp_f32 v52, v52
    v_exp_f32 v53, v53
    v_exp_f32 v54, v54
    v_exp_f32 v55, v55
    v_mfma_f32_32x32x16_bf16 v[96:111], v[144:147], v[80:83], v[96:111]
    v_exp_f32 v56, v56
    v_exp_f32 v57, v57
    v_exp_f32 v58, v58
    v_exp_f32 v59, v59
    v_mfma_f32_32x32x16_bf16 v[96:111], v[148:151], v[84:87], v[96:111]
    v_exp_f32 v60, v60
    v_exp_f32 v61, v61
    v_exp_f32 v62, v62
    v_exp_f32 v63, v63
    v_cvt_pk_bf16_f32 v88, v48, v49
    v_cvt_pk_bf16_f32 v89, v50, v51
    v_cvt_pk_bf16_f32 v90, v52, v53
    v_cvt_pk_bf16_f32 v91, v54, v55
    v_cvt_pk_bf16_f32 v92, v56, v57
    v_cvt_pk_bf16_f32 v93, v58, v59
    v_cvt_pk_bf16_f32 v94, v60, v61
    v_cvt_pk_bf16_f32 v95, v62, v63
    s_waitcnt lgkmcnt(0)
    s_mov_b64 exec, s[42:43]
    ds_read_b128 v[144:147], v163 offset:5120
    ds_read_b128 v[148:151], v163 offset:5760
    s_mov_b64 exec, -1
    ds_read_b128 v[112:115], v5 offset:7680
    s_mov_b64 exec, s[40:41]
    ds_read_b64 v[116:117], v1 offset:8704
    s_mov_b64 exec, -1
    v_mfma_f32_32x32x16_bf16 v[48:63], v[120:123], v[8:11], v[16:31]
    v_exp_f32 v32, v32
    v_exp_f32 v33, v33
    v_exp_f32 v34, v34
    v_exp_f32 v35, v35
    v_mfma_f32_32x32x16_bf16 v[48:63], v[124:127], v[12:15], v[48:63]
    v_exp_f32 v36, v36
    v_exp_f32 v37, v37
    v_exp_f32 v38, v38
    v_exp_f32 v39, v39
    v_mfma_f32_32x32x16_bf16 v[96:111], v[152:155], v[88:91], v[96:111]
    v_exp_f32 v40, v40
    v_exp_f32 v41, v41
    v_exp_f32 v42, v42
    v_exp_f32 v43, v43
    v_mfma_f32_32x32x16_bf16 v[96:111], v[156:159], v[92:95], v[96:111]
    v_exp_f32 v44, v44
    v_exp_f32 v45, v45
    v_exp_f32 v46, v46
    v_exp_f32 v47, v47
    v_cvt_pk_bf16_f32 v80, v32, v33
    v_cvt_pk_bf16_f32 v81, v34, v35
    v_cvt_pk_bf16_f32 v82, v36, v37
    v_cvt_pk_bf16_f32 v83, v38, v39
    v_cvt_pk_bf16_f32 v84, v40, v41
    v_cvt_pk_bf16_f32 v85, v42, v43
    v_cvt_pk_bf16_f32 v86, v44, v45
    v_cvt_pk_bf16_f32 v87, v46, v47
    s_waitcnt lgkmcnt(0)
    s_mov_b64 exec, s[42:43]
    ds_read_b128 v[152:155], v163 offset:6400
    ds_read_b128 v[156:159], v163 offset:7040
    s_mov_b64 exec, -1
    ds_read_b128 v[120:123], v5 offset:8960
    s_mov_b64 exec, s[40:41]
    ds_read_b64 v[124:125], v1 offset:9984
    s_mov_b64 exec, -1
    v_mfma_f32_32x32x16_bf16 v[32:47], v[112:115], v[8:11], v[16:31]
    v_exp_f32 v48, v48
    v_exp_f32 v49, v49
    v_exp_f32 v50, v50
    v_exp_f32 v51, v51
    v_mfma_f32_32x32x16_bf16 v[32:47], v[116:119], v[12:15], v[32:47]
    v_exp_f32 v52, v52
    v_exp_f32 v53, v53
    v_exp_f32 v54, v54
    v_exp_f32 v55, v55
    v_mfma_f32_32x32x16_bf16 v[96:111], v[144:147], v[80:83], v[96:111]
    v_exp_f32 v56, v56
    v_exp_f32 v57, v57
    v_exp_f32 v58, v58
    v_exp_f32 v59, v59
    v_mfma_f32_32x32x16_bf16 v[96:111], v[148:151], v[84:87], v[96:111]
    v_exp_f32 v60, v60
    v_exp_f32 v61, v61
    v_exp_f32 v62, v62
    v_exp_f32 v63, v63
    v_cvt_pk_bf16_f32 v88, v48, v49
    v_cvt_pk_bf16_f32 v89, v50, v51
    v_cvt_pk_bf16_f32 v90, v52, v53
    v_cvt_pk_bf16_f32 v91, v54, v55
    v_cvt_pk_bf16_f32 v92, v56, v57
    v_cvt_pk_bf16_f32 v93, v58, v59
    v_cvt_pk_bf16_f32 v94, v60, v61
    v_cvt_pk_bf16_f32 v95, v62, v63
    s_waitcnt lgkmcnt(0)
    s_mov_b64 exec, s[42:43]
    ds_read_b128 v[144:147], v163 offset:7680
    ds_read_b128 v[148:151], v163 offset:8320
    s_mov_b64 exec, -1
    ds_read_b128 v[112:115], v5 offset:10240
    s_mov_b64 exec, s[40:41]
    ds_read_b64 v[116:117], v1 offset:11264
    s_mov_b64 exec, -1
    v_mfma_f32_32x32x16_bf16 v[48:63], v[120:123], v[8:11], v[16:31]
    v_exp_f32 v32, v32
    v_exp_f32 v33, v33
    v_exp_f32 v34, v34
    v_exp_f32 v35, v35
    v_mfma_f32_32x32x16_bf16 v[48:63], v[124:127], v[12:15], v[48:63]
    v_exp_f32 v36, v36
    v_exp_f32 v37, v37
    v_exp_f32 v38, v38
    v_exp_f32 v39, v39
    v_mfma_f32_32x32x16_bf16 v[96:111], v[152:155], v[88:91], v[96:111]
    v_exp_f32 v40, v40
    v_exp_f32 v41, v41
    v_exp_f32 v42, v42
    v_exp_f32 v43, v43
    v_mfma_f32_32x32x16_bf16 v[96:111], v[156:159], v[92:95], v[96:111]
    v_exp_f32 v44, v44
    v_exp_f32 v45, v45
    v_exp_f32 v46, v46
    v_exp_f32 v47, v47
    v_cvt_pk_bf16_f32 v80, v32, v33
    v_cvt_pk_bf16_f32 v81, v34, v35
    v_cvt_pk_bf16_f32 v82, v36, v37
    v_cvt_pk_bf16_f32 v83, v38, v39
    v_cvt_pk_bf16_f32 v84, v40, v41
    v_cvt_pk_bf16_f32 v85, v42, v43
    v_cvt_pk_bf16_f32 v86, v44, v45
    v_cvt_pk_bf16_f32 v87, v46, v47
    s_waitcnt lgkmcnt(0)
    s_mov_b64 exec, s[42:43]
    ds_read_b128 v[152:155], v163 offset:8960
    ds_read_b128 v[156:159], v163 offset:9600
    s_mov_b64 exec, -1
    ds_read_b128 v[120:123], v5 offset:11520
    s_mov_b64 exec, s[40:41]
    ds_read_b64 v[124:125], v1 offset:12544
    s_mov_b64 exec, -1
    v_mfma_f32_32x32x16_bf16 v[32:47], v[112:115], v[8:11], v[16:31]
    v_exp_f32 v48, v48
    v_exp_f32 v49, v49
    v_exp_f32 v50, v50
    v_exp_f32 v51, v51
    v_mfma_f32_32x32x16_bf16 v[32:47], v[116:119], v[12:15], v[32:47]
    v_exp_f32 v52, v52
    v_exp_f32 v53, v53
    v_exp_f32 v54, v54
    v_exp_f32 v55, v55
    v_mfma_f32_32x32x16_bf16 v[96:111], v[144:147], v[80:83], v[96:111]
    v_exp_f32 v56, v56
    v_exp_f32 v57, v57
    v_exp_f32 v58, v58
    v_exp_f32 v59, v59
    v_mfma_f32_32x32x16_bf16 v[96:111], v[148:151], v[84:87], v[96:111]
    v_exp_f32 v60, v60
    v_exp_f32 v61, v61
    v_exp_f32 v62, v62
    v_exp_f32 v63, v63
    v_cvt_pk_bf16_f32 v88, v48, v49
    v_cvt_pk_bf16_f32 v89, v50, v51
    v_cvt_pk_bf16_f32 v90, v52, v53
    v_cvt_pk_bf16_f32 v91, v54, v55
    v_cvt_pk_bf16_f32 v92, v56, v57
    v_cvt_pk_bf16_f32 v93, v58, v59
    v_cvt_pk_bf16_f32 v94, v60, v61
    v_cvt_pk_bf16_f32 v95, v62, v63
    s_waitcnt lgkmcnt(0)
    s_mov_b64 exec, s[42:43]
    ds_read_b128 v[144:147], v163 offset:10240
    ds_read_b128 v[148:151], v163 offset:10880
    s_mov_b64 exec, -1
    ds_read_b128 v[112:115], v5 offset:12800
    s_mov_b64 exec, s[40:41]
    ds_read_b64 v[116:117], v1 offset:13824
    s_mov_b64 exec, -1
    v_mfma_f32_32x32x16_bf16 v[48:63], v[120:123], v[8:11], v[16:31]
    v_exp_f32 v32, v32
    v_exp_f32 v33, v33
    v_exp_f32 v34, v34
    v_exp_f32 v35, v35
    v_mfma_f32_32x32x16_bf16 v[48:63], v[124:127], v[12:15], v[48:63]
    v_exp_f32 v36, v36
    v_exp_f32 v37, v37
    v_exp_f32 v38, v38
    v_exp_f32 v39, v39
    v_mfma_f32_32x32x16_bf16 v[96:111], v[152:155], v[88:91], v[96:111]
    v_exp_f32 v40, v40
    v_exp_f32 v41, v41
    v_exp_f32 v42, v42
    v_exp_f32 v43, v43
    v_mfma_f32_32x32x16_bf16 v[96:111], v[156:159], v[92:95], v[96:111]
    v_exp_f32 v44, v44
    v_exp_f32 v45, v45
    v_exp_f32 v46, v46
    v_exp_f32 v47, v47
    v_cvt_pk_bf16_f32 v80, v32, v33
    v_cvt_pk_bf16_f32 v81, v34, v35
    v_cvt_pk_bf16_f32 v82, v36, v37
    v_cvt_pk_bf16_f32 v83, v38, v39
    v_cvt_pk_bf16_f32 v84, v40, v41
    v_cvt_pk_bf16_f32 v85, v42, v43
    v_cvt_pk_bf16_f32 v86, v44, v45
    v_cvt_pk_bf16_f32 v87, v46, v47
    s_waitcnt lgkmcnt(0)
    s_mov_b64 exec, s[42:43]
    ds_read_b128 v[152:155], v163 offset:11520
    ds_read_b128 v[156:159], v163 offset:12160
    s_mov_b64 exec, -1
    ds_read_b128 v[120:123], v5 offset:14080
    s_mov_b64 exec, s[40:41]
    ds_read_b64 v[124:125], v1 offset:15104
    s_mov_b64 exec, -1
    v_mfma_f32_32x32x16_bf16 v[32:47], v[112:115], v[8:11], v[16:31]
    v_exp_f32 v48, v48
    v_exp_f32 v49, v49
    v_exp_f32 v50, v50
    v_exp_f32 v51, v51
    v_mfma_f32_32x32x16_bf16 v[32:47], v[116:119], v[12:15], v[32:47]
    v_exp_f32 v52, v52
    v_exp_f32 v53, v53
    v_exp_f32 v54, v54
    v_exp_f32 v55, v55
    v_mfma_f32_32x32x16_bf16 v[96:111], v[144:147], v[80:83], v[96:111]
    v_exp_f32 v56, v56
    v_exp_f32 v57, v57
    v_exp_f32 v58, v58
    v_exp_f32 v59, v59
    v_mfma_f32_32x32x16_bf16 v[96:111], v[148:151], v[84:87], v[96:111]
    v_exp_f32 v60, v60
    v_exp_f32 v61, v61
    v_exp_f32 v62, v62
    v_exp_f32 v63, v63
    v_cvt_pk_bf16_f32 v88, v48, v49
    v_cvt_pk_bf16_f32 v89, v50, v51
    v_cvt_pk_bf16_f32 v90, v52, v53
    v_cvt_pk_bf16_f32 v91, v54, v55
    v_cvt_pk_bf16_f32 v92, v56, v57
    v_cvt_pk_bf16_f32 v93, v58, v59
    v_cvt_pk_bf16_f32 v94, v60, v61
    v_cvt_pk_bf16_f32 v95, v62, v63
    s_waitcnt lgkmcnt(0)
    s_mov_b64 exec, s[42:43]
    ds_read_b128 v[144:147], v163 offset:12800
    ds_read_b128 v[148:151], v163 offset:13440
    s_mov_b64 exec, -1
    ds_read_b128 v[112:115], v5 offset:15360
    s_mov_b64 exec, s[40:41]
    ds_read_b64 v[116:117], v1 offset:16384
    s_mov_b64 exec, -1
    v_mfma_f32_32x32x16_bf16 v[48:63], v[120:123], v[8:11], v[16:31]
    v_exp_f32 v32, v32
    v_exp_f32 v33, v33
    v_exp_f32 v34, v34
    v_exp_f32 v35, v35
    v_mfma_f32_32x32x16_bf16 v[48:63], v[124:127], v[12:15], v[48:63]
    v_exp_f32 v36, v36
    v_exp_f32 v37, v37
    v_exp_f32 v38, v38
    v_exp_f32 v39, v39
    v_mfma_f32_32x32x16_bf16 v[96:111], v[152:155], v[88:91], v[96:111]
    v_exp_f32 v40, v40
    v_exp_f32 v41, v41
    v_exp_f32 v42, v42
    v_exp_f32 v43, v43
    v_mfma_f32_32x32x16_bf16 v[96:111], v[156:159], v[92:95], v[96:111]
    v_exp_f32 v44, v44
    v_exp_f32 v45, v45
    v_exp_f32 v46, v46
    v_exp_f32 v47, v47
    v_cvt_pk_bf16_f32 v80, v32, v33
    v_cvt_pk_bf16_f32 v81, v34, v35
    v_cvt_pk_bf16_f32 v82, v36, v37
    v_cvt_pk_bf16_f32 v83, v38, v39
    v_cvt_pk_bf16_f32 v84, v40, v41
    v_cvt_pk_bf16_f32 v85, v42, v43
    v_cvt_pk_bf16_f32 v86, v44, v45
    v_cvt_pk_bf16_f32 v87, v46, v47
    s_waitcnt lgkmcnt(0)
    s_mov_b64 exec, s[42:43]
    ds_read_b128 v[152:155], v163 offset:14080
    ds_read_b128 v[156:159], v163 offset:14720
    s_mov_b64 exec, -1
    ds_read_b128 v[120:123], v5 offset:16640
    s_mov_b64 exec, s[40:41]
    ds_read_b64 v[124:125], v1 offset:17664
    s_mov_b64 exec, -1
    v_mfma_f32_32x32x16_bf16 v[32:47], v[112:115], v[8:11], v[16:31]
    v_exp_f32 v48, v48
    v_exp_f32 v49, v49
    v_exp_f32 v50, v50
    v_exp_f32 v51, v51
    v_mfma_f32_32x32x16_bf16 v[32:47], v[116:119], v[12:15], v[32:47]
    v_exp_f32 v52, v52
    v_exp_f32 v53, v53
    v_exp_f32 v54, v54
    v_exp_f32 v55, v55
    v_mfma_f32_32x32x16_bf16 v[96:111], v[144:147], v[80:83], v[96:111]
    v_exp_f32 v56, v56
    v_exp_f32 v57, v57
    v_exp_f32 v58, v58
    v_exp_f32 v59, v59
    v_mfma_f32_32x32x16_bf16 v[96:111], v[148:151], v[84:87], v[96:111]
    v_exp_f32 v60, v60
    v_exp_f32 v61, v61
    v_exp_f32 v62, v62
    v_exp_f32 v63, v63
    v_cvt_pk_bf16_f32 v88, v48, v49
    v_cvt_pk_bf16_f32 v89, v50, v51
    v_cvt_pk_bf16_f32 v90, v52, v53
    v_cvt_pk_bf16_f32 v91, v54, v55
    v_cvt_pk_bf16_f32 v92, v56, v57
    v_cvt_pk_bf16_f32 v93, v58, v59
    v_cvt_pk_bf16_f32 v94, v60, v61
    v_cvt_pk_bf16_f32 v95, v62, v63
    s_waitcnt lgkmcnt(0)
    s_mov_b64 exec, s[42:43]
    ds_read_b128 v[144:147], v163 offset:15360
    ds_read_b128 v[148:151], v163 offset:16000
    s_mov_b64 exec, -1
    ds_read_b128 v[112:115], v5 offset:17920
    s_mov_b64 exec, s[40:41]
    ds_read_b64 v[116:117], v1 offset:18944
    s_mov_b64 exec, -1
    v_mfma_f32_32x32x16_bf16 v[48:63], v[120:123], v[8:11], v[16:31]
    v_exp_f32 v32, v32
    v_exp_f32 v33, v33
    v_exp_f32 v34, v34
    v_exp_f32 v35, v35
    v_mfma_f32_32x32x16_bf16 v[48:63], v[124:127], v[12:15], v[48:63]
    v_exp_f32 v36, v36
    v_exp_f32 v37, v37
    v_exp_f32 v38, v38
    v_exp_f32 v39, v39
    v_mfma_f32_32x32x16_bf16 v[96:111], v[152:155], v[88:91], v[96:111]
    v_exp_f32 v40, v40
    v_exp_f32 v41, v41
    v_exp_f32 v42, v42
    v_exp_f32 v43, v43
    v_mfma_f32_32x32x16_bf16 v[96:111], v[156:159], v[92:95], v[96:111]
    v_exp_f32 v44, v44
    v_exp_f32 v45, v45
    v_exp_f32 v46, v46
    v_exp_f32 v47, v47
    v_cvt_pk_bf16_f32 v80, v32, v33
    v_cvt_pk_bf16_f32 v81, v34, v35
    v_cvt_pk_bf16_f32 v82, v36, v37
    v_cvt_pk_bf16_f32 v83, v38, v39
    v_cvt_pk_bf16_f32 v84, v40, v41
    v_cvt_pk_bf16_f32 v85, v42, v43
    v_cvt_pk_bf16_f32 v86, v44, v45
    v_cvt_pk_bf16_f32 v87, v46, v47
    s_waitcnt lgkmcnt(0)
    s_mov_b64 exec, s[42:43]
    ds_read_b128 v[152:155], v163 offset:16640
    ds_read_b128 v[156:159], v163 offset:17280
    s_mov_b64 exec, -1
    ds_read_b128 v[120:123], v5 offset:19200
    s_mov_b64 exec, s[40:41]
    ds_read_b64 v[124:125], v1 offset:20224
    s_mov_b64 exec, -1
    v_mfma_f32_32x32x16_bf16 v[32:47], v[112:115], v[8:11], v[16:31]
    v_exp_f32 v48, v48
    v_exp_f32 v49, v49
    v_exp_f32 v50, v50
    v_exp_f32 v51, v51
    v_mfma_f32_32x32x16_bf16 v[32:47], v[116:119], v[12:15], v[32:47]
    v_exp_f32 v52, v52
    v_exp_f32 v53, v53
    v_exp_f32 v54, v54
    v_exp_f32 v55, v55
    v_mfma_f32_32x32x16_bf16 v[96:111], v[144:147], v[80:83], v[96:111]
    v_exp_f32 v56, v56
    v_exp_f32 v57, v57
    v_exp_f32 v58, v58
    v_exp_f32 v59, v59
    v_mfma_f32_32x32x16_bf16 v[96:111], v[148:151], v[84:87], v[96:111]
    v_exp_f32 v60, v60
    v_exp_f32 v61, v61
    v_exp_f32 v62, v62
    v_exp_f32 v63, v63
    v_cvt_pk_bf16_f32 v88, v48, v49
    v_cvt_pk_bf16_f32 v89, v50, v51
    v_cvt_pk_bf16_f32 v90, v52, v53
    v_cvt_pk_bf16_f32 v91, v54, v55
    v_cvt_pk_bf16_f32 v92, v56, v57
    v_cvt_pk_bf16_f32 v93, v58, v59
    v_cvt_pk_bf16_f32 v94, v60, v61
    v_cvt_pk_bf16_f32 v95, v62, v63
    s_waitcnt lgkmcnt(0)
    s_mov_b64 exec, s[42:43]
    ds_read_b128 v[144:147], v163 offset:17920
    ds_read_b128 v[148:151], v163 offset:18560
    s_mov_b64 exec, -1
    ds_read_b128 v[112:115], v5 offset:20480
    s_mov_b64 exec, s[40:41]
    ds_read_b64 v[116:117], v1 offset:21504
    s_mov_b64 exec, -1
    v_mfma_f32_32x32x16_bf16 v[48:63], v[120:123], v[8:11], v[16:31]
    v_exp_f32 v32, v32
    v_exp_f32 v33, v33
    v_exp_f32 v34, v34
    v_exp_f32 v35, v35
    v_mfma_f32_32x32x16_bf16 v[48:63], v[124:127], v[12:15], v[48:63]
    v_exp_f32 v36, v36
    v_exp_f32 v37, v37
    v_exp_f32 v38, v38
    v_exp_f32 v39, v39
    v_mfma_f32_32x32x16_bf16 v[96:111], v[152:155], v[88:91], v[96:111]
    v_exp_f32 v40, v40
    v_exp_f32 v41, v41
    v_exp_f32 v42, v42
    v_exp_f32 v43, v43
    v_mfma_f32_32x32x16_bf16 v[96:111], v[156:159], v[92:95], v[96:111]
    v_exp_f32 v44, v44
    v_exp_f32 v45, v45
    v_exp_f32 v46, v46
    v_exp_f32 v47, v47
    v_cvt_pk_bf16_f32 v80, v32, v33
    v_cvt_pk_bf16_f32 v81, v34, v35
    v_cvt_pk_bf16_f32 v82, v36, v37
    v_cvt_pk_bf16_f32 v83, v38, v39
    v_cvt_pk_bf16_f32 v84, v40, v41
    v_cvt_pk_bf16_f32 v85, v42, v43
    v_cvt_pk_bf16_f32 v86, v44, v45
    v_cvt_pk_bf16_f32 v87, v46, v47
    s_waitcnt lgkmcnt(0)
    s_mov_b64 exec, s[42:43]
    ds_read_b128 v[152:155], v163 offset:19200
    ds_read_b128 v[156:159], v163 offset:19840
    s_mov_b64 exec, -1
    ds_read_b128 v[120:123], v5 offset:21760
    s_mov_b64 exec, s[40:41]
    ds_read_b64 v[124:125], v1 offset:22784
    s_mov_b64 exec, -1
    v_mfma_f32_32x32x16_bf16 v[32:47], v[112:115], v[8:11], v[16:31]
    v_exp_f32 v48, v48
    v_exp_f32 v49, v49
    v_exp_f32 v50, v50
    v_exp_f32 v51, v51
    v_mfma_f32_32x32x16_bf16 v[32:47], v[116:119], v[12:15], v[32:47]
    v_exp_f32 v52, v52
    v_exp_f32 v53, v53
    v_exp_f32 v54, v54
    v_exp_f32 v55, v55
    v_mfma_f32_32x32x16_bf16 v[96:111], v[144:147], v[80:83], v[96:111]
    v_exp_f32 v56, v56
    v_exp_f32 v57, v57
    v_exp_f32 v58, v58
    v_exp_f32 v59, v59
    v_mfma_f32_32x32x16_bf16 v[96:111], v[148:151], v[84:87], v[96:111]
    v_exp_f32 v60, v60
    v_exp_f32 v61, v61
    v_exp_f32 v62, v62
    v_exp_f32 v63, v63
    v_cvt_pk_bf16_f32 v88, v48, v49
    v_cvt_pk_bf16_f32 v89, v50, v51
    v_cvt_pk_bf16_f32 v90, v52, v53
    v_cvt_pk_bf16_f32 v91, v54, v55
    v_cvt_pk_bf16_f32 v92, v56, v57
    v_cvt_pk_bf16_f32 v93, v58, v59
    v_cvt_pk_bf16_f32 v94, v60, v61
    v_cvt_pk_bf16_f32 v95, v62, v63
    s_waitcnt lgkmcnt(0)
    s_mov_b64 exec, s[42:43]
    ds_read_b128 v[144:147], v163 offset:20480
    ds_read_b128 v[148:151], v163 offset:21120
    s_mov_b64 exec, -1
    ds_read_b128 v[112:115], v5 offset:23040
    s_mov_b64 exec, s[40:41]
    ds_read_b64 v[116:117], v1 offset:24064
    s_mov_b64 exec, -1
    v_mfma_f32_32x32x16_bf16 v[48:63], v[120:123], v[8:11], v[16:31]
    v_exp_f32 v32, v32
    v_exp_f32 v33, v33
    v_exp_f32 v34, v34
    v_exp_f32 v35, v35
    v_mfma_f32_32x32x16_bf16 v[48:63], v[124:127], v[12:15], v[48:63]
    v_exp_f32 v36, v36
    v_exp_f32 v37, v37
    v_exp_f32 v38, v38
    v_exp_f32 v39, v39
    v_mfma_f32_32x32x16_bf16 v[96:111], v[152:155], v[88:91], v[96:111]
    v_exp_f32 v40, v40
    v_exp_f32 v41, v41
    v_exp_f32 v42, v42
    v_exp_f32 v43, v43
    v_mfma_f32_32x32x16_bf16 v[96:111], v[156:159], v[92:95], v[96:111]
    v_exp_f32 v44, v44
    v_exp_f32 v45, v45
    v_exp_f32 v46, v46
    v_exp_f32 v47, v47
    v_cvt_pk_bf16_f32 v80, v32, v33
    v_cvt_pk_bf16_f32 v81, v34, v35
    v_cvt_pk_bf16_f32 v82, v36, v37
    v_cvt_pk_bf16_f32 v83, v38, v39
    v_cvt_pk_bf16_f32 v84, v40, v41
    v_cvt_pk_bf16_f32 v85, v42, v43
    v_cvt_pk_bf16_f32 v86, v44, v45
    v_cvt_pk_bf16_f32 v87, v46, v47
    s_waitcnt lgkmcnt(0)
    s_mov_b64 exec, s[42:43]
    ds_read_b128 v[152:155], v163 offset:21760
    ds_read_b128 v[156:159], v163 offset:22400
    s_mov_b64 exec, -1
    ds_read_b128 v[120:123], v5 offset:24320
    s_mov_b64 exec, s[40:41]
    ds_read_b64 v[124:125], v1 offset:25344
    s_mov_b64 exec, -1
    v_mfma_f32_32x32x16_bf16 v[32:47], v[112:115], v[8:11], v[16:31]
    v_exp_f32 v48, v48
    v_exp_f32 v49, v49
    v_exp_f32 v50, v50
    v_exp_f32 v51, v51
    v_mfma_f32_32x32x16_bf16 v[32:47], v[116:119], v[12:15], v[32:47]
    v_exp_f32 v52, v52
    v_exp_f32 v53, v53
    v_exp_f32 v54, v54
    v_exp_f32 v55, v55
    v_mfma_f32_32x32x16_bf16 v[96:111], v[144:147], v[80:83], v[96:111]
    v_exp_f32 v56, v56
    v_exp_f32 v57, v57
    v_exp_f32 v58, v58
    v_exp_f32 v59, v59
    v_mfma_f32_32x32x16_bf16 v[96:111], v[148:151], v[84:87], v[96:111]
    v_exp_f32 v60, v60
    v_exp_f32 v61, v61
    v_exp_f32 v62, v62
    v_exp_f32 v63, v63
    v_cvt_pk_bf16_f32 v88, v48, v49
    v_cvt_pk_bf16_f32 v89, v50, v51
    v_cvt_pk_bf16_f32 v90, v52, v53
    v_cvt_pk_bf16_f32 v91, v54, v55
    v_cvt_pk_bf16_f32 v92, v56, v57
    v_cvt_pk_bf16_f32 v93, v58, v59
    v_cvt_pk_bf16_f32 v94, v60, v61
    v_cvt_pk_bf16_f32 v95, v62, v63
    s_waitcnt lgkmcnt(0)
    s_mov_b64 exec, s[42:43]
    ds_read_b128 v[144:147], v163 offset:23040
    ds_read_b128 v[148:151], v163 offset:23680
    s_mov_b64 exec, -1
    ds_read_b128 v[112:115], v5 offset:25600
    s_mov_b64 exec, s[40:41]
    ds_read_b64 v[116:117], v1 offset:26624
    s_mov_b64 exec, -1
    v_mfma_f32_32x32x16_bf16 v[48:63], v[120:123], v[8:11], v[16:31]
    v_exp_f32 v32, v32
    v_exp_f32 v33, v33
    v_exp_f32 v34, v34
    v_exp_f32 v35, v35
    v_mfma_f32_32x32x16_bf16 v[48:63], v[124:127], v[12:15], v[48:63]
    v_exp_f32 v36, v36
    v_exp_f32 v37, v37
    v_exp_f32 v38, v38
    v_exp_f32 v39, v39
    v_mfma_f32_32x32x16_bf16 v[96:111], v[152:155], v[88:91], v[96:111]
    v_exp_f32 v40, v40
    v_exp_f32 v41, v41
    v_exp_f32 v42, v42
    v_exp_f32 v43, v43
    v_mfma_f32_32x32x16_bf16 v[96:111], v[156:159], v[92:95], v[96:111]
    v_exp_f32 v44, v44
    v_exp_f32 v45, v45
    v_exp_f32 v46, v46
    v_exp_f32 v47, v47
    v_cvt_pk_bf16_f32 v80, v32, v33
    v_cvt_pk_bf16_f32 v81, v34, v35
    v_cvt_pk_bf16_f32 v82, v36, v37
    v_cvt_pk_bf16_f32 v83, v38, v39
    v_cvt_pk_bf16_f32 v84, v40, v41
    v_cvt_pk_bf16_f32 v85, v42, v43
    v_cvt_pk_bf16_f32 v86, v44, v45
    v_cvt_pk_bf16_f32 v87, v46, v47
    s_waitcnt lgkmcnt(0)
    s_mov_b64 exec, s[42:43]
    ds_read_b128 v[152:155], v163 offset:24320
    ds_read_b128 v[156:159], v163 offset:24960
    s_mov_b64 exec, -1
    ds_read_b128 v[120:123], v5 offset:26880
    s_mov_b64 exec, s[40:41]
    ds_read_b64 v[124:125], v1 offset:27904
    s_mov_b64 exec, -1
    v_mfma_f32_32x32x16_bf16 v[32:47], v[112:115], v[8:11], v[16:31]
    v_exp_f32 v48, v48
    v_exp_f32 v49, v49
    v_exp_f32 v50, v50
    v_exp_f32 v51, v51
    v_mfma_f32_32x32x16_bf16 v[32:47], v[116:119], v[12:15], v[32:47]
    v_exp_f32 v52, v52
    v_exp_f32 v53, v53
    v_exp_f32 v54, v54
    v_exp_f32 v55, v55
    v_mfma_f32_32x32x16_bf16 v[96:111], v[144:147], v[80:83], v[96:111]
    v_exp_f32 v56, v56
    v_exp_f32 v57, v57
    v_exp_f32 v58, v58
    v_exp_f32 v59, v59
    v_mfma_f32_32x32x16_bf16 v[96:111], v[148:151], v[84:87], v[96:111]
    v_exp_f32 v60, v60
    v_exp_f32 v61, v61
    v_exp_f32 v62, v62
    v_exp_f32 v63, v63
    v_cvt_pk_bf16_f32 v88, v48, v49
    v_cvt_pk_bf16_f32 v89, v50, v51
    v_cvt_pk_bf16_f32 v90, v52, v53
    v_cvt_pk_bf16_f32 v91, v54, v55
    v_cvt_pk_bf16_f32 v92, v56, v57
    v_cvt_pk_bf16_f32 v93, v58, v59
    v_cvt_pk_bf16_f32 v94, v60, v61
    v_cvt_pk_bf16_f32 v95, v62, v63
    s_waitcnt lgkmcnt(0)
    s_mov_b64 exec, s[42:43]
    ds_read_b128 v[144:147], v163 offset:25600
    ds_read_b128 v[148:151], v163 offset:26240
    s_mov_b64 exec, -1
    ds_read_b128 v[112:115], v5 offset:28160
    s_mov_b64 exec, s[40:41]
    ds_read_b64 v[116:117], v1 offset:29184
    s_mov_b64 exec, -1
    v_mfma_f32_32x32x16_bf16 v[48:63], v[120:123], v[8:11], v[16:31]
    v_exp_f32 v32, v32
    v_exp_f32 v33, v33
    v_exp_f32 v34, v34
    v_exp_f32 v35, v35
    v_mfma_f32_32x32x16_bf16 v[48:63], v[124:127], v[12:15], v[48:63]
    v_exp_f32 v36, v36
    v_exp_f32 v37, v37
    v_exp_f32 v38, v38
    v_exp_f32 v39, v39
    v_mfma_f32_32x32x16_bf16 v[96:111], v[152:155], v[88:91], v[96:111]
    v_exp_f32 v40, v40
    v_exp_f32 v41, v41
    v_exp_f32 v42, v42
    v_exp_f32 v43, v43
    v_mfma_f32_32x32x16_bf16 v[96:111], v[156:159], v[92:95], v[96:111]
    v_exp_f32 v44, v44
    v_exp_f32 v45, v45
    v_exp_f32 v46, v46
    v_exp_f32 v47, v47
    v_cvt_pk_bf16_f32 v80, v32, v33
    v_cvt_pk_bf16_f32 v81, v34, v35
    v_cvt_pk_bf16_f32 v82, v36, v37
    v_cvt_pk_bf16_f32 v83, v38, v39
    v_cvt_pk_bf16_f32 v84, v40, v41
    v_cvt_pk_bf16_f32 v85, v42, v43
    v_cvt_pk_bf16_f32 v86, v44, v45
    v_cvt_pk_bf16_f32 v87, v46, v47
    s_waitcnt lgkmcnt(0)
    s_mov_b64 exec, s[42:43]
    ds_read_b128 v[152:155], v163 offset:26880
    ds_read_b128 v[156:159], v163 offset:27520
    s_mov_b64 exec, -1
    ds_read_b128 v[120:123], v5 offset:29440
    s_mov_b64 exec, s[40:41]
    ds_read_b64 v[124:125], v1 offset:30464
    s_mov_b64 exec, -1
    v_mfma_f32_32x32x16_bf16 v[32:47], v[112:115], v[8:11], v[16:31]
    v_exp_f32 v48, v48
    v_exp_f32 v49, v49
    v_exp_f32 v50, v50
    v_exp_f32 v51, v51
    v_mfma_f32_32x32x16_bf16 v[32:47], v[116:119], v[12:15], v[32:47]
    v_exp_f32 v52, v52
    v_exp_f32 v53, v53
    v_exp_f32 v54, v54
    v_exp_f32 v55, v55
    v_mfma_f32_32x32x16_bf16 v[96:111], v[144:147], v[80:83], v[96:111]
    v_exp_f32 v56, v56
    v_exp_f32 v57, v57
    v_exp_f32 v58, v58
    v_exp_f32 v59, v59
    v_mfma_f32_32x32x16_bf16 v[96:111], v[148:151], v[84:87], v[96:111]
    v_exp_f32 v60, v60
    v_exp_f32 v61, v61
    v_exp_f32 v62, v62
    v_exp_f32 v63, v63
    v_cvt_pk_bf16_f32 v88, v48, v49
    v_cvt_pk_bf16_f32 v89, v50, v51
    v_cvt_pk_bf16_f32 v90, v52, v53
    v_cvt_pk_bf16_f32 v91, v54, v55
    v_cvt_pk_bf16_f32 v92, v56, v57
    v_cvt_pk_bf16_f32 v93, v58, v59
    v_cvt_pk_bf16_f32 v94, v60, v61
    v_cvt_pk_bf16_f32 v95, v62, v63
    s_waitcnt lgkmcnt(0)
    s_mov_b64 exec, s[42:43]
    ds_read_b128 v[144:147], v163 offset:28160
    ds_read_b128 v[148:151], v163 offset:28800
    s_mov_b64 exec, -1
    ds_read_b128 v[112:115], v5 offset:30720
    s_mov_b64 exec, s[40:41]
    ds_read_b64 v[116:117], v1 offset:31744
    s_mov_b64 exec, -1
    v_mfma_f32_32x32x16_bf16 v[48:63], v[120:123], v[8:11], v[16:31]
    v_exp_f32 v32, v32
    v_exp_f32 v33, v33
    v_exp_f32 v34, v34
    v_exp_f32 v35, v35
    v_mfma_f32_32x32x16_bf16 v[48:63], v[124:127], v[12:15], v[48:63]
    v_exp_f32 v36, v36
    v_exp_f32 v37, v37
    v_exp_f32 v38, v38
    v_exp_f32 v39, v39
    v_mfma_f32_32x32x16_bf16 v[96:111], v[152:155], v[88:91], v[96:111]
    v_exp_f32 v40, v40
    v_exp_f32 v41, v41
    v_exp_f32 v42, v42
    v_exp_f32 v43, v43
    v_mfma_f32_32x32x16_bf16 v[96:111], v[156:159], v[92:95], v[96:111]
    v_exp_f32 v44, v44
    v_exp_f32 v45, v45
    v_exp_f32 v46, v46
    v_exp_f32 v47, v47
    v_cvt_pk_bf16_f32 v80, v32, v33
    v_cvt_pk_bf16_f32 v81, v34, v35
    v_cvt_pk_bf16_f32 v82, v36, v37
    v_cvt_pk_bf16_f32 v83, v38, v39
    v_cvt_pk_bf16_f32 v84, v40, v41
    v_cvt_pk_bf16_f32 v85, v42, v43
    v_cvt_pk_bf16_f32 v86, v44, v45
    v_cvt_pk_bf16_f32 v87, v46, v47
    s_waitcnt lgkmcnt(0)
    s_mov_b64 exec, s[42:43]
    ds_read_b128 v[152:155], v163 offset:29440
    ds_read_b128 v[156:159], v163 offset:30080
    s_mov_b64 exec, -1
    ds_read_b128 v[120:123], v5 offset:32000
    s_mov_b64 exec, s[40:41]
    ds_read_b64 v[124:125], v1 offset:33024
    s_mov_b64 exec, -1
    v_mfma_f32_32x32x16_bf16 v[32:47], v[112:115], v[8:11], v[16:31]
    v_exp_f32 v48, v48
    v_exp_f32 v49, v49
    v_exp_f32 v50, v50
    v_exp_f32 v51, v51
    v_mfma_f32_32x32x16_bf16 v[32:47], v[116:119], v[12:15], v[32:47]
    v_exp_f32 v52, v52
    v_exp_f32 v53, v53
    v_exp_f32 v54, v54
    v_exp_f32 v55, v55
    v_mfma_f32_32x32x16_bf16 v[96:111], v[144:147], v[80:83], v[96:111]
    v_exp_f32 v56, v56
    v_exp_f32 v57, v57
    v_exp_f32 v58, v58
    v_exp_f32 v59, v59
    v_mfma_f32_32x32x16_bf16 v[96:111], v[148:151], v[84:87], v[96:111]
    v_exp_f32 v60, v60
    v_exp_f32 v61, v61
    v_exp_f32 v62, v62
    v_exp_f32 v63, v63
    v_cvt_pk_bf16_f32 v88, v48, v49
    v_cvt_pk_bf16_f32 v89, v50, v51
    v_cvt_pk_bf16_f32 v90, v52, v53
    v_cvt_pk_bf16_f32 v91, v54, v55
    v_cvt_pk_bf16_f32 v92, v56, v57
    v_cvt_pk_bf16_f32 v93, v58, v59
    v_cvt_pk_bf16_f32 v94, v60, v61
    v_cvt_pk_bf16_f32 v95, v62, v63
    s_waitcnt lgkmcnt(0)
    s_mov_b64 exec, s[42:43]
    ds_read_b128 v[144:147], v163 offset:30720
    ds_read_b128 v[148:151], v163 offset:31360
    s_mov_b64 exec, -1
    ds_read_b128 v[112:115], v5 offset:33280
    s_mov_b64 exec, s[40:41]
    ds_read_b64 v[116:117], v1 offset:34304
    s_mov_b64 exec, -1
    v_mfma_f32_32x32x16_bf16 v[48:63], v[120:123], v[8:11], v[16:31]
    v_exp_f32 v32, v32
    v_exp_f32 v33, v33
    v_exp_f32 v34, v34
    v_exp_f32 v35, v35
    v_mfma_f32_32x32x16_bf16 v[48:63], v[124:127], v[12:15], v[48:63]
    v_exp_f32 v36, v36
    v_exp_f32 v37, v37
    v_exp_f32 v38, v38
    v_exp_f32 v39, v39
    v_mfma_f32_32x32x16_bf16 v[96:111], v[152:155], v[88:91], v[96:111]
    v_exp_f32 v40, v40
    v_exp_f32 v41, v41
    v_exp_f32 v42, v42
    v_exp_f32 v43, v43
    v_mfma_f32_32x32x16_bf16 v[96:111], v[156:159], v[92:95], v[96:111]
    v_exp_f32 v44, v44
    v_exp_f32 v45, v45
    v_exp_f32 v46, v46
    v_exp_f32 v47, v47
    v_cvt_pk_bf16_f32 v80, v32, v33
    v_cvt_pk_bf16_f32 v81, v34, v35
    v_cvt_pk_bf16_f32 v82, v36, v37
    v_cvt_pk_bf16_f32 v83, v38, v39
    v_cvt_pk_bf16_f32 v84, v40, v41
    v_cvt_pk_bf16_f32 v85, v42, v43
    v_cvt_pk_bf16_f32 v86, v44, v45
    v_cvt_pk_bf16_f32 v87, v46, v47
    s_waitcnt lgkmcnt(0)
    s_mov_b64 exec, s[42:43]
    ds_read_b128 v[152:155], v163 offset:32000
    ds_read_b128 v[156:159], v163 offset:32640
    s_mov_b64 exec, -1
    ds_read_b128 v[120:123], v5 offset:34560
    s_mov_b64 exec, s[40:41]
    ds_read_b64 v[124:125], v1 offset:35584
    s_mov_b64 exec, -1
    v_mfma_f32_32x32x16_bf16 v[32:47], v[112:115], v[8:11], v[16:31]
    v_exp_f32 v48, v48
    v_exp_f32 v49, v49
    v_exp_f32 v50, v50
    v_exp_f32 v51, v51
    v_mfma_f32_32x32x16_bf16 v[32:47], v[116:119], v[12:15], v[32:47]
    v_exp_f32 v52, v52
    v_exp_f32 v53, v53
    v_exp_f32 v54, v54
    v_exp_f32 v55, v55
    v_mfma_f32_32x32x16_bf16 v[96:111], v[144:147], v[80:83], v[96:111]
    v_exp_f32 v56, v56
    v_exp_f32 v57, v57
    v_exp_f32 v58, v58
    v_exp_f32 v59, v59
    v_mfma_f32_32x32x16_bf16 v[96:111], v[148:151], v[84:87], v[96:111]
    v_exp_f32 v60, v60
    v_exp_f32 v61, v61
    v_exp_f32 v62, v62
    v_exp_f32 v63, v63
    v_cvt_pk_bf16_f32 v88, v48, v49
    v_cvt_pk_bf16_f32 v89, v50, v51
    v_cvt_pk_bf16_f32 v90, v52, v53
    v_cvt_pk_bf16_f32 v91, v54, v55
    v_cvt_pk_bf16_f32 v92, v56, v57
    v_cvt_pk_bf16_f32 v93, v58, v59
    v_cvt_pk_bf16_f32 v94, v60, v61
    v_cvt_pk_bf16_f32 v95, v62, v63
    s_waitcnt lgkmcnt(0)
    s_mov_b64 exec, s[42:43]
    ds_read_b128 v[144:147], v163 offset:33280
    ds_read_b128 v[148:151], v163 offset:33920
    s_mov_b64 exec, -1
    ds_read_b128 v[112:115], v5 offset:35840
    s_mov_b64 exec, s[40:41]
    ds_read_b64 v[116:117], v1 offset:36864
    s_mov_b64 exec, -1
    v_mfma_f32_32x32x16_bf16 v[48:63], v[120:123], v[8:11], v[16:31]
    v_exp_f32 v32, v32
    v_exp_f32 v33, v33
    v_exp_f32 v34, v34
    v_exp_f32 v35, v35
    v_mfma_f32_32x32x16_bf16 v[48:63], v[124:127], v[12:15], v[48:63]
    v_exp_f32 v36, v36
    v_exp_f32 v37, v37
    v_exp_f32 v38, v38
    v_exp_f32 v39, v39
    v_mfma_f32_32x32x16_bf16 v[96:111], v[152:155], v[88:91], v[96:111]
    v_exp_f32 v40, v40
    v_exp_f32 v41, v41
    v_exp_f32 v42, v42
    v_exp_f32 v43, v43
    v_mfma_f32_32x32x16_bf16 v[96:111], v[156:159], v[92:95], v[96:111]
    v_exp_f32 v44, v44
    v_exp_f32 v45, v45
    v_exp_f32 v46, v46
    v_exp_f32 v47, v47
    v_cvt_pk_bf16_f32 v80, v32, v33
    v_cvt_pk_bf16_f32 v81, v34, v35
    v_cvt_pk_bf16_f32 v82, v36, v37
    v_cvt_pk_bf16_f32 v83, v38, v39
    v_cvt_pk_bf16_f32 v84, v40, v41
    v_cvt_pk_bf16_f32 v85, v42, v43
    v_cvt_pk_bf16_f32 v86, v44, v45
    v_cvt_pk_bf16_f32 v87, v46, v47
    s_waitcnt lgkmcnt(0)
    s_mov_b64 exec, s[42:43]
    ds_read_b128 v[152:155], v163 offset:34560
    ds_read_b128 v[156:159], v163 offset:35200
    s_mov_b64 exec, -1
    ds_read_b128 v[120:123], v5 offset:37120
    s_mov_b64 exec, s[40:41]
    ds_read_b64 v[124:125], v1 offset:38144
    s_mov_b64 exec, -1
    v_mfma_f32_32x32x16_bf16 v[32:47], v[112:115], v[8:11], v[16:31]
    v_exp_f32 v48, v48
    v_exp_f32 v49, v49
    v_exp_f32 v50, v50
    v_exp_f32 v51, v51
    v_mfma_f32_32x32x16_bf16 v[32:47], v[116:119], v[12:15], v[32:47]
    v_exp_f32 v52, v52
    v_exp_f32 v53, v53
    v_exp_f32 v54, v54
    v_exp_f32 v55, v55
    v_mfma_f32_32x32x16_bf16 v[96:111], v[144:147], v[80:83], v[96:111]
    v_exp_f32 v56, v56
    v_exp_f32 v57, v57
    v_exp_f32 v58, v58
    v_exp_f32 v59, v59
    v_mfma_f32_32x32x16_bf16 v[96:111], v[148:151], v[84:87], v[96:111]
    v_exp_f32 v60, v60
    v_exp_f32 v61, v61
    v_exp_f32 v62, v62
    v_exp_f32 v63, v63
    v_cvt_pk_bf16_f32 v88, v48, v49
    v_cvt_pk_bf16_f32 v89, v50, v51
    v_cvt_pk_bf16_f32 v90, v52, v53
    v_cvt_pk_bf16_f32 v91, v54, v55
    v_cvt_pk_bf16_f32 v92, v56, v57
    v_cvt_pk_bf16_f32 v93, v58, v59
    v_cvt_pk_bf16_f32 v94, v60, v61
    v_cvt_pk_bf16_f32 v95, v62, v63
    s_waitcnt lgkmcnt(0)
    s_mov_b64 exec, s[42:43]
    ds_read_b128 v[144:147], v163 offset:35840
    ds_read_b128 v[148:151], v163 offset:36480
    s_mov_b64 exec, -1
    ds_read_b128 v[112:115], v5 offset:38400
    s_mov_b64 exec, s[40:41]
    ds_read_b64 v[116:117], v1 offset:39424
    s_mov_b64 exec, -1
    v_mfma_f32_32x32x16_bf16 v[48:63], v[120:123], v[8:11], v[16:31]
    v_exp_f32 v32, v32
    v_exp_f32 v33, v33
    v_exp_f32 v34, v34
    v_exp_f32 v35, v35
    v_mfma_f32_32x32x16_bf16 v[48:63], v[124:127], v[12:15], v[48:63]
    v_exp_f32 v36, v36
    v_exp_f32 v37, v37
    v_exp_f32 v38, v38
    v_exp_f32 v39, v39
    v_mfma_f32_32x32x16_bf16 v[96:111], v[152:155], v[88:91], v[96:111]
    v_exp_f32 v40, v40
    v_exp_f32 v41, v41
    v_exp_f32 v42, v42
    v_exp_f32 v43, v43
    v_mfma_f32_32x32x16_bf16 v[96:111], v[156:159], v[92:95], v[96:111]
    v_exp_f32 v44, v44
    v_exp_f32 v45, v45
    v_exp_f32 v46, v46
    v_exp_f32 v47, v47
    v_cvt_pk_bf16_f32 v80, v32, v33
    v_cvt_pk_bf16_f32 v81, v34, v35
    v_cvt_pk_bf16_f32 v82, v36, v37
    v_cvt_pk_bf16_f32 v83, v38, v39
    v_cvt_pk_bf16_f32 v84, v40, v41
    v_cvt_pk_bf16_f32 v85, v42, v43
    v_cvt_pk_bf16_f32 v86, v44, v45
    v_cvt_pk_bf16_f32 v87, v46, v47
    s_waitcnt lgkmcnt(0)
    s_mov_b64 exec, s[42:43]
    ds_read_b128 v[152:155], v163 offset:37120
    ds_read_b128 v[156:159], v163 offset:37760
    s_mov_b64 exec, -1
    ds_read_b128 v[120:123], v5 offset:39680
    s_mov_b64 exec, s[40:41]
    ds_read_b64 v[124:125], v1 offset:40704
    s_mov_b64 exec, -1
    v_mfma_f32_32x32x16_bf16 v[32:47], v[112:115], v[8:11], v[16:31]
    v_exp_f32 v48, v48
    v_exp_f32 v49, v49
    v_exp_f32 v50, v50
    v_exp_f32 v51, v51
    v_mfma_f32_32x32x16_bf16 v[32:47], v[116:119], v[12:15], v[32:47]
    v_exp_f32 v52, v52
    v_exp_f32 v53, v53
    v_exp_f32 v54, v54
    v_exp_f32 v55, v55
    v_mfma_f32_32x32x16_bf16 v[96:111], v[144:147], v[80:83], v[96:111]
    v_exp_f32 v56, v56
    v_exp_f32 v57, v57
    v_exp_f32 v58, v58
    v_exp_f32 v59, v59
    v_mfma_f32_32x32x16_bf16 v[96:111], v[148:151], v[84:87], v[96:111]
    v_exp_f32 v60, v60
    v_exp_f32 v61, v61
    v_exp_f32 v62, v62
    v_exp_f32 v63, v63
    v_cvt_pk_bf16_f32 v88, v48, v49
    v_cvt_pk_bf16_f32 v89, v50, v51
    v_cvt_pk_bf16_f32 v90, v52, v53
    v_cvt_pk_bf16_f32 v91, v54, v55
    v_cvt_pk_bf16_f32 v92, v56, v57
    v_cvt_pk_bf16_f32 v93, v58, v59
    v_cvt_pk_bf16_f32 v94, v60, v61
    v_cvt_pk_bf16_f32 v95, v62, v63
    s_waitcnt lgkmcnt(0)
    s_mov_b64 exec, s[42:43]
    ds_read_b128 v[144:147], v163 offset:38400
    ds_read_b128 v[148:151], v163 offset:39040
    s_mov_b64 exec, -1
    v_mfma_f32_32x32x16_bf16 v[48:63], v[120:123], v[8:11], v[16:31]
    v_exp_f32 v32, v32
    v_exp_f32 v33, v33
    v_exp_f32 v34, v34
    v_exp_f32 v35, v35
    v_mfma_f32_32x32x16_bf16 v[48:63], v[124:127], v[12:15], v[48:63]
    v_exp_f32 v36, v36
    v_exp_f32 v37, v37
    v_exp_f32 v38, v38
    v_exp_f32 v39, v39
    v_mfma_f32_32x32x16_bf16 v[96:111], v[152:155], v[88:91], v[96:111]
    v_exp_f32 v40, v40
    v_exp_f32 v41, v41
    v_exp_f32 v42, v42
    v_exp_f32 v43, v43
    v_mfma_f32_32x32x16_bf16 v[96:111], v[156:159], v[92:95], v[96:111]
    v_exp_f32 v44, v44
    v_exp_f32 v45, v45
    v_exp_f32 v46, v46
    v_exp_f32 v47, v47
    v_cvt_pk_bf16_f32 v80, v32, v33
    v_cvt_pk_bf16_f32 v81, v34, v35
    v_cvt_pk_bf16_f32 v82, v36, v37
    v_cvt_pk_bf16_f32 v83, v38, v39
    v_cvt_pk_bf16_f32 v84, v40, v41
    v_cvt_pk_bf16_f32 v85, v42, v43
    v_cvt_pk_bf16_f32 v86, v44, v45
    v_cvt_pk_bf16_f32 v87, v46, v47
    s_waitcnt lgkmcnt(0)
    s_mov_b64 exec, s[42:43]
    ds_read_b128 v[152:155], v163 offset:39680
    ds_read_b128 v[156:159], v163 offset:40320
    s_mov_b64 exec, -1
    v_exp_f32 v48, v48
    v_exp_f32 v49, v49
    v_exp_f32 v50, v50
    v_exp_f32 v51, v51
    v_exp_f32 v52, v52
    v_exp_f32 v53, v53
    v_exp_f32 v54, v54
    v_exp_f32 v55, v55
    v_mfma_f32_32x32x16_bf16 v[96:111], v[144:147], v[80:83], v[96:111]
    v_exp_f32 v56, v56
    v_exp_f32 v57, v57
    v_exp_f32 v58, v58
    v_exp_f32 v59, v59
    v_mfma_f32_32x32x16_bf16 v[96:111], v[148:151], v[84:87], v[96:111]
    v_exp_f32 v60, v60
    v_exp_f32 v61, v61
    v_exp_f32 v62, v62
    v_exp_f32 v63, v63
    v_cvt_pk_bf16_f32 v88, v48, v49
    v_cvt_pk_bf16_f32 v89, v50, v51
    v_cvt_pk_bf16_f32 v90, v52, v53
    v_cvt_pk_bf16_f32 v91, v54, v55
    v_cvt_pk_bf16_f32 v92, v56, v57
    v_cvt_pk_bf16_f32 v93, v58, v59
    v_cvt_pk_bf16_f32 v94, v60, v61
    v_cvt_pk_bf16_f32 v95, v62, v63
    s_waitcnt lgkmcnt(0)
    v_mfma_f32_32x32x16_bf16 v[96:111], v[152:155], v[88:91], v[96:111]
    v_mfma_f32_32x32x16_bf16 v[96:111], v[156:159], v[92:95], v[96:111]
    s_nop 15
    s_nop 3
    v_cmp_gt_u32 vcc, 32, v2
    s_nop 1
    v_cndmask_b32 v160, v104, v108, vcc
    v_rcp_f32 v160, v160
    s_nop 0
    v_mul_f32 v96, v96, v160
    v_mul_f32 v97, v97, v160
    v_mul_f32 v98, v98, v160
    v_mul_f32 v99, v99, v160
    v_mul_f32 v100, v100, v160
    v_mul_f32 v101, v101, v160
    v_mul_f32 v102, v102, v160
    v_mul_f32 v103, v103, v160
    v_mul_f32 v104, v104, v160
    v_mul_f32 v105, v105, v160
    v_mul_f32 v106, v106, v160
    v_mul_f32 v107, v107, v160
    v_mul_f32 v108, v108, v160
    v_mul_f32 v109, v109, v160
    v_mul_f32 v110, v110, v160
    v_mul_f32 v111, v111, v160
    v_cvt_pk_bf16_f32 v80, v96, v97
    v_cvt_pk_bf16_f32 v81, v98, v99
    v_cvt_pk_bf16_f32 v82, v100, v101
    v_cvt_pk_bf16_f32 v83, v102, v103
    v_cvt_pk_bf16_f32 v84, v104, v105
    v_cvt_pk_bf16_f32 v85, v106, v107
    v_cvt_pk_bf16_f32 v86, v108, v109
    v_cvt_pk_bf16_f32 v87, v110, v111
    s_mul_i32 s31, s6, 20
    s_mul_i32 s32, s10, 40960
    v_lshrrev_b32 v4, 5, v2
    v_and_b32 v5, 31, v2
    v_lshlrev_b32 v5, 4, v5
    s_add_u32 s35, s31, 0
    v_lshl_add_u32 v6, v4, 2, s35
    v_lshrrev_b32 v7, 4, v6
    v_lshl_add_u32 v7, v7, 10, v5
    v_bfe_u32 v1, v6, 2, 1
    v_lshl_add_u32 v7, v1, 9, v7
    v_bfe_u32 v1, v6, 3, 1
    v_lshl_add_u32 v7, v1, 3, v7
    buffer_store_dwordx2 v[80:81], v7, s[24:27], s32 offen
    s_nop 1
    s_add_u32 s35, s31, 8
    v_lshl_add_u32 v6, v4, 2, s35
    v_lshrrev_b32 v7, 4, v6
    v_lshl_add_u32 v7, v7, 10, v5
    v_bfe_u32 v1, v6, 2, 1
    v_lshl_add_u32 v7, v1, 9, v7
    v_bfe_u32 v1, v6, 3, 1
    v_lshl_add_u32 v7, v1, 3, v7
    buffer_store_dwordx2 v[82:83], v7, s[24:27], s32 offen
    s_nop 1
    s_add_u32 s35, s31, 16
    v_lshl_add_u32 v6, v4, 2, s35
    v_lshrrev_b32 v7, 4, v6
    v_lshl_add_u32 v7, v7, 10, v5
    v_bfe_u32 v1, v6, 2, 1
    v_lshl_add_u32 v7, v1, 9, v7
    v_bfe_u32 v1, v6, 3, 1
    v_lshl_add_u32 v7, v1, 3, v7
    v_mov_b32 v1, 0x40000000
    v_cndmask_b32 v7, v1, v7, vcc
    buffer_store_dwordx2 v[84:85], v7, s[24:27], s32 offen
    s_nop 1
L_att_end:
    s_endpgm
.globl wo_kernel
.p2align 8
.type wo_kernel,@function
wo_kernel:
    s_load_dwordx2 s[4:5], s[0:1], 72
    s_cmp_ge_u32 s2, 256
    s_cbranch_scc1 L_wo_kernel_end
    s_and_b32 s6, s2, 7
    s_lshr_b32 s7, s2, 3
    s_lshr_b32 s8, s6, 1
    s_lshl_b32 s8, s8, 4
    s_lshr_b32 s9, s7, 1
    s_add_u32 s8, s8, s9
    s_and_b32 s9, s6, 1
    s_lshl_b32 s9, s9, 1
    s_and_b32 s7, s7, 1
    s_add_u32 s9, s9, s7
    v_lshrrev_b32 v1, 6, v0
    v_and_b32 v0, 63, v0
    s_nop 0
    v_readfirstlane_b32 s10, v1
    v_and_b32 v1, 31, v0
    v_lshrrev_b32 v2, 5, v0
    v_lshlrev_b32 v3, 4, v0
    s_waitcnt lgkmcnt(0)
    s_add_u32 s12, s4, 0x2000000
    s_addc_u32 s13, s5, 0
    s_and_b32 s13, s13, 0xffff
    s_mov_b32 s14, 0x280000
    s_mov_b32 s15, 0x00020000
    s_add_u32 s16, s4, 0x400000
    s_addc_u32 s17, s5, 0
    s_and_b32 s17, s17, 0xffff
    s_mov_b32 s18, 0xc8000
    s_mov_b32 s19, 0x00020000
    s_add_u32 s20, s4, 0x1300000
    s_addc_u32 s21, s5, 0
    s_and_b32 s21, s21, 0xffff
    s_mov_b32 s22, 0x50000
    s_mov_b32 s23, 0x00020000
    s_add_u32 s24, s4, 0x1000000
    s_addc_u32 s25, s5, 0
    s_and_b32 s25, s25, 0xffff
    s_mov_b32 s26, 0x280000
    s_mov_b32 s27, 0x00020000
    s_mul_i32 s34, s10, 10240
    s_mul_i32 s32, s8, 40960
    s_add_u32 s32, s32, s34
    v_add_u32 v4, s32, v3
    s_mul_i32 s33, s9, 204800
    s_add_u32 s33, s33, s34
    v_add_u32 v5, s33, v3
    v_add_u32 v6, 0xa000, v5
    v_add_u32 v7, 0x14000, v5
    v_add_u32 v8, 0x1e000, v5
    v_add_u32 v9, 0x28000, v5
    s_mov_b32 s40, 0x0
    buffer_load_dwordx4 a[0:3], v4, s[12:15], s40 offen offset:0
    buffer_load_dwordx4 a[4:7], v5, s[16:19], s40 offen offset:0
    buffer_load_dwordx4 a[8:11], v6, s[16:19], s40 offen offset:0
    buffer_load_dwordx4 a[12:15], v7, s[16:19], s40 offen offset:0
    buffer_load_dwordx4 a[16:19], v8, s[16:19], s40 offen offset:0
    buffer_load_dwordx4 a[20:23], v9, s[16:19], s40 offen offset:0
    buffer_load_dwordx4 a[24:27], v4, s[12:15], s40 offen offset:1024
    buffer_load_dwordx4 a[28:31], v5, s[16:19], s40 offen offset:1024
    buffer_load_dwordx4 a[32:35], v6, s[16:19], s40 offen offset:1024
    buffer_load_dwordx4 a[36:39], v7, s[16:19], s40 offen offset:1024
    buffer_load_dwordx4 a[40:43], v8, s[16:19], s40 offen offset:1024
    buffer_load_dwordx4 a[44:47], v9, s[16:19], s40 offen offset:1024
    buffer_load_dwordx4 a[48:51], v4, s[12:15], s40 offen offset:2048
    buffer_load_dwordx4 a[52:55], v5, s[16:19], s40 offen offset:2048
    buffer_load_dwordx4 a[56:59], v6, s[16:19], s40 offen offset:2048
    buffer_load_dwordx4 a[60:63], v7, s[16:19], s40 offen offset:2048
    buffer_load_dwordx4 a[64:67], v8, s[16:19], s40 offen offset:2048
    buffer_load_dwordx4 a[68:71], v9, s[16:19], s40 offen offset:2048
    buffer_load_dwordx4 a[72:75], v4, s[12:15], s40 offen offset:3072
    buffer_load_dwordx4 a[76:79], v5, s[16:19], s40 offen offset:3072
    buffer_load_dwordx4 a[80:83], v6, s[16:19], s40 offen offset:3072
    buffer_load_dwordx4 a[84:87], v7, s[16:19], s40 offen offset:3072
    buffer_load_dwordx4 a[88:91], v8, s[16:19], s40 offen offset:3072
    buffer_load_dwordx4 a[92:95], v9, s[16:19], s40 offen offset:3072
    s_mov_b32 s40, 0x1000
    buffer_load_dwordx4 a[96:99], v4, s[12:15], s40 offen offset:0
    buffer_load_dwordx4 a[100:103], v5, s[16:19], s40 offen offset:0
    buffer_load_dwordx4 a[104:107], v6, s[16:19], s40 offen offset:0
    buffer_load_dwordx4 a[108:111], v7, s[16:19], s40 offen offset:0
    buffer_load_dwordx4 a[112:115], v8, s[16:19], s40 offen offset:0
    buffer_load_dwordx4 a[116:119], v9, s[16:19], s40 offen offset:0
    buffer_load_dwordx4 a[120:123], v4, s[12:15], s40 offen offset:1024
    buffer_load_dwordx4 a[124:127], v5, s[16:19], s40 offen offset:1024
    buffer_load_dwordx4 a[128:131], v6, s[16:19], s40 offen offset:1024
    buffer_load_dwordx4 a[132:135], v7, s[16:19], s40 offen offset:1024
    buffer_load_dwordx4 a[136:139], v8, s[16:19], s40 offen offset:1024
    buffer_load_dwordx4 a[140:143], v9, s[16:19], s40 offen offset:1024
    buffer_load_dwordx4 a[144:147], v4, s[12:15], s40 offen offset:2048
    buffer_load_dwordx4 a[148:151], v5, s[16:19], s40 offen offset:2048
    buffer_load_dwordx4 a[152:155], v6, s[16:19], s40 offen offset:2048
    buffer_load_dwordx4 a[156:159], v7, s[16:19], s40 offen offset:2048
    buffer_load_dwordx4 a[160:163], v8, s[16:19], s40 offen offset:2048
    buffer_load_dwordx4 a[164:167], v9, s[16:19], s40 offen offset:2048
    buffer_load_dwordx4 a[168:171], v4, s[12:15], s40 offen offset:3072
    buffer_load_dwordx4 a[172:175], v5, s[16:19], s40 offen offset:3072
    buffer_load_dwordx4 a[176:179], v6, s[16:19], s40 offen offset:3072
    buffer_load_dwordx4 a[180:183], v7, s[16:19], s40 offen offset:3072
    buffer_load_dwordx4 a[184:187], v8, s[16:19], s40 offen offset:3072
    buffer_load_dwordx4 a[188:191], v9, s[16:19], s40 offen offset:3072
    s_mov_b32 s40, 0x2000
    buffer_load_dwordx4 a[192:195], v4, s[12:15], s40 offen offset:0
    buffer_load_dwordx4 a[196:199], v5, s[16:19], s40 offen offset:0
    buffer_load_dwordx4 a[200:203], v6, s[16:19], s40 offen offset:0
    buffer_load_dwordx4 a[204:207], v7, s[16:19], s40 offen offset:0
    buffer_load_dwordx4 a[208:211], v8, s[16:19], s40 offen offset:0
    buffer_load_dwordx4 a[212:215], v9, s[16:19], s40 offen offset:0
    buffer_load_dwordx4 a[216:219], v4, s[12:15], s40 offen offset:1024
    buffer_load_dwordx4 a[220:223], v5, s[16:19], s40 offen offset:1024
    buffer_load_dwordx4 a[224:227], v6, s[16:19], s40 offen offset:1024
    buffer_load_dwordx4 a[228:231], v7, s[16:19], s40 offen offset:1024
    buffer_load_dwordx4 a[232:235], v8, s[16:19], s40 offen offset:1024
    buffer_load_dwordx4 a[236:239], v9, s[16:19], s40 offen offset:1024
    s_mul_i32 s38, s9, 5
    s_add_u32 s36, s38, s10
    s_add_u32 s37, s38, 4
    s_mul_i32 s39, s8, 40
    s_lshl_b32 s41, s36, 1
    s_add_u32 s41, s41, s39
    s_lshl_b32 s41, s41, 10
    s_lshl_b32 s42, s37, 1
    s_add_u32 s42, s42, s39
    s_lshl_b32 s42, s42, 10
    s_waitcnt vmcnt(54)
    v_mfma_f32_32x32x16_bf16 v[128:143], a[4:7], a[0:3], 0
    v_mfma_f32_32x32x16_bf16 v[144:159], a[8:11], a[0:3], 0
    v_mfma_f32_32x32x16_bf16 v[160:175], a[12:15], a[0:3], 0
    v_mfma_f32_32x32x16_bf16 v[176:191], a[16:19], a[0:3], 0
    v_mfma_f32_32x32x16_bf16 v[192:207], a[20:23], a[0:3], 0
    buffer_load_dwordx4 v[12:15], v3, s[24:27], s41 offen
    buffer_load_dwordx4 v[16:19], v3, s[24:27], s41 offen offset:1024
    buffer_load_dwordx4 v[20:23], v3, s[24:27], s42 offen
    buffer_load_dwordx4 v[24:27], v3, s[24:27], s42 offen offset:1024
    s_waitcnt vmcnt(52)
    v_mfma_f32_32x32x16_bf16 v[128:143], a[28:31], a[24:27], v[128:143]
    v_mfma_f32_32x32x16_bf16 v[144:159], a[32:35], a[24:27], v[144:159]
    v_mfma_f32_32x32x16_bf16 v[160:175], a[36:39], a[24:27], v[160:175]
    v_mfma_f32_32x32x16_bf16 v[176:191], a[40:43], a[24:27], v[176:191]
    v_mfma_f32_32x32x16_bf16 v[192:207], a[44:47], a[24:27], v[192:207]
    s_waitcnt vmcnt(46)
    v_mfma_f32_32x32x16_bf16 v[128:143], a[52:55], a[48:51], v[128:143]
    v_mfma_f32_32x32x16_bf16 v[144:159], a[56:59], a[48:51], v[144:159]
    v_mfma_f32_32x32x16_bf16 v[160:175], a[60:63], a[48:51], v[160:175]
    v_mfma_f32_32x32x16_bf16 v[176:191], a[64:67], a[48:51], v[176:191]
    v_mfma_f32_32x32x16_bf16 v[192:207], a[68:71], a[48:51], v[192:207]
    s_waitcnt vmcnt(40)
    v_mfma_f32_32x32x16_bf16 v[128:143], a[76:79], a[72:75], v[128:143]
    v_mfma_f32_32x32x16_bf16 v[144:159], a[80:83], a[72:75], v[144:159]
    v_mfma_f32_32x32x16_bf16 v[160:175], a[84:87], a[72:75], v[160:175]
    v_mfma_f32_32x32x16_bf16 v[176:191], a[88:91], a[72:75], v[176:191]
    v_mfma_f32_32x32x16_bf16 v[192:207], a[92:95], a[72:75], v[192:207]
    s_waitcnt vmcnt(34)
    v_mfma_f32_32x32x16_bf16 v[128:143], a[100:103], a[96:99], v[128:143]
    v_mfma_f32_32x32x16_bf16 v[144:159], a[104:107], a[96:99], v[144:159]
    v_mfma_f32_32x32x16_bf16 v[160:175], a[108:111], a[96:99], v[160:175]
    v_mfma_f32_32x32x16_bf16 v[176:191], a[112:115], a[96:99], v[176:191]
    v_mfma_f32_32x32x16_bf16 v[192:207], a[116:119], a[96:99], v[192:207]
    s_waitcnt vmcnt(28)
    v_mfma_f32_32x32x16_bf16 v[128:143], a[124:127], a[120:123], v[128:143]
    v_mfma_f32_32x32x16_bf16 v[144:159], a[128:131], a[120:123], v[144:159]
    v_mfma_f32_32x32x16_bf16 v[160:175], a[132:135], a[120:123], v[160:175]
    v_mfma_f32_32x32x16_bf16 v[176:191], a[136:139], a[120:123], v[176:191]
    v_mfma_f32_32x32x16_bf16 v[192:207], a[140:143], a[120:123], v[192:207]
    s_waitcnt vmcnt(22)
    v_mfma_f32_32x32x16_bf16 v[128:143], a[148:151], a[144:147], v[128:143]
    v_mfma_f32_32x32x16_bf16 v[144:159], a[152:155], a[144:147], v[144:159]
    v_mfma_f32_32x32x16_bf16 v[160:175], a[156:159], a[144:147], v[160:175]
    v_mfma_f32_32x32x16_bf16 v[176:191], a[160:163], a[144:147], v[176:191]
    v_mfma_f32_32x32x16_bf16 v[192:207], a[164:167], a[144:147], v[192:207]
    s_waitcnt vmcnt(16)
    v_mfma_f32_32x32x16_bf16 v[128:143], a[172:175], a[168:171], v[128:143]
    v_mfma_f32_32x32x16_bf16 v[144:159], a[176:179], a[168:171], v[144:159]
    v_mfma_f32_32x32x16_bf16 v[160:175], a[180:183], a[168:171], v[160:175]
    v_mfma_f32_32x32x16_bf16 v[176:191], a[184:187], a[168:171], v[176:191]
    v_mfma_f32_32x32x16_bf16 v[192:207], a[188:191], a[168:171], v[192:207]
    s_waitcnt vmcnt(10)
    v_mfma_f32_32x32x16_bf16 v[128:143], a[196:199], a[192:195], v[128:143]
    v_mfma_f32_32x32x16_bf16 v[144:159], a[200:203], a[192:195], v[144:159]
    v_mfma_f32_32x32x16_bf16 v[160:175], a[204:207], a[192:195], v[160:175]
    v_mfma_f32_32x32x16_bf16 v[176:191], a[208:211], a[192:195], v[176:191]
    v_mfma_f32_32x32x16_bf16 v[192:207], a[212:215], a[192:195], v[192:207]
    s_waitcnt vmcnt(4)
    v_mfma_f32_32x32x16_bf16 v[128:143], a[220:223], a[216:219], v[128:143]
    v_mfma_f32_32x32x16_bf16 v[144:159], a[224:227], a[216:219], v[144:159]
    v_mfma_f32_32x32x16_bf16 v[160:175], a[228:231], a[216:219], v[160:175]
    v_mfma_f32_32x32x16_bf16 v[176:191], a[232:235], a[216:219], v[176:191]
    v_mfma_f32_32x32x16_bf16 v[192:207], a[236:239], a[216:219], v[192:207]
    s_waitcnt vmcnt(0)
    s_nop 15
    s_mul_i32 s43, s10, 20480
    v_add_u32 v10, s43, v3
    ds_write_b128 v10, v[128:131] offset:0
    ds_write_b128 v10, v[132:135] offset:1024
    ds_write_b128 v10, v[136:139] offset:2048
    ds_write_b128 v10, v[140:143] offset:3072
    ds_write_b128 v10, v[144:147] offset:4096
    ds_write_b128 v10, v[148:151] offset:5120
    ds_write_b128 v10, v[152:155] offset:6144
    ds_write_b128 v10, v[156:159] offset:7168
    ds_write_b128 v10, v[160:163] offset:8192
    ds_write_b128 v10, v[164:167] offset:9216
    ds_write_b128 v10, v[168:171] offset:10240
    ds_write_b128 v10, v[172:175] offset:11264
    ds_write_b128 v10, v[176:179] offset:12288
    ds_write_b128 v10, v[180:183] offset:13312
    ds_write_b128 v10, v[184:187] offset:14336
    ds_write_b128 v10, v[188:191] offset:15360
    ds_write_b128 v10, v[192:195] offset:16384
    ds_write_b128 v10, v[196:199] offset:17408
    ds_write_b128 v10, v[200:203] offset:18432
    ds_write_b128 v10, v[204:207] offset:19456
    s_waitcnt lgkmcnt(0)
    s_barrier
    s_lshl_b32 s43, s10, 12
    v_add_u32 v11, s43, v3
    ds_read_b128 v[32:35], v11 offset:0
    ds_read_b128 v[36:39], v11 offset:1024
    ds_read_b128 v[40:43], v11 offset:2048
    ds_read_b128 v[44:47], v11 offset:3072
    ds_read_b128 v[48:51], v11 offset:20480
    ds_read_b128 v[52:55], v11 offset:21504
    ds_read_b128 v[56:59], v11 offset:22528
    ds_read_b128 v[60:63], v11 offset:23552
    ds_read_b128 v[64:67], v11 offset:40960
    ds_read_b128 v[68:71], v11 offset:41984
    ds_read_b128 v[72:75], v11 offset:43008
    ds_read_b128 v[76:79], v11 offset:44032
    ds_read_b128 v[80:83], v11 offset:61440
    ds_read_b128 v[84:87], v11 offset:62464
    ds_read_b128 v[88:91], v11 offset:63488
    ds_read_b128 v[92:95], v11 offset:64512
    s_waitcnt lgkmcnt(0)
    v_pk_add_f32 v[32:33], v[32:33], v[48:49]
    v_pk_add_f32 v[64:65], v[64:65], v[80:81]
    v_pk_add_f32 v[34:35], v[34:35], v[50:51]
    v_pk_add_f32 v[66:67], v[66:67], v[82:83]
    v_pk_add_f32 v[36:37], v[36:37], v[52:53]
    v_pk_add_f32 v[68:69], v[68:69], v[84:85]
    v_pk_add_f32 v[38:39], v[38:39], v[54:55]
    v_pk_add_f32 v[70:71], v[70:71], v[86:87]
    v_pk_add_f32 v[40:41], v[40:41], v[56:57]
    v_pk_add_f32 v[72:73], v[72:73], v[88:89]
    v_pk_add_f32 v[42:43], v[42:43], v[58:59]
    v_pk_add_f32 v[74:75], v[74:75], v[90:91]
    v_pk_add_f32 v[44:45], v[44:45], v[60:61]
    v_pk_add_f32 v[76:77], v[76:77], v[92:93]
    v_pk_add_f32 v[46:47], v[46:47], v[62:63]
    v_pk_add_f32 v[78:79], v[78:79], v[94:95]
    v_pk_add_f32 v[32:33], v[32:33], v[64:65]
    v_pk_add_f32 v[34:35], v[34:35], v[66:67]
    v_pk_add_f32 v[36:37], v[36:37], v[68:69]
    v_pk_add_f32 v[38:39], v[38:39], v[70:71]
    v_pk_add_f32 v[40:41], v[40:41], v[72:73]
    v_pk_add_f32 v[42:43], v[42:43], v[74:75]
    v_pk_add_f32 v[44:45], v[44:45], v[76:77]
    v_pk_add_f32 v[46:47], v[46:47], v[78:79]
    v_cvt_pk_bf16_f32 v48, v32, v33
    v_cvt_pk_bf16_f32 v49, v34, v35
    v_cvt_pk_bf16_f32 v50, v36, v37
    v_cvt_pk_bf16_f32 v51, v38, v39
    v_cvt_pk_bf16_f32 v52, v40, v41
    v_cvt_pk_bf16_f32 v53, v42, v43
    v_cvt_pk_bf16_f32 v54, v44, v45
    v_cvt_pk_bf16_f32 v55, v46, v47
    v_lshlrev_b32 v32, 16, v48
    v_and_b32 v33, 0xffff0000, v48
    v_lshlrev_b32 v64, 16, v12
    v_and_b32 v65, 0xffff0000, v12
    v_lshlrev_b32 v34, 16, v49
    v_and_b32 v35, 0xffff0000, v49
    v_lshlrev_b32 v66, 16, v13
    v_and_b32 v67, 0xffff0000, v13
    v_lshlrev_b32 v36, 16, v50
    v_and_b32 v37, 0xffff0000, v50
    v_lshlrev_b32 v68, 16, v14
    v_and_b32 v69, 0xffff0000, v14
    v_lshlrev_b32 v38, 16, v51
    v_and_b32 v39, 0xffff0000, v51
    v_lshlrev_b32 v70, 16, v15
    v_and_b32 v71, 0xffff0000, v15
    v_lshlrev_b32 v40, 16, v52
    v_and_b32 v41, 0xffff0000, v52
    v_lshlrev_b32 v72, 16, v16
    v_and_b32 v73, 0xffff0000, v16
    v_lshlrev_b32 v42, 16, v53
    v_and_b32 v43, 0xffff0000, v53
    v_lshlrev_b32 v74, 16, v17
    v_and_b32 v75, 0xffff0000, v17
    v_lshlrev_b32 v44, 16, v54
    v_and_b32 v45, 0xffff0000, v54
    v_lshlrev_b32 v76, 16, v18
    v_and_b32 v77, 0xffff0000, v18
    v_lshlrev_b32 v46, 16, v55
    v_and_b32 v47, 0xffff0000, v55
    v_lshlrev_b32 v78, 16, v19
    v_and_b32 v79, 0xffff0000, v19
    v_pk_add_f32 v[32:33], v[32:33], v[64:65]
    v_pk_add_f32 v[34:35], v[34:35], v[66:67]
    v_pk_add_f32 v[36:37], v[36:37], v[68:69]
    v_pk_add_f32 v[38:39], v[38:39], v[70:71]
    v_pk_add_f32 v[40:41], v[40:41], v[72:73]
    v_pk_add_f32 v[42:43], v[42:43], v[74:75]
    v_pk_add_f32 v[44:45], v[44:45], v[76:77]
    v_pk_add_f32 v[46:47], v[46:47], v[78:79]
    v_cvt_pk_bf16_f32 v48, v32, v33
    v_cvt_pk_bf16_f32 v49, v34, v35
    v_cvt_pk_bf16_f32 v50, v36, v37
    v_cvt_pk_bf16_f32 v51, v38, v39
    v_cvt_pk_bf16_f32 v52, v40, v41
    v_cvt_pk_bf16_f32 v53, v42, v43
    v_cvt_pk_bf16_f32 v54, v44, v45
    v_cvt_pk_bf16_f32 v55, v46, v47
    buffer_store_dwordx4 v[48:51], v3, s[24:27], s41 offen
    buffer_store_dwordx4 v[52:55], v3, s[24:27], s41 offen offset:1024
    v_mov_b32 v100, 0x3f803f80
    v_mov_b32 v102, 0
    v_mov_b32 v103, 0
    v_dot2_f32_bf16 v102, v48, v100, v102
    v_dot2_f32_bf16 v103, v48, v48, v103
    v_dot2_f32_bf16 v102, v49, v100, v102
    v_dot2_f32_bf16 v103, v49, v49, v103
    v_dot2_f32_bf16 v102, v50, v100, v102
    v_dot2_f32_bf16 v103, v50, v50, v103
    v_dot2_f32_bf16 v102, v51, v100, v102
    v_dot2_f32_bf16 v103, v51, v51, v103
    v_dot2_f32_bf16 v102, v52, v100, v102
    v_dot2_f32_bf16 v103, v52, v52, v103
    v_dot2_f32_bf16 v102, v53, v100, v102
    v_dot2_f32_bf16 v103, v53, v53, v103
    v_dot2_f32_bf16 v102, v54, v100, v102
    v_dot2_f32_bf16 v103, v54, v54, v103
    v_dot2_f32_bf16 v102, v55, v100, v102
    v_dot2_f32_bf16 v103, v55, v55, v103
    s_nop 4
    v_mov_b32 v104, v102
    v_mov_b32 v105, v103
    s_nop 1
    v_permlane32_swap_b32 v104, v102
    v_permlane32_swap_b32 v105, v103
    s_nop 1
    v_add_f32 v102, v102, v104
    v_add_f32 v103, v103, v105
    s_lshl_b32 s46, s8, 8
    v_lshl_add_u32 v96, v1, 3, s46
    s_lshl_b32 s47, s36, 14
    buffer_store_dwordx2 v[102:103], v96, s[20:23], s47 offen
    s_nop 1
    s_cmp_lg_u32 s10, 3
    s_cbranch_scc1 L_wo_kernel_end
    v_add_u32 v11, 16384, v3
    ds_read_b128 v[32:35], v11 offset:0
    ds_read_b128 v[36:39], v11 offset:1024
    ds_read_b128 v[40:43], v11 offset:2048
    ds_read_b128 v[44:47], v11 offset:3072
    ds_read_b128 v[48:51], v11 offset:20480
    ds_read_b128 v[52:55], v11 offset:21504
    ds_read_b128 v[56:59], v11 offset:22528
    ds_read_b128 v[60:63], v11 offset:23552
    ds_read_b128 v[64:67], v11 offset:40960
    ds_read_b128 v[68:71], v11 offset:41984
    ds_read_b128 v[72:75], v11 offset:43008
    ds_read_b128 v[76:79], v11 offset:44032
    ds_read_b128 v[80:83], v11 offset:61440
    ds_read_b128 v[84:87], v11 offset:62464
    ds_read_b128 v[88:91], v11 offset:63488
    ds_read_b128 v[92:95], v11 offset:64512
    s_waitcnt lgkmcnt(0)
    v_pk_add_f32 v[32:33], v[32:33], v[48:49]
    v_pk_add_f32 v[64:65], v[64:65], v[80:81]
    v_pk_add_f32 v[34:35], v[34:35], v[50:51]
    v_pk_add_f32 v[66:67], v[66:67], v[82:83]
    v_pk_add_f32 v[36:37], v[36:37], v[52:53]
    v_pk_add_f32 v[68:69], v[68:69], v[84:85]
    v_pk_add_f32 v[38:39], v[38:39], v[54:55]
    v_pk_add_f32 v[70:71], v[70:71], v[86:87]
    v_pk_add_f32 v[40:41], v[40:41], v[56:57]
    v_pk_add_f32 v[72:73], v[72:73], v[88:89]
    v_pk_add_f32 v[42:43], v[42:43], v[58:59]
    v_pk_add_f32 v[74:75], v[74:75], v[90:91]
    v_pk_add_f32 v[44:45], v[44:45], v[60:61]
    v_pk_add_f32 v[76:77], v[76:77], v[92:93]
    v_pk_add_f32 v[46:47], v[46:47], v[62:63]
    v_pk_add_f32 v[78:79], v[78:79], v[94:95]
    v_pk_add_f32 v[32:33], v[32:33], v[64:65]
    v_pk_add_f32 v[34:35], v[34:35], v[66:67]
    v_pk_add_f32 v[36:37], v[36:37], v[68:69]
    v_pk_add_f32 v[38:39], v[38:39], v[70:71]
    v_pk_add_f32 v[40:41], v[40:41], v[72:73]
    v_pk_add_f32 v[42:43], v[42:43], v[74:75]
    v_pk_add_f32 v[44:45], v[44:45], v[76:77]
    v_pk_add_f32 v[46:47], v[46:47], v[78:79]
    v_cvt_pk_bf16_f32 v48, v32, v33
    v_cvt_pk_bf16_f32 v49, v34, v35
    v_cvt_pk_bf16_f32 v50, v36, v37
    v_cvt_pk_bf16_f32 v51, v38, v39
    v_cvt_pk_bf16_f32 v52, v40, v41
    v_cvt_pk_bf16_f32 v53, v42, v43
    v_cvt_pk_bf16_f32 v54, v44, v45
    v_cvt_pk_bf16_f32 v55, v46, v47
    v_lshlrev_b32 v32, 16, v48
    v_and_b32 v33, 0xffff0000, v48
    v_lshlrev_b32 v64, 16, v20
    v_and_b32 v65, 0xffff0000, v20
    v_lshlrev_b32 v34, 16, v49
    v_and_b32 v35, 0xffff0000, v49
    v_lshlrev_b32 v66, 16, v21
    v_and_b32 v67, 0xffff0000, v21
    v_lshlrev_b32 v36, 16, v50
    v_and_b32 v37, 0xffff0000, v50
    v_lshlrev_b32 v68, 16, v22
    v_and_b32 v69, 0xffff0000, v22
    v_lshlrev_b32 v38, 16, v51
    v_and_b32 v39, 0xffff0000, v51
    v_lshlrev_b32 v70, 16, v23
    v_and_b32 v71, 0xffff0000, v23
    v_lshlrev_b32 v40, 16, v52
    v_and_b32 v41, 0xffff0000, v52
    v_lshlrev_b32 v72, 16, v24
    v_and_b32 v73, 0xffff0000, v24
    v_lshlrev_b32 v42, 16, v53
    v_and_b32 v43, 0xffff0000, v53
    v_lshlrev_b32 v74, 16, v25
    v_and_b32 v75, 0xffff0000, v25
    v_lshlrev_b32 v44, 16, v54
    v_and_b32 v45, 0xffff0000, v54
    v_lshlrev_b32 v76, 16, v26
    v_and_b32 v77, 0xffff0000, v26
    v_lshlrev_b32 v46, 16, v55
    v_and_b32 v47, 0xffff0000, v55
    v_lshlrev_b32 v78, 16, v27
    v_and_b32 v79, 0xffff0000, v27
    v_pk_add_f32 v[32:33], v[32:33], v[64:65]
    v_pk_add_f32 v[34:35], v[34:35], v[66:67]
    v_pk_add_f32 v[36:37], v[36:37], v[68:69]
    v_pk_add_f32 v[38:39], v[38:39], v[70:71]
    v_pk_add_f32 v[40:41], v[40:41], v[72:73]
    v_pk_add_f32 v[42:43], v[42:43], v[74:75]
    v_pk_add_f32 v[44:45], v[44:45], v[76:77]
    v_pk_add_f32 v[46:47], v[46:47], v[78:79]
    v_cvt_pk_bf16_f32 v48, v32, v33
    v_cvt_pk_bf16_f32 v49, v34, v35
    v_cvt_pk_bf16_f32 v50, v36, v37
    v_cvt_pk_bf16_f32 v51, v38, v39
    v_cvt_pk_bf16_f32 v52, v40, v41
    v_cvt_pk_bf16_f32 v53, v42, v43
    v_cvt_pk_bf16_f32 v54, v44, v45
    v_cvt_pk_bf16_f32 v55, v46, v47
    buffer_store_dwordx4 v[48:51], v3, s[24:27], s42 offen
    buffer_store_dwordx4 v[52:55], v3, s[24:27], s42 offen offset:1024
    v_mov_b32 v100, 0x3f803f80
    v_mov_b32 v102, 0
    v_mov_b32 v103, 0
    v_dot2_f32_bf16 v102, v48, v100, v102
    v_dot2_f32_bf16 v103, v48, v48, v103
    v_dot2_f32_bf16 v102, v49, v100, v102
    v_dot2_f32_bf16 v103, v49, v49, v103
    v_dot2_f32_bf16 v102, v50, v100, v102
    v_dot2_f32_bf16 v103, v50, v50, v103
    v_dot2_f32_bf16 v102, v51, v100, v102
    v_dot2_f32_bf16 v103, v51, v51, v103
    v_dot2_f32_bf16 v102, v52, v100, v102
    v_dot2_f32_bf16 v103, v52, v52, v103
    v_dot2_f32_bf16 v102, v53, v100, v102
    v_dot2_f32_bf16 v103, v53, v53, v103
    v_dot2_f32_bf16 v102, v54, v100, v102
    v_dot2_f32_bf16 v103, v54, v54, v103
    v_dot2_f32_bf16 v102, v55, v100, v102
    v_dot2_f32_bf16 v103, v55, v55, v103
    s_nop 4
    v_mov_b32 v104, v102
    v_mov_b32 v105, v103
    s_nop 1
    v_permlane32_swap_b32 v104, v102
    v_permlane32_swap_b32 v105, v103
    s_nop 1
    v_add_f32 v102, v102, v104
    v_add_f32 v103, v103, v105
    s_lshl_b32 s46, s8, 8
    v_lshl_add_u32 v96, v1, 3, s46
    s_lshl_b32 s47, s37, 14
    buffer_store_dwordx2 v[102:103], v96, s[20:23], s47 offen
    s_nop 1
L_wo_kernel_end:
    s_endpgm
.globl gu_kernel
.p2align 8
.type gu_kernel,@function
gu_kernel:
    s_load_dwordx2 s[4:5], s[0:1], 72
    s_cmp_ge_u32 s2, 224
    s_cbranch_scc1 L_gu_end
    s_and_b32 s6, s2, 7
    s_lshr_b32 s7, s2, 3
    s_mul_hi_u32 s8, s7, 0x24924925
    s_mul_i32 s9, s8, 7
    s_sub_u32 s9, s7, s9
    s_lshr_b32 s7, s6, 1
    s_lshl_b32 s7, s7, 2
    s_add_u32 s8, s8, s7
    s_and_b32 s7, s6, 1
    s_mul_i32 s7, s7, 7
    s_add_u32 s9, s9, s7
    v_lshrrev_b32 v1, 6, v0
    v_and_b32 v0, 63, v0
    s_nop 0
    v_readfirstlane_b32 s10, v1
    v_and_b32 v1, 31, v0
    v_lshrrev_b32 v2, 5, v0
    v_lshlrev_b32 v3, 4, v0
    v_add_u32 v4, 0x10000, v3
    v_add_u32 v5, 0x20000, v3
    s_waitcnt lgkmcnt(0)
    s_add_u32 s12, s4, 0x1000000
    s_addc_u32 s13, s5, 0
    s_and_b32 s13, s13, 0xffff
    s_mov_b32 s14, 0x280000
    s_mov_b32 s15, 0x00020000
    s_add_u32 s16, s4, 0x600000
    s_addc_u32 s17, s5, 0
    s_and_b32 s17, s17, 0xffff
    s_mov_b32 s18, 0x600000
    s_mov_b32 s19, 0x00020000
    s_add_u32 s20, s4, 0x1300000
    s_addc_u32 s21, s5, 0
    s_and_b32 s21, s21, 0xffff
    s_mov_b32 s22, 0x50000
    s_mov_b32 s23, 0x00020000
    s_add_u32 s24, s4, 0xf04000
    s_addc_u32 s25, s5, 0
    s_and_b32 s25, s25, 0xffff
    s_mov_b32 s26, 0x8000
    s_mov_b32 s27, 0x00020000
    s_add_u32 s28, s4, 0x2400000
    s_addc_u32 s29, s5, 0
    s_and_b32 s29, s29, 0xffff
    s_mov_b32 s30, 0x6c0000
    s_mov_b32 s31, 0x00020000
    s_lshl_b32 s11, s9, 2
    s_add_u32 s11, s11, s10
    s_lshl_b32 s33, s8, 2
    s_add_u32 s33, s33, s10
    s_mul_i32 s34, s33, 40960
    s_lshl_b32 s35, s10, 10
    s_mul_i32 s36, s11, 40960
    v_add_u32 v6, s36, v3
    v_add_u32 v7, 0x300000, v6
    s_lshl_b32 s36, s33, 8
    v_lshl_add_u32 v9, v1, 3, s36
    s_lshl_b32 s36, s11, 7
    v_lshl_add_u32 v10, v2, 4, s36
    v_add_u32 v12, 0x4000, v10
    s_lshl_b32 s36, s10, 7
    v_lshl_add_u32 v16, v1, 2, s36
    s_cmp_ge_u32 s11, 54
    s_cbranch_scc1 L_gu_idle
    s_add_u32 s42, s35, 0x0
    s_mov_b32 m0, s42
    s_add_u32 s43, s34, 0x0
    buffer_load_dwordx4 v3, s[12:15], s43 offen lds
    s_mov_b32 s40, 0x0
    buffer_load_dwordx4 a[0:3], v6, s[16:19], s40 offen offset:0
    buffer_load_dwordx4 a[4:7], v7, s[16:19], s40 offen offset:0
    s_add_u32 s42, s35, 0x1000
    s_mov_b32 m0, s42
    s_add_u32 s43, s34, 0x400
    buffer_load_dwordx4 v3, s[12:15], s43 offen lds
    buffer_load_dwordx4 a[8:11], v6, s[16:19], s40 offen offset:1024
    buffer_load_dwordx4 a[12:15], v7, s[16:19], s40 offen offset:1024
    s_add_u32 s42, s35, 0x2000
    s_mov_b32 m0, s42
    s_add_u32 s43, s34, 0x800
    buffer_load_dwordx4 v3, s[12:15], s43 offen lds
    buffer_load_dwordx4 a[16:19], v6, s[16:19], s40 offen offset:2048
    buffer_load_dwordx4 a[20:23], v7, s[16:19], s40 offen offset:2048
    s_add_u32 s42, s35, 0x3000
    s_mov_b32 m0, s42
    s_add_u32 s43, s34, 0xc00
    buffer_load_dwordx4 v3, s[12:15], s43 offen lds
    buffer_load_dwordx4 a[24:27], v6, s[16:19], s40 offen offset:3072
    buffer_load_dwordx4 a[28:31], v7, s[16:19], s40 offen offset:3072
    s_add_u32 s42, s35, 0x4000
    s_mov_b32 m0, s42
    s_add_u32 s43, s34, 0x1000
    buffer_load_dwordx4 v3, s[12:15], s43 offen lds
    s_mov_b32 s40, 0x1000
    buffer_load_dwordx4 a[32:35], v6, s[16:19], s40 offen offset:0
    buffer_load_dwordx4 a[36:39], v7, s[16:19], s40 offen offset:0
    s_add_u32 s42, s35, 0x5000
    s_mov_b32 m0, s42
    s_add_u32 s43, s34, 0x1400
    buffer_load_dwordx4 v3, s[12:15], s43 offen lds
    buffer_load_dwordx4 a[40:43], v6, s[16:19], s40 offen offset:1024
    buffer_load_dwordx4 a[44:47], v7, s[16:19], s40 offen offset:1024
    s_add_u32 s42, s35, 0x6000
    s_mov_b32 m0, s42
    s_add_u32 s43, s34, 0x1800
    buffer_load_dwordx4 v3, s[12:15], s43 offen lds
    buffer_load_dwordx4 a[48:51], v6, s[16:19], s40 offen offset:2048
    buffer_load_dwordx4 a[52:55], v7, s[16:19], s40 offen offset:2048
    s_add_u32 s42, s35, 0x7000
    s_mov_b32 m0, s42
    s_add_u32 s43, s34, 0x1c00
    buffer_load_dwordx4 v3, s[12:15], s43 offen lds
    buffer_load_dwordx4 a[56:59], v6, s[16:19], s40 offen offset:3072
    buffer_load_dwordx4 a[60:63], v7, s[16:19], s40 offen offset:3072
    s_add_u32 s42, s35, 0x8000
    s_mov_b32 m0, s42
    s_add_u32 s43, s34, 0x2000
    buffer_load_dwordx4 v3, s[12:15], s43 offen lds
    s_mov_b32 s40, 0x2000
    buffer_load_dwordx4 a[64:67], v6, s[16:19], s40 offen offset:0
    buffer_load_dwordx4 a[68:71], v7, s[16:19], s40 offen offset:0
    s_add_u32 s42, s35, 0x9000
    s_mov_b32 m0, s42
    s_add_u32 s43, s34, 0x2400
    buffer_load_dwordx4 v3, s[12:15], s43 offen lds
    buffer_load_dwordx4 a[72:75], v6, s[16:19], s40 offen offset:1024
    buffer_load_dwordx4 a[76:79], v7, s[16:19], s40 offen offset:1024
    buffer_load_dwordx4 a[80:83], v6, s[16:19], s40 offen offset:2048
    buffer_load_dwordx4 a[84:87], v7, s[16:19], s40 offen offset:2048
    buffer_load_dwordx4 a[88:91], v6, s[16:19], s40 offen offset:3072
    buffer_load_dwordx4 a[92:95], v7, s[16:19], s40 offen offset:3072
    s_waitcnt vmcnt(6)
    s_barrier
    ds_read_b128 v[20:23], v3 offset:0
    ds_read_b128 v[24:27], v3 offset:1024
    ds_read_b128 v[28:31], v3 offset:2048
    ds_read_b128 v[32:35], v3 offset:3072
    ds_read_b128 v[36:39], v3 offset:4096
    ds_read_b128 v[40:43], v3 offset:5120
    ds_read_b128 v[44:47], v3 offset:6144
    ds_read_b128 v[48:51], v3 offset:7168
    ds_read_b128 v[52:55], v3 offset:8192
    ds_read_b128 v[56:59], v3 offset:9216
    ds_read_b128 v[60:63], v3 offset:10240
    ds_read_b128 v[64:67], v3 offset:11264
    s_waitcnt lgkmcnt(8)
    v_mfma_f32_32x32x16_bf16 v[128:143], a[0:3], v[20:23], 0
    v_mfma_f32_32x32x16_bf16 v[160:175], a[0:3], v[24:27], 0
    v_mfma_f32_32x32x16_bf16 v[192:207], a[0:3], v[28:31], 0
    v_mfma_f32_32x32x16_bf16 v[224:239], a[0:3], v[32:35], 0
    v_mfma_f32_32x32x16_bf16 v[144:159], a[4:7], v[20:23], 0
    v_mfma_f32_32x32x16_bf16 v[176:191], a[4:7], v[24:27], 0
    v_mfma_f32_32x32x16_bf16 v[208:223], a[4:7], v[28:31], 0
    v_mfma_f32_32x32x16_bf16 v[240:255], a[4:7], v[32:35], 0
    s_add_u32 s42, s35, 0xa000
    s_mov_b32 m0, s42
    s_add_u32 s43, s34, 0x2800
    buffer_load_dwordx4 v3, s[12:15], s43 offen lds
    s_add_u32 s42, s35, 0xb000
    s_mov_b32 m0, s42
    s_add_u32 s43, s34, 0x2c00
    buffer_load_dwordx4 v3, s[12:15], s43 offen lds
    s_mov_b32 s40, 0x3000
    buffer_load_dwordx4 a[0:3], v6, s[16:19], s40 offen offset:0
    buffer_load_dwordx4 a[4:7], v7, s[16:19], s40 offen offset:0
    ds_read_b128 v[20:23], v3 offset:12288
    ds_read_b128 v[24:27], v3 offset:13312
    ds_read_b128 v[28:31], v3 offset:14336
    ds_read_b128 v[32:35], v3 offset:15360
    s_waitcnt lgkmcnt(8)
    v_mfma_f32_32x32x16_bf16 v[128:143], a[8:11], v[36:39], v[128:143]
    v_mfma_f32_32x32x16_bf16 v[160:175], a[8:11], v[40:43], v[160:175]
    v_mfma_f32_32x32x16_bf16 v[192:207], a[8:11], v[44:47], v[192:207]
    v_mfma_f32_32x32x16_bf16 v[224:239], a[8:11], v[48:51], v[224:239]
    v_mfma_f32_32x32x16_bf16 v[144:159], a[12:15], v[36:39], v[144:159]
    v_mfma_f32_32x32x16_bf16 v[176:191], a[12:15], v[40:43], v[176:191]
    v_mfma_f32_32x32x16_bf16 v[208:223], a[12:15], v[44:47], v[208:223]
    v_mfma_f32_32x32x16_bf16 v[240:255], a[12:15], v[48:51], v[240:255]
    s_add_u32 s42, s35, 0xc000
    s_mov_b32 m0, s42
    s_add_u32 s43, s34, 0x3000
    buffer_load_dwordx4 v3, s[12:15], s43 offen lds
    s_add_u32 s42, s35, 0xd000
    s_mov_b32 m0, s42
    s_add_u32 s43, s34, 0x3400
    buffer_load_dwordx4 v3, s[12:15], s43 offen lds
    buffer_load_dwordx4 a[8:11], v6, s[16:19], s40 offen offset:1024
    buffer_load_dwordx4 a[12:15], v7, s[16:19], s40 offen offset:1024
    s_mov_b32 s41, 0x0
    buffer_load_dwordx2 v[100:101], v9, s[20:23], s41 offen
    s_mov_b32 s41, 0x4000
    buffer_load_dwordx2 v[102:103], v9, s[20:23], s41 offen
    s_mov_b32 s41, 0x8000
    buffer_load_dwordx2 v[104:105], v9, s[20:23], s41 offen
    s_mov_b32 s41, 0xc000
    buffer_load_dwordx2 v[106:107], v9, s[20:23], s41 offen
    ds_read_b128 v[36:39], v3 offset:16384
    ds_read_b128 v[40:43], v3 offset:17408
    ds_read_b128 v[44:47], v3 offset:18432
    ds_read_b128 v[48:51], v3 offset:19456
    s_waitcnt lgkmcnt(8)
    v_mfma_f32_32x32x16_bf16 v[128:143], a[16:19], v[52:55], v[128:143]
    v_mfma_f32_32x32x16_bf16 v[160:175], a[16:19], v[56:59], v[160:175]
    v_mfma_f32_32x32x16_bf16 v[192:207], a[16:19], v[60:63], v[192:207]
    v_mfma_f32_32x32x16_bf16 v[224:239], a[16:19], v[64:67], v[224:239]
    v_mfma_f32_32x32x16_bf16 v[144:159], a[20:23], v[52:55], v[144:159]
    v_mfma_f32_32x32x16_bf16 v[176:191], a[20:23], v[56:59], v[176:191]
    v_mfma_f32_32x32x16_bf16 v[208:223], a[20:23], v[60:63], v[208:223]
    v_mfma_f32_32x32x16_bf16 v[240:255], a[20:23], v[64:67], v[240:255]
    s_add_u32 s42, s35, 0xe000
    s_mov_b32 m0, s42
    s_add_u32 s43, s34, 0x3800
    buffer_load_dwordx4 v3, s[12:15], s43 offen lds
    s_add_u32 s42, s35, 0xf000
    s_mov_b32 m0, s42
    s_add_u32 s43, s34, 0x3c00
    buffer_load_dwordx4 v3, s[12:15], s43 offen lds
    buffer_load_dwordx4 a[16:19], v6, s[16:19], s40 offen offset:2048
    buffer_load_dwordx4 a[20:23], v7, s[16:19], s40 offen offset:2048
    ds_read_b128 v[52:55], v3 offset:20480
    ds_read_b128 v[56:59], v3 offset:21504
    ds_read_b128 v[60:63], v3 offset:22528
    ds_read_b128 v[64:67], v3 offset:23552
    s_waitcnt lgkmcnt(8)
    v_mfma_f32_32x32x16_bf16 v[128:143], a[24:27], v[20:23], v[128:143]
    v_mfma_f32_32x32x16_bf16 v[160:175], a[24:27], v[24:27], v[160:175]
    v_mfma_f32_32x32x16_bf16 v[192:207], a[24:27], v[28:31], v[192:207]
    v_mfma_f32_32x32x16_bf16 v[224:239], a[24:27], v[32:35], v[224:239]
    v_mfma_f32_32x32x16_bf16 v[144:159], a[28:31], v[20:23], v[144:159]
    v_mfma_f32_32x32x16_bf16 v[176:191], a[28:31], v[24:27], v[176:191]
    v_mfma_f32_32x32x16_bf16 v[208:223], a[28:31], v[28:31], v[208:223]
    v_mfma_f32_32x32x16_bf16 v[240:255], a[28:31], v[32:35], v[240:255]
    s_add_u32 s42, s35, 0x10000
    s_mov_b32 m0, s42
    s_add_u32 s43, s34, 0x4000
    buffer_load_dwordx4 v3, s[12:15], s43 offen lds
    s_add_u32 s42, s35, 0x11000
    s_mov_b32 m0, s42
    s_add_u32 s43, s34, 0x4400
    buffer_load_dwordx4 v3, s[12:15], s43 offen lds
    buffer_load_dwordx4 a[24:27], v6, s[16:19], s40 offen offset:3072
    buffer_load_dwordx4 a[28:31], v7, s[16:19], s40 offen offset:3072
    s_mov_b32 s41, 0x10000
    buffer_load_dwordx2 v[108:109], v9, s[20:23], s41 offen
    s_mov_b32 s41, 0x14000
    buffer_load_dwordx2 v[110:111], v9, s[20:23], s41 offen
    s_mov_b32 s41, 0x18000
    buffer_load_dwordx2 v[112:113], v9, s[20:23], s41 offen
    s_mov_b32 s41, 0x1c000
    buffer_load_dwordx2 v[114:115], v9, s[20:23], s41 offen
    ds_read_b128 v[20:23], v3 offset:24576
    ds_read_b128 v[24:27], v3 offset:25600
    ds_read_b128 v[28:31], v3 offset:26624
    ds_read_b128 v[32:35], v3 offset:27648
    s_waitcnt lgkmcnt(8)
    v_mfma_f32_32x32x16_bf16 v[128:143], a[32:35], v[36:39], v[128:143]
    v_mfma_f32_32x32x16_bf16 v[160:175], a[32:35], v[40:43], v[160:175]
    v_mfma_f32_32x32x16_bf16 v[192:207], a[32:35], v[44:47], v[192:207]
    v_mfma_f32_32x32x16_bf16 v[224:239], a[32:35], v[48:51], v[224:239]
    v_mfma_f32_32x32x16_bf16 v[144:159], a[36:39], v[36:39], v[144:159]
    v_mfma_f32_32x32x16_bf16 v[176:191], a[36:39], v[40:43], v[176:191]
    v_mfma_f32_32x32x16_bf16 v[208:223], a[36:39], v[44:47], v[208:223]
    v_mfma_f32_32x32x16_bf16 v[240:255], a[36:39], v[48:51], v[240:255]
    s_add_u32 s42, s35, 0x12000
    s_mov_b32 m0, s42
    s_add_u32 s43, s34, 0x4800
    buffer_load_dwordx4 v3, s[12:15], s43 offen lds
    s_add_u32 s42, s35, 0x13000
    s_mov_b32 m0, s42
    s_add_u32 s43, s34, 0x4c00
    buffer_load_dwordx4 v3, s[12:15], s43 offen lds
    s_mov_b32 s40, 0x4000
    buffer_load_dwordx4 a[32:35], v6, s[16:19], s40 offen offset:0
    buffer_load_dwordx4 a[36:39], v7, s[16:19], s40 offen offset:0
    ds_read_b128 v[36:39], v3 offset:28672
    ds_read_b128 v[40:43], v3 offset:29696
    ds_read_b128 v[44:47], v3 offset:30720
    ds_read_b128 v[48:51], v3 offset:31744
    s_waitcnt lgkmcnt(8)
    v_mfma_f32_32x32x16_bf16 v[128:143], a[40:43], v[52:55], v[128:143]
    v_mfma_f32_32x32x16_bf16 v[160:175], a[40:43], v[56:59], v[160:175]
    v_mfma_f32_32x32x16_bf16 v[192:207], a[40:43], v[60:63], v[192:207]
    v_mfma_f32_32x32x16_bf16 v[224:239], a[40:43], v[64:67], v[224:239]
    v_mfma_f32_32x32x16_bf16 v[144:159], a[44:47], v[52:55], v[144:159]
    v_mfma_f32_32x32x16_bf16 v[176:191], a[44:47], v[56:59], v[176:191]
    v_mfma_f32_32x32x16_bf16 v[208:223], a[44:47], v[60:63], v[208:223]
    v_mfma_f32_32x32x16_bf16 v[240:255], a[44:47], v[64:67], v[240:255]
    s_add_u32 s42, s35, 0x14000
    s_mov_b32 m0, s42
    s_add_u32 s43, s34, 0x5000
    buffer_load_dwordx4 v3, s[12:15], s43 offen lds
    s_add_u32 s42, s35, 0x15000
    s_mov_b32 m0, s42
    s_add_u32 s43, s34, 0x5400
    buffer_load_dwordx4 v3, s[12:15], s43 offen lds
    buffer_load_dwordx4 a[40:43], v6, s[16:19], s40 offen offset:1024
    buffer_load_dwordx4 a[44:47], v7, s[16:19], s40 offen offset:1024
    s_mov_b32 s41, 0x20000
    buffer_load_dwordx2 v[116:117], v9, s[20:23], s41 offen
    s_mov_b32 s41, 0x24000
    buffer_load_dwordx2 v[118:119], v9, s[20:23], s41 offen
    s_mov_b32 s41, 0x28000
    buffer_load_dwordx2 v[120:121], v9, s[20:23], s41 offen
    s_mov_b32 s41, 0x2c000
    buffer_load_dwordx2 v[122:123], v9, s[20:23], s41 offen
    ds_read_b128 v[52:55], v3 offset:32768
    ds_read_b128 v[56:59], v3 offset:33792
    ds_read_b128 v[60:63], v3 offset:34816
    ds_read_b128 v[64:67], v3 offset:35840
    s_waitcnt lgkmcnt(8)
    v_mfma_f32_32x32x16_bf16 v[128:143], a[48:51], v[20:23], v[128:143]
    v_mfma_f32_32x32x16_bf16 v[160:175], a[48:51], v[24:27], v[160:175]
    v_mfma_f32_32x32x16_bf16 v[192:207], a[48:51], v[28:31], v[192:207]
    v_mfma_f32_32x32x16_bf16 v[224:239], a[48:51], v[32:35], v[224:239]
    v_mfma_f32_32x32x16_bf16 v[144:159], a[52:55], v[20:23], v[144:159]
    v_mfma_f32_32x32x16_bf16 v[176:191], a[52:55], v[24:27], v[176:191]
    v_mfma_f32_32x32x16_bf16 v[208:223], a[52:55], v[28:31], v[208:223]
    v_mfma_f32_32x32x16_bf16 v[240:255], a[52:55], v[32:35], v[240:255]
    s_add_u32 s42, s35, 0x16000
    s_mov_b32 m0, s42
    s_add_u32 s43, s34, 0x5800
    buffer_load_dwordx4 v3, s[12:15], s43 offen lds
    s_add_u32 s42, s35, 0x17000
    s_mov_b32 m0, s42
    s_add_u32 s43, s34, 0x5c00
    buffer_load_dwordx4 v3, s[12:15], s43 offen lds
    buffer_load_dwordx4 a[48:51], v6, s[16:19], s40 offen offset:2048
    buffer_load_dwordx4 a[52:55], v7, s[16:19], s40 offen offset:2048
    buffer_load_dwordx4 v[68:71], v10, s[24:27], 0 offen offset:0
    buffer_load_dwordx4 v[72:75], v10, s[24:27], 0 offen offset:32
    buffer_load_dwordx4 v[76:79], v10, s[24:27], 0 offen offset:64
    buffer_load_dwordx4 v[80:83], v10, s[24:27], 0 offen offset:96
    buffer_load_dwordx4 v[84:87], v12, s[24:27], 0 offen offset:0
    buffer_load_dwordx4 v[88:91], v12, s[24:27], 0 offen offset:32
    buffer_load_dwordx4 v[92:95], v12, s[24:27], 0 offen offset:64
    buffer_load_dwordx4 v[96:99], v12, s[24:27], 0 offen offset:96
    ds_read_b128 v[20:23], v3 offset:36864
    ds_read_b128 v[24:27], v3 offset:37888
    ds_read_b128 v[28:31], v3 offset:38912
    ds_read_b128 v[32:35], v3 offset:39936
    s_waitcnt lgkmcnt(8)
    v_mfma_f32_32x32x16_bf16 v[128:143], a[56:59], v[36:39], v[128:143]
    v_mfma_f32_32x32x16_bf16 v[160:175], a[56:59], v[40:43], v[160:175]
    v_mfma_f32_32x32x16_bf16 v[192:207], a[56:59], v[44:47], v[192:207]
    v_mfma_f32_32x32x16_bf16 v[224:239], a[56:59], v[48:51], v[224:239]
    v_mfma_f32_32x32x16_bf16 v[144:159], a[60:63], v[36:39], v[144:159]
    v_mfma_f32_32x32x16_bf16 v[176:191], a[60:63], v[40:43], v[176:191]
    v_mfma_f32_32x32x16_bf16 v[208:223], a[60:63], v[44:47], v[208:223]
    v_mfma_f32_32x32x16_bf16 v[240:255], a[60:63], v[48:51], v[240:255]
    s_add_u32 s42, s35, 0x18000
    s_mov_b32 m0, s42
    s_add_u32 s43, s34, 0x6000
    buffer_load_dwordx4 v3, s[12:15], s43 offen lds
    s_add_u32 s42, s35, 0x19000
    s_mov_b32 m0, s42
    s_add_u32 s43, s34, 0x6400
    buffer_load_dwordx4 v3, s[12:15], s43 offen lds
    buffer_load_dwordx4 a[56:59], v6, s[16:19], s40 offen offset:3072
    buffer_load_dwordx4 a[60:63], v7, s[16:19], s40 offen offset:3072
    s_waitcnt vmcnt(40)
    v_mov_b32 v124, v100
    v_mov_b32 v125, v101
    v_add_f32 v124, v124, v102
    v_add_f32 v125, v125, v103
    v_add_f32 v124, v124, v104
    v_add_f32 v125, v125, v105
    v_add_f32 v124, v124, v106
    v_add_f32 v125, v125, v107
    s_mov_b32 s41, 0x30000
    buffer_load_dwordx2 v[100:101], v9, s[20:23], s41 offen
    s_mov_b32 s41, 0x34000
    buffer_load_dwordx2 v[102:103], v9, s[20:23], s41 offen
    s_mov_b32 s41, 0x38000
    buffer_load_dwordx2 v[104:105], v9, s[20:23], s41 offen
    s_mov_b32 s41, 0x3c000
    buffer_load_dwordx2 v[106:107], v9, s[20:23], s41 offen
    s_waitcnt lgkmcnt(4)
    v_mfma_f32_32x32x16_bf16 v[128:143], a[64:67], v[52:55], v[128:143]
    v_mfma_f32_32x32x16_bf16 v[160:175], a[64:67], v[56:59], v[160:175]
    v_mfma_f32_32x32x16_bf16 v[192:207], a[64:67], v[60:63], v[192:207]
    v_mfma_f32_32x32x16_bf16 v[224:239], a[64:67], v[64:67], v[224:239]
    v_mfma_f32_32x32x16_bf16 v[144:159], a[68:71], v[52:55], v[144:159]
    v_mfma_f32_32x32x16_bf16 v[176:191], a[68:71], v[56:59], v[176:191]
    v_mfma_f32_32x32x16_bf16 v[208:223], a[68:71], v[60:63], v[208:223]
    v_mfma_f32_32x32x16_bf16 v[240:255], a[68:71], v[64:67], v[240:255]
    s_add_u32 s42, s35, 0x1a000
    s_mov_b32 m0, s42
    s_add_u32 s43, s34, 0x6800
    buffer_load_dwordx4 v3, s[12:15], s43 offen lds
    s_add_u32 s42, s35, 0x1b000
    s_mov_b32 m0, s42
    s_add_u32 s43, s34, 0x6c00
    buffer_load_dwordx4 v3, s[12:15], s43 offen lds
    s_mov_b32 s40, 0x5000
    buffer_load_dwordx4 a[64:67], v6, s[16:19], s40 offen offset:0
    buffer_load_dwordx4 a[68:71], v7, s[16:19], s40 offen offset:0
    s_waitcnt lgkmcnt(0)
    v_mfma_f32_32x32x16_bf16 v[128:143], a[72:75], v[20:23], v[128:143]
    v_mfma_f32_32x32x16_bf16 v[160:175], a[72:75], v[24:27], v[160:175]
    v_mfma_f32_32x32x16_bf16 v[192:207], a[72:75], v[28:31], v[192:207]
    v_mfma_f32_32x32x16_bf16 v[224:239], a[72:75], v[32:35], v[224:239]
    v_mfma_f32_32x32x16_bf16 v[144:159], a[76:79], v[20:23], v[144:159]
    v_mfma_f32_32x32x16_bf16 v[176:191], a[76:79], v[24:27], v[176:191]
    v_mfma_f32_32x32x16_bf16 v[208:223], a[76:79], v[28:31], v[208:223]
    v_mfma_f32_32x32x16_bf16 v[240:255], a[76:79], v[32:35], v[240:255]
    s_add_u32 s42, s35, 0x1c000
    s_mov_b32 m0, s42
    s_add_u32 s43, s34, 0x7000
    buffer_load_dwordx4 v3, s[12:15], s43 offen lds
    s_add_u32 s42, s35, 0x1d000
    s_mov_b32 m0, s42
    s_add_u32 s43, s34, 0x7400
    buffer_load_dwordx4 v3, s[12:15], s43 offen lds
    buffer_load_dwordx4 a[72:75], v6, s[16:19], s40 offen offset:1024
    buffer_load_dwordx4 a[76:79], v7, s[16:19], s40 offen offset:1024
    s_waitcnt vmcnt(40)
    v_add_f32 v124, v124, v108
    v_add_f32 v125, v125, v109
    v_add_f32 v124, v124, v110
    v_add_f32 v125, v125, v111
    v_add_f32 v124, v124, v112
    v_add_f32 v125, v125, v113
    v_add_f32 v124, v124, v114
    v_add_f32 v125, v125, v115
    s_mov_b32 s41, 0x40000
    buffer_load_dwordx2 v[108:109], v9, s[20:23], s41 offen
    s_mov_b32 s41, 0x44000
    buffer_load_dwordx2 v[110:111], v9, s[20:23], s41 offen
    s_mov_b32 s41, 0x48000
    buffer_load_dwordx2 v[112:113], v9, s[20:23], s41 offen
    s_mov_b32 s41, 0x4c000
    buffer_load_dwordx2 v[114:115], v9, s[20:23], s41 offen
    s_waitcnt vmcnt(42)
    s_barrier
    ds_read_b128 v[36:39], v3 offset:40960
    ds_read_b128 v[40:43], v3 offset:41984
    ds_read_b128 v[44:47], v3 offset:43008
    ds_read_b128 v[48:51], v3 offset:44032
    ds_read_b128 v[52:55], v3 offset:45056
    ds_read_b128 v[56:59], v3 offset:46080
    ds_read_b128 v[60:63], v3 offset:47104
    ds_read_b128 v[64:67], v3 offset:48128
    ds_read_b128 v[20:23], v3 offset:49152
    ds_read_b128 v[24:27], v3 offset:50176
    ds_read_b128 v[28:31], v3 offset:51200
    ds_read_b128 v[32:35], v3 offset:52224
    s_waitcnt lgkmcnt(8)
    v_mfma_f32_32x32x16_bf16 v[128:143], a[80:83], v[36:39], v[128:143]
    v_mfma_f32_32x32x16_bf16 v[160:175], a[80:83], v[40:43], v[160:175]
    v_mfma_f32_32x32x16_bf16 v[192:207], a[80:83], v[44:47], v[192:207]
    v_mfma_f32_32x32x16_bf16 v[224:239], a[80:83], v[48:51], v[224:239]
    v_mfma_f32_32x32x16_bf16 v[144:159], a[84:87], v[36:39], v[144:159]
    v_mfma_f32_32x32x16_bf16 v[176:191], a[84:87], v[40:43], v[176:191]
    v_mfma_f32_32x32x16_bf16 v[208:223], a[84:87], v[44:47], v[208:223]
    v_mfma_f32_32x32x16_bf16 v[240:255], a[84:87], v[48:51], v[240:255]
    s_add_u32 s42, s35, 0x1e000
    s_mov_b32 m0, s42
    s_add_u32 s43, s34, 0x7800
    buffer_load_dwordx4 v3, s[12:15], s43 offen lds
    s_add_u32 s42, s35, 0x1f000
    s_mov_b32 m0, s42
    s_add_u32 s43, s34, 0x7c00
    buffer_load_dwordx4 v3, s[12:15], s43 offen lds
    buffer_load_dwordx4 a[80:83], v6, s[16:19], s40 offen offset:2048
    buffer_load_dwordx4 a[84:87], v7, s[16:19], s40 offen offset:2048
    ds_read_b128 v[36:39], v3 offset:53248
    ds_read_b128 v[40:43], v3 offset:54272
    ds_read_b128 v[44:47], v3 offset:55296
    ds_read_b128 v[48:51], v3 offset:56320
    s_waitcnt lgkmcnt(8)
    v_mfma_f32_32x32x16_bf16 v[128:143], a[88:91], v[52:55], v[128:143]
    v_mfma_f32_32x32x16_bf16 v[160:175], a[88:91], v[56:59], v[160:175]
    v_mfma_f32_32x32x16_bf16 v[192:207], a[88:91], v[60:63], v[192:207]
    v_mfma_f32_32x32x16_bf16 v[224:239], a[88:91], v[64:67], v[224:239]
    v_mfma_f32_32x32x16_bf16 v[144:159], a[92:95], v[52:55], v[144:159]
    v_mfma_f32_32x32x16_bf16 v[176:191], a[92:95], v[56:59], v[176:191]
    v_mfma_f32_32x32x16_bf16 v[208:223], a[92:95], v[60:63], v[208:223]
    v_mfma_f32_32x32x16_bf16 v[240:255], a[92:95], v[64:67], v[240:255]
    s_add_u32 s42, s35, 0x20000
    s_mov_b32 m0, s42
    s_add_u32 s43, s34, 0x8000
    buffer_load_dwordx4 v3, s[12:15], s43 offen lds
    s_add_u32 s42, s35, 0x21000
    s_mov_b32 m0, s42
    s_add_u32 s43, s34, 0x8400
    buffer_load_dwordx4 v3, s[12:15], s43 offen lds
    buffer_load_dwordx4 a[88:91], v6, s[16:19], s40 offen offset:3072
    buffer_load_dwordx4 a[92:95], v7, s[16:19], s40 offen offset:3072
    s_waitcnt vmcnt(40)
    v_add_f32 v124, v124, v116
    v_add_f32 v125, v125, v117
    v_add_f32 v124, v124, v118
    v_add_f32 v125, v125, v119
    v_add_f32 v124, v124, v120
    v_add_f32 v125, v125, v121
    v_add_f32 v124, v124, v122
    v_add_f32 v125, v125, v123
    ds_read_b128 v[52:55], v3 offset:57344
    ds_read_b128 v[56:59], v3 offset:58368
    ds_read_b128 v[60:63], v3 offset:59392
    ds_read_b128 v[64:67], v3 offset:60416
    s_waitcnt lgkmcnt(8)
    v_mfma_f32_32x32x16_bf16 v[128:143], a[0:3], v[20:23], v[128:143]
    v_mfma_f32_32x32x16_bf16 v[160:175], a[0:3], v[24:27], v[160:175]
    v_mfma_f32_32x32x16_bf16 v[192:207], a[0:3], v[28:31], v[192:207]
    v_mfma_f32_32x32x16_bf16 v[224:239], a[0:3], v[32:35], v[224:239]
    v_mfma_f32_32x32x16_bf16 v[144:159], a[4:7], v[20:23], v[144:159]
    v_mfma_f32_32x32x16_bf16 v[176:191], a[4:7], v[24:27], v[176:191]
    v_mfma_f32_32x32x16_bf16 v[208:223], a[4:7], v[28:31], v[208:223]
    v_mfma_f32_32x32x16_bf16 v[240:255], a[4:7], v[32:35], v[240:255]
    s_add_u32 s42, s35, 0x22000
    s_mov_b32 m0, s42
    s_add_u32 s43, s34, 0x8800
    buffer_load_dwordx4 v3, s[12:15], s43 offen lds
    s_add_u32 s42, s35, 0x23000
    s_mov_b32 m0, s42
    s_add_u32 s43, s34, 0x8c00
    buffer_load_dwordx4 v3, s[12:15], s43 offen lds
    s_mov_b32 s40, 0x6000
    buffer_load_dwordx4 a[0:3], v6, s[16:19], s40 offen offset:0
    buffer_load_dwordx4 a[4:7], v7, s[16:19], s40 offen offset:0
    ds_read_b128 v[20:23], v3 offset:61440
    ds_read_b128 v[24:27], v3 offset:62464
    ds_read_b128 v[28:31], v3 offset:63488
    ds_read_b128 v[32:35], v3 offset:64512
    s_waitcnt lgkmcnt(8)
    v_mfma_f32_32x32x16_bf16 v[128:143], a[8:11], v[36:39], v[128:143]
    v_mfma_f32_32x32x16_bf16 v[160:175], a[8:11], v[40:43], v[160:175]
    v_mfma_f32_32x32x16_bf16 v[192:207], a[8:11], v[44:47], v[192:207]
    v_mfma_f32_32x32x16_bf16 v[224:239], a[8:11], v[48:51], v[224:239]
    v_mfma_f32_32x32x16_bf16 v[144:159], a[12:15], v[36:39], v[144:159]
    v_mfma_f32_32x32x16_bf16 v[176:191], a[12:15], v[40:43], v[176:191]
    v_mfma_f32_32x32x16_bf16 v[208:223], a[12:15], v[44:47], v[208:223]
    v_mfma_f32_32x32x16_bf16 v[240:255], a[12:15], v[48:51], v[240:255]
    s_add_u32 s42, s35, 0x24000
    s_mov_b32 m0, s42
    s_add_u32 s43, s34, 0x9000
    buffer_load_dwordx4 v3, s[12:15], s43 offen lds
    s_add_u32 s42, s35, 0x25000
    s_mov_b32 m0, s42
    s_add_u32 s43, s34, 0x9400
    buffer_load_dwordx4 v3, s[12:15], s43 offen lds
    buffer_load_dwordx4 a[8:11], v6, s[16:19], s40 offen offset:1024
    buffer_load_dwordx4 a[12:15], v7, s[16:19], s40 offen offset:1024
    s_waitcnt vmcnt(28)
    v_add_f32 v124, v124, v100
    v_add_f32 v125, v125, v101
    v_add_f32 v124, v124, v102
    v_add_f32 v125, v125, v103
    v_add_f32 v124, v124, v104
    v_add_f32 v125, v125, v105
    v_add_f32 v124, v124, v106
    v_add_f32 v125, v125, v107
    ds_read_b128 v[36:39], v4 offset:0
    ds_read_b128 v[40:43], v4 offset:1024
    ds_read_b128 v[44:47], v4 offset:2048
    ds_read_b128 v[48:51], v4 offset:3072
    s_waitcnt lgkmcnt(8)
    v_mfma_f32_32x32x16_bf16 v[128:143], a[16:19], v[52:55], v[128:143]
    v_mfma_f32_32x32x16_bf16 v[160:175], a[16:19], v[56:59], v[160:175]
    v_mfma_f32_32x32x16_bf16 v[192:207], a[16:19], v[60:63], v[192:207]
    v_mfma_f32_32x32x16_bf16 v[224:239], a[16:19], v[64:67], v[224:239]
    v_mfma_f32_32x32x16_bf16 v[144:159], a[20:23], v[52:55], v[144:159]
    v_mfma_f32_32x32x16_bf16 v[176:191], a[20:23], v[56:59], v[176:191]
    v_mfma_f32_32x32x16_bf16 v[208:223], a[20:23], v[60:63], v[208:223]
    v_mfma_f32_32x32x16_bf16 v[240:255], a[20:23], v[64:67], v[240:255]
    s_add_u32 s42, s35, 0x26000
    s_mov_b32 m0, s42
    s_add_u32 s43, s34, 0x9800
    buffer_load_dwordx4 v3, s[12:15], s43 offen lds
    s_add_u32 s42, s35, 0x27000
    s_mov_b32 m0, s42
    s_add_u32 s43, s34, 0x9c00
    buffer_load_dwordx4 v3, s[12:15], s43 offen lds
    buffer_load_dwordx4 a[16:19], v6, s[16:19], s40 offen offset:2048
    buffer_load_dwordx4 a[20:23], v7, s[16:19], s40 offen offset:2048
    ds_read_b128 v[52:55], v4 offset:4096
    ds_read_b128 v[56:59], v4 offset:5120
    ds_read_b128 v[60:63], v4 offset:6144
    ds_read_b128 v[64:67], v4 offset:7168
    s_waitcnt lgkmcnt(8)
    v_mfma_f32_32x32x16_bf16 v[128:143], a[24:27], v[20:23], v[128:143]
    v_mfma_f32_32x32x16_bf16 v[160:175], a[24:27], v[24:27], v[160:175]
    v_mfma_f32_32x32x16_bf16 v[192:207], a[24:27], v[28:31], v[192:207]
    v_mfma_f32_32x32x16_bf16 v[224:239], a[24:27], v[32:35], v[224:239]
    v_mfma_f32_32x32x16_bf16 v[144:159], a[28:31], v[20:23], v[144:159]
    v_mfma_f32_32x32x16_bf16 v[176:191], a[28:31], v[24:27], v[176:191]
    v_mfma_f32_32x32x16_bf16 v[208:223], a[28:31], v[28:31], v[208:223]
    v_mfma_f32_32x32x16_bf16 v[240:255], a[28:31], v[32:35], v[240:255]
    buffer_load_dwordx4 a[24:27], v6, s[16:19], s40 offen offset:3072
    buffer_load_dwordx4 a[28:31], v7, s[16:19], s40 offen offset:3072
    s_waitcnt vmcnt(22)
    v_add_f32 v124, v124, v108
    v_add_f32 v125, v125, v109
    v_add_f32 v124, v124, v110
    v_add_f32 v125, v125, v111
    v_add_f32 v124, v124, v112
    v_add_f32 v125, v125, v113
    v_add_f32 v124, v124, v114
    v_add_f32 v125, v125, v115
    ds_read_b128 v[20:23], v4 offset:8192
    ds_read_b128 v[24:27], v4 offset:9216
    ds_read_b128 v[28:31], v4 offset:10240
    ds_read_b128 v[32:35], v4 offset:11264
    s_waitcnt lgkmcnt(8)
    v_mfma_f32_32x32x16_bf16 v[128:143], a[32:35], v[36:39], v[128:143]
    v_mfma_f32_32x32x16_bf16 v[160:175], a[32:35], v[40:43], v[160:175]
    v_mfma_f32_32x32x16_bf16 v[192:207], a[32:35], v[44:47], v[192:207]
    v_mfma_f32_32x32x16_bf16 v[224:239], a[32:35], v[48:51], v[224:239]
    v_mfma_f32_32x32x16_bf16 v[144:159], a[36:39], v[36:39], v[144:159]
    v_mfma_f32_32x32x16_bf16 v[176:191], a[36:39], v[40:43], v[176:191]
    v_mfma_f32_32x32x16_bf16 v[208:223], a[36:39], v[44:47], v[208:223]
    v_mfma_f32_32x32x16_bf16 v[240:255], a[36:39], v[48:51], v[240:255]
    s_mov_b32 s40, 0x7000
    buffer_load_dwordx4 a[32:35], v6, s[16:19], s40 offen offset:0
    buffer_load_dwordx4 a[36:39], v7, s[16:19], s40 offen offset:0
    ds_read_b128 v[36:39], v4 offset:12288
    ds_read_b128 v[40:43], v4 offset:13312
    ds_read_b128 v[44:47], v4 offset:14336
    ds_read_b128 v[48:51], v4 offset:15360
    s_waitcnt lgkmcnt(8)
    v_mfma_f32_32x32x16_bf16 v[128:143], a[40:43], v[52:55], v[128:143]
    v_mfma_f32_32x32x16_bf16 v[160:175], a[40:43], v[56:59], v[160:175]
    v_mfma_f32_32x32x16_bf16 v[192:207], a[40:43], v[60:63], v[192:207]
    v_mfma_f32_32x32x16_bf16 v[224:239], a[40:43], v[64:67], v[224:239]
    v_mfma_f32_32x32x16_bf16 v[144:159], a[44:47], v[52:55], v[144:159]
    v_mfma_f32_32x32x16_bf16 v[176:191], a[44:47], v[56:59], v[176:191]
    v_mfma_f32_32x32x16_bf16 v[208:223], a[44:47], v[60:63], v[208:223]
    v_mfma_f32_32x32x16_bf16 v[240:255], a[44:47], v[64:67], v[240:255]
    buffer_load_dwordx4 a[40:43], v6, s[16:19], s40 offen offset:1024
    buffer_load_dwordx4 a[44:47], v7, s[16:19], s40 offen offset:1024
    v_mul_f32 v102, 0x3acccccd, v124
    v_mul_f32 v103, 0x3acccccd, v125
    v_fma_f32 v103, -v102, v102, v103
    v_max_f32 v103, 0, v103
    v_cvt_pk_bf16_f32 v102, v102, v102
    v_lshlrev_b32 v102, 16, v102
    v_cvt_pk_bf16_f32 v103, v103, v103
    v_lshlrev_b32 v103, 16, v103
    v_add_f32 v103, 0x3727c5ac, v103
    v_cvt_pk_bf16_f32 v103, v103, v103
    v_lshlrev_b32 v103, 16, v103
    v_sqrt_f32 v103, v103
    s_nop 0
    v_cvt_pk_bf16_f32 v103, v103, v103
    v_lshlrev_b32 v103, 16, v103
    v_rcp_f32 v18, v103
    s_nop 0
    v_mul_f32 v19, v102, v18
    v_sub_f32 v19, 0, v19
    s_waitcnt lgkmcnt(4)
    v_mfma_f32_32x32x16_bf16 v[128:143], a[48:51], v[20:23], v[128:143]
    v_mfma_f32_32x32x16_bf16 v[160:175], a[48:51], v[24:27], v[160:175]
    v_mfma_f32_32x32x16_bf16 v[192:207], a[48:51], v[28:31], v[192:207]
    v_mfma_f32_32x32x16_bf16 v[224:239], a[48:51], v[32:35], v[224:239]
    v_mfma_f32_32x32x16_bf16 v[144:159], a[52:55], v[20:23], v[144:159]
    v_mfma_f32_32x32x16_bf16 v[176:191], a[52:55], v[24:27], v[176:191]
    v_mfma_f32_32x32x16_bf16 v[208:223], a[52:55], v[28:31], v[208:223]
    v_mfma_f32_32x32x16_bf16 v[240:255], a[52:55], v[32:35], v[240:255]
    buffer_load_dwordx4 a[48:51], v6, s[16:19], s40 offen offset:2048
    buffer_load_dwordx4 a[52:55], v7, s[16:19], s40 offen offset:2048
    s_waitcnt lgkmcnt(0)
    v_mfma_f32_32x32x16_bf16 v[128:143], a[56:59], v[36:39], v[128:143]
    v_mfma_f32_32x32x16_bf16 v[160:175], a[56:59], v[40:43], v[160:175]
    v_mfma_f32_32x32x16_bf16 v[192:207], a[56:59], v[44:47], v[192:207]
    v_mfma_f32_32x32x16_bf16 v[224:239], a[56:59], v[48:51], v[224:239]
    v_mfma_f32_32x32x16_bf16 v[144:159], a[60:63], v[36:39], v[144:159]
    v_mfma_f32_32x32x16_bf16 v[176:191], a[60:63], v[40:43], v[176:191]
    v_mfma_f32_32x32x16_bf16 v[208:223], a[60:63], v[44:47], v[208:223]
    v_mfma_f32_32x32x16_bf16 v[240:255], a[60:63], v[48:51], v[240:255]
    buffer_load_dwordx4 a[56:59], v6, s[16:19], s40 offen offset:3072
    buffer_load_dwordx4 a[60:63], v7, s[16:19], s40 offen offset:3072
    s_barrier
    ds_write_b32 v16, v18
    ds_write_b32 v16, v19 offset:512
    s_waitcnt lgkmcnt(0)
    ds_read_b128 v[52:55], v4 offset:16384
    ds_read_b128 v[56:59], v4 offset:17408
    ds_read_b128 v[60:63], v4 offset:18432
    ds_read_b128 v[64:67], v4 offset:19456
    ds_read_b128 v[20:23], v4 offset:20480
    ds_read_b128 v[24:27], v4 offset:21504
    ds_read_b128 v[28:31], v4 offset:22528
    ds_read_b128 v[32:35], v4 offset:23552
    ds_read_b128 v[36:39], v4 offset:24576
    ds_read_b128 v[40:43], v4 offset:25600
    ds_read_b128 v[44:47], v4 offset:26624
    ds_read_b128 v[48:51], v4 offset:27648
    s_waitcnt lgkmcnt(8)
    v_mfma_f32_32x32x16_bf16 v[128:143], a[64:67], v[52:55], v[128:143]
    v_mfma_f32_32x32x16_bf16 v[160:175], a[64:67], v[56:59], v[160:175]
    v_mfma_f32_32x32x16_bf16 v[192:207], a[64:67], v[60:63], v[192:207]
    v_mfma_f32_32x32x16_bf16 v[224:239], a[64:67], v[64:67], v[224:239]
    v_mfma_f32_32x32x16_bf16 v[144:159], a[68:71], v[52:55], v[144:159]
    v_mfma_f32_32x32x16_bf16 v[176:191], a[68:71], v[56:59], v[176:191]
    v_mfma_f32_32x32x16_bf16 v[208:223], a[68:71], v[60:63], v[208:223]
    v_mfma_f32_32x32x16_bf16 v[240:255], a[68:71], v[64:67], v[240:255]
    s_mov_b32 s40, 0x8000
    buffer_load_dwordx4 a[64:67], v6, s[16:19], s40 offen offset:0
    buffer_load_dwordx4 a[68:71], v7, s[16:19], s40 offen offset:0
    ds_read_b128 v[52:55], v4 offset:28672
    ds_read_b128 v[56:59], v4 offset:29696
    ds_read_b128 v[60:63], v4 offset:30720
    ds_read_b128 v[64:67], v4 offset:31744
    s_waitcnt lgkmcnt(8)
    v_mfma_f32_32x32x16_bf16 v[128:143], a[72:75], v[20:23], v[128:143]
    v_mfma_f32_32x32x16_bf16 v[160:175], a[72:75], v[24:27], v[160:175]
    v_mfma_f32_32x32x16_bf16 v[192:207], a[72:75], v[28:31], v[192:207]
    v_mfma_f32_32x32x16_bf16 v[224:239], a[72:75], v[32:35], v[224:239]
    v_mfma_f32_32x32x16_bf16 v[144:159], a[76:79], v[20:23], v[144:159]
    v_mfma_f32_32x32x16_bf16 v[176:191], a[76:79], v[24:27], v[176:191]
    v_mfma_f32_32x32x16_bf16 v[208:223], a[76:79], v[28:31], v[208:223]
    v_mfma_f32_32x32x16_bf16 v[240:255], a[76:79], v[32:35], v[240:255]
    buffer_load_dwordx4 a[72:75], v6, s[16:19], s40 offen offset:1024
    buffer_load_dwordx4 a[76:79], v7, s[16:19], s40 offen offset:1024
    ds_read_b128 v[20:23], v4 offset:32768
    ds_read_b128 v[24:27], v4 offset:33792
    ds_read_b128 v[28:31], v4 offset:34816
    ds_read_b128 v[32:35], v4 offset:35840
    s_waitcnt lgkmcnt(8)
    s_waitcnt vmcnt(30)
    v_mfma_f32_32x32x16_bf16 v[128:143], a[80:83], v[36:39], v[128:143]
    v_mfma_f32_32x32x16_bf16 v[160:175], a[80:83], v[40:43], v[160:175]
    v_mfma_f32_32x32x16_bf16 v[192:207], a[80:83], v[44:47], v[192:207]
    v_mfma_f32_32x32x16_bf16 v[224:239], a[80:83], v[48:51], v[224:239]
    v_mfma_f32_32x32x16_bf16 v[144:159], a[84:87], v[36:39], v[144:159]
    v_mfma_f32_32x32x16_bf16 v[176:191], a[84:87], v[40:43], v[176:191]
    v_mfma_f32_32x32x16_bf16 v[208:223], a[84:87], v[44:47], v[208:223]
    v_mfma_f32_32x32x16_bf16 v[240:255], a[84:87], v[48:51], v[240:255]
    buffer_load_dwordx4 a[80:83], v6, s[16:19], s40 offen offset:2048
    buffer_load_dwordx4 a[84:87], v7, s[16:19], s40 offen offset:2048
    ds_read_b128 v[36:39], v4 offset:36864
    ds_read_b128 v[40:43], v4 offset:37888
    ds_read_b128 v[44:47], v4 offset:38912
    ds_read_b128 v[48:51], v4 offset:39936
    s_waitcnt lgkmcnt(8)
    s_waitcnt vmcnt(28)
    v_mfma_f32_32x32x16_bf16 v[128:143], a[88:91], v[52:55], v[128:143]
    v_mfma_f32_32x32x16_bf16 v[160:175], a[88:91], v[56:59], v[160:175]
    v_mfma_f32_32x32x16_bf16 v[192:207], a[88:91], v[60:63], v[192:207]
    v_mfma_f32_32x32x16_bf16 v[224:239], a[88:91], v[64:67], v[224:239]
    v_mfma_f32_32x32x16_bf16 v[144:159], a[92:95], v[52:55], v[144:159]
    v_mfma_f32_32x32x16_bf16 v[176:191], a[92:95], v[56:59], v[176:191]
    v_mfma_f32_32x32x16_bf16 v[208:223], a[92:95], v[60:63], v[208:223]
    v_mfma_f32_32x32x16_bf16 v[240:255], a[92:95], v[64:67], v[240:255]
    buffer_load_dwordx4 a[88:91], v6, s[16:19], s40 offen offset:3072
    buffer_load_dwordx4 a[92:95], v7, s[16:19], s40 offen offset:3072
    ds_read_b128 v[52:55], v4 offset:40960
    ds_read_b128 v[56:59], v4 offset:41984
    ds_read_b128 v[60:63], v4 offset:43008
    ds_read_b128 v[64:67], v4 offset:44032
    s_waitcnt lgkmcnt(8)
    s_waitcnt vmcnt(26)
    v_mfma_f32_32x32x16_bf16 v[128:143], a[0:3], v[20:23], v[128:143]
    v_mfma_f32_32x32x16_bf16 v[160:175], a[0:3], v[24:27], v[160:175]
    v_mfma_f32_32x32x16_bf16 v[192:207], a[0:3], v[28:31], v[192:207]
    v_mfma_f32_32x32x16_bf16 v[224:239], a[0:3], v[32:35], v[224:239]
    v_mfma_f32_32x32x16_bf16 v[144:159], a[4:7], v[20:23], v[144:159]
    v_mfma_f32_32x32x16_bf16 v[176:191], a[4:7], v[24:27], v[176:191]
    v_mfma_f32_32x32x16_bf16 v[208:223], a[4:7], v[28:31], v[208:223]
    v_mfma_f32_32x32x16_bf16 v[240:255], a[4:7], v[32:35], v[240:255]
    s_mov_b32 s40, 0x9000
    buffer_load_dwordx4 a[0:3], v6, s[16:19], s40 offen offset:0
    buffer_load_dwordx4 a[4:7], v7, s[16:19], s40 offen offset:0
    ds_read_b128 v[20:23], v4 offset:45056
    ds_read_b128 v[24:27], v4 offset:46080
    ds_read_b128 v[28:31], v4 offset:47104
    ds_read_b128 v[32:35], v4 offset:48128
    s_waitcnt lgkmcnt(8)
    s_waitcnt vmcnt(24)
    v_mfma_f32_32x32x16_bf16 v[128:143], a[8:11], v[36:39], v[128:143]
    v_mfma_f32_32x32x16_bf16 v[160:175], a[8:11], v[40:43], v[160:175]
    v_mfma_f32_32x32x16_bf16 v[192:207], a[8:11], v[44:47], v[192:207]
    v_mfma_f32_32x32x16_bf16 v[224:239], a[8:11], v[48:51], v[224:239]
    v_mfma_f32_32x32x16_bf16 v[144:159], a[12:15], v[36:39], v[144:159]
    v_mfma_f32_32x32x16_bf16 v[176:191], a[12:15], v[40:43], v[176:191]
    v_mfma_f32_32x32x16_bf16 v[208:223], a[12:15], v[44:47], v[208:223]
    v_mfma_f32_32x32x16_bf16 v[240:255], a[12:15], v[48:51], v[240:255]
    buffer_load_dwordx4 a[8:11], v6, s[16:19], s40 offen offset:1024
    buffer_load_dwordx4 a[12:15], v7, s[16:19], s40 offen offset:1024
    ds_read_b128 v[36:39], v4 offset:49152
    ds_read_b128 v[40:43], v4 offset:50176
    ds_read_b128 v[44:47], v4 offset:51200
    ds_read_b128 v[48:51], v4 offset:52224
    s_waitcnt lgkmcnt(8)
    s_waitcnt vmcnt(22)
    v_mfma_f32_32x32x16_bf16 v[128:143], a[16:19], v[52:55], v[128:143]
    v_mfma_f32_32x32x16_bf16 v[160:175], a[16:19], v[56:59], v[160:175]
    v_mfma_f32_32x32x16_bf16 v[192:207], a[16:19], v[60:63], v[192:207]
    v_mfma_f32_32x32x16_bf16 v[224:239], a[16:19], v[64:67], v[224:239]
    v_mfma_f32_32x32x16_bf16 v[144:159], a[20:23], v[52:55], v[144:159]
    v_mfma_f32_32x32x16_bf16 v[176:191], a[20:23], v[56:59], v[176:191]
    v_mfma_f32_32x32x16_bf16 v[208:223], a[20:23], v[60:63], v[208:223]
    v_mfma_f32_32x32x16_bf16 v[240:255], a[20:23], v[64:67], v[240:255]
    buffer_load_dwordx4 a[16:19], v6, s[16:19], s40 offen offset:2048
    buffer_load_dwordx4 a[20:23], v7, s[16:19], s40 offen offset:2048
    ds_read_b128 v[52:55], v4 offset:53248
    ds_read_b128 v[56:59], v4 offset:54272
    ds_read_b128 v[60:63], v4 offset:55296
    ds_read_b128 v[64:67], v4 offset:56320
    s_waitcnt lgkmcnt(8)
    s_waitcnt vmcnt(22)
    v_mfma_f32_32x32x16_bf16 v[128:143], a[24:27], v[20:23], v[128:143]
    v_mfma_f32_32x32x16_bf16 v[160:175], a[24:27], v[24:27], v[160:175]
    v_mfma_f32_32x32x16_bf16 v[192:207], a[24:27], v[28:31], v[192:207]
    v_mfma_f32_32x32x16_bf16 v[224:239], a[24:27], v[32:35], v[224:239]
    v_mfma_f32_32x32x16_bf16 v[144:159], a[28:31], v[20:23], v[144:159]
    v_mfma_f32_32x32x16_bf16 v[176:191], a[28:31], v[24:27], v[176:191]
    v_mfma_f32_32x32x16_bf16 v[208:223], a[28:31], v[28:31], v[208:223]
    v_mfma_f32_32x32x16_bf16 v[240:255], a[28:31], v[32:35], v[240:255]
    buffer_load_dwordx4 a[24:27], v6, s[16:19], s40 offen offset:3072
    buffer_load_dwordx4 a[28:31], v7, s[16:19], s40 offen offset:3072
    s_waitcnt lgkmcnt(4)
    s_waitcnt vmcnt(22)
    v_mfma_f32_32x32x16_bf16 v[128:143], a[32:35], v[36:39], v[128:143]
    v_mfma_f32_32x32x16_bf16 v[160:175], a[32:35], v[40:43], v[160:175]
    v_mfma_f32_32x32x16_bf16 v[192:207], a[32:35], v[44:47], v[192:207]
    v_mfma_f32_32x32x16_bf16 v[224:239], a[32:35], v[48:51], v[224:239]
    v_mfma_f32_32x32x16_bf16 v[144:159], a[36:39], v[36:39], v[144:159]
    v_mfma_f32_32x32x16_bf16 v[176:191], a[36:39], v[40:43], v[176:191]
    v_mfma_f32_32x32x16_bf16 v[208:223], a[36:39], v[44:47], v[208:223]
    v_mfma_f32_32x32x16_bf16 v[240:255], a[36:39], v[48:51], v[240:255]
    s_waitcnt lgkmcnt(0)
    s_waitcnt vmcnt(20)
    v_mfma_f32_32x32x16_bf16 v[128:143], a[40:43], v[52:55], v[128:143]
    v_mfma_f32_32x32x16_bf16 v[160:175], a[40:43], v[56:59], v[160:175]
    v_mfma_f32_32x32x16_bf16 v[192:207], a[40:43], v[60:63], v[192:207]
    v_mfma_f32_32x32x16_bf16 v[224:239], a[40:43], v[64:67], v[224:239]
    v_mfma_f32_32x32x16_bf16 v[144:159], a[44:47], v[52:55], v[144:159]
    v_mfma_f32_32x32x16_bf16 v[176:191], a[44:47], v[56:59], v[176:191]
    v_mfma_f32_32x32x16_bf16 v[208:223], a[44:47], v[60:63], v[208:223]
    v_mfma_f32_32x32x16_bf16 v[240:255], a[44:47], v[64:67], v[240:255]
    s_barrier
    ds_read_b128 v[20:23], v4 offset:57344
    ds_read_b128 v[24:27], v4 offset:58368
    ds_read_b128 v[28:31], v4 offset:59392
    ds_read_b128 v[32:35], v4 offset:60416
    ds_read_b128 v[36:39], v4 offset:61440
    ds_read_b128 v[40:43], v4 offset:62464
    ds_read_b128 v[44:47], v4 offset:63488
    ds_read_b128 v[48:51], v4 offset:64512
    ds_read_b128 v[52:55], v5 offset:0
    ds_read_b128 v[56:59], v5 offset:1024
    ds_read_b128 v[60:63], v5 offset:2048
    ds_read_b128 v[64:67], v5 offset:3072
    s_waitcnt lgkmcnt(8)
    s_waitcnt vmcnt(18)
    v_mfma_f32_32x32x16_bf16 v[128:143], a[48:51], v[20:23], v[128:143]
    v_mfma_f32_32x32x16_bf16 v[160:175], a[48:51], v[24:27], v[160:175]
    v_mfma_f32_32x32x16_bf16 v[192:207], a[48:51], v[28:31], v[192:207]
    v_mfma_f32_32x32x16_bf16 v[224:239], a[48:51], v[32:35], v[224:239]
    v_mfma_f32_32x32x16_bf16 v[144:159], a[52:55], v[20:23], v[144:159]
    v_mfma_f32_32x32x16_bf16 v[176:191], a[52:55], v[24:27], v[176:191]
    v_mfma_f32_32x32x16_bf16 v[208:223], a[52:55], v[28:31], v[208:223]
    v_mfma_f32_32x32x16_bf16 v[240:255], a[52:55], v[32:35], v[240:255]
    ds_read_b128 v[20:23], v5 offset:4096
    ds_read_b128 v[24:27], v5 offset:5120
    ds_read_b128 v[28:31], v5 offset:6144
    ds_read_b128 v[32:35], v5 offset:7168
    s_waitcnt lgkmcnt(8)
    s_waitcnt vmcnt(16)
    v_mfma_f32_32x32x16_bf16 v[128:143], a[56:59], v[36:39], v[128:143]
    v_mfma_f32_32x32x16_bf16 v[160:175], a[56:59], v[40:43], v[160:175]
    v_mfma_f32_32x32x16_bf16 v[192:207], a[56:59], v[44:47], v[192:207]
    v_mfma_f32_32x32x16_bf16 v[224:239], a[56:59], v[48:51], v[224:239]
    v_mfma_f32_32x32x16_bf16 v[144:159], a[60:63], v[36:39], v[144:159]
    v_mfma_f32_32x32x16_bf16 v[176:191], a[60:63], v[40:43], v[176:191]
    v_mfma_f32_32x32x16_bf16 v[208:223], a[60:63], v[44:47], v[208:223]
    v_mfma_f32_32x32x16_bf16 v[240:255], a[60:63], v[48:51], v[240:255]
    ds_read_b128 v[36:39], v5 offset:8192
    ds_read_b128 v[40:43], v5 offset:9216
    ds_read_b128 v[44:47], v5 offset:10240
    ds_read_b128 v[48:51], v5 offset:11264
    s_waitcnt lgkmcnt(8)
    s_waitcnt vmcnt(14)
    v_mfma_f32_32x32x16_bf16 v[128:143], a[64:67], v[52:55], v[128:143]
    v_mfma_f32_32x32x16_bf16 v[160:175], a[64:67], v[56:59], v[160:175]
    v_mfma_f32_32x32x16_bf16 v[192:207], a[64:67], v[60:63], v[192:207]
    v_mfma_f32_32x32x16_bf16 v[224:239], a[64:67], v[64:67], v[224:239]
    v_mfma_f32_32x32x16_bf16 v[144:159], a[68:71], v[52:55], v[144:159]
    v_mfma_f32_32x32x16_bf16 v[176:191], a[68:71], v[56:59], v[176:191]
    v_mfma_f32_32x32x16_bf16 v[208:223], a[68:71], v[60:63], v[208:223]
    v_mfma_f32_32x32x16_bf16 v[240:255], a[68:71], v[64:67], v[240:255]
    ds_read_b128 v[52:55], v5 offset:12288
    ds_read_b128 v[56:59], v5 offset:13312
    ds_read_b128 v[60:63], v5 offset:14336
    ds_read_b128 v[64:67], v5 offset:15360
    s_waitcnt lgkmcnt(8)
    s_waitcnt vmcnt(12)
    v_mfma_f32_32x32x16_bf16 v[128:143], a[72:75], v[20:23], v[128:143]
    v_mfma_f32_32x32x16_bf16 v[160:175], a[72:75], v[24:27], v[160:175]
    v_mfma_f32_32x32x16_bf16 v[192:207], a[72:75], v[28:31], v[192:207]
    v_mfma_f32_32x32x16_bf16 v[224:239], a[72:75], v[32:35], v[224:239]
    v_mfma_f32_32x32x16_bf16 v[144:159], a[76:79], v[20:23], v[144:159]
    v_mfma_f32_32x32x16_bf16 v[176:191], a[76:79], v[24:27], v[176:191]
    v_mfma_f32_32x32x16_bf16 v[208:223], a[76:79], v[28:31], v[208:223]
    v_mfma_f32_32x32x16_bf16 v[240:255], a[76:79], v[32:35], v[240:255]
    ds_read_b128 v[20:23], v5 offset:16384
    ds_read_b128 v[24:27], v5 offset:17408
    ds_read_b128 v[28:31], v5 offset:18432
    ds_read_b128 v[32:35], v5 offset:19456
    s_waitcnt lgkmcnt(8)
    s_waitcnt vmcnt(10)
    v_mfma_f32_32x32x16_bf16 v[128:143], a[80:83], v[36:39], v[128:143]
    v_mfma_f32_32x32x16_bf16 v[160:175], a[80:83], v[40:43], v[160:175]
    v_mfma_f32_32x32x16_bf16 v[192:207], a[80:83], v[44:47], v[192:207]
    v_mfma_f32_32x32x16_bf16 v[224:239], a[80:83], v[48:51], v[224:239]
    v_mfma_f32_32x32x16_bf16 v[144:159], a[84:87], v[36:39], v[144:159]
    v_mfma_f32_32x32x16_bf16 v[176:191], a[84:87], v[40:43], v[176:191]
    v_mfma_f32_32x32x16_bf16 v[208:223], a[84:87], v[44:47], v[208:223]
    v_mfma_f32_32x32x16_bf16 v[240:255], a[84:87], v[48:51], v[240:255]
    ds_read_b128 v[36:39], v5 offset:20480
    ds_read_b128 v[40:43], v5 offset:21504
    ds_read_b128 v[44:47], v5 offset:22528
    ds_read_b128 v[48:51], v5 offset:23552
    s_waitcnt lgkmcnt(8)
    s_waitcnt vmcnt(8)
    v_mfma_f32_32x32x16_bf16 v[128:143], a[88:91], v[52:55], v[128:143]
    v_mfma_f32_32x32x16_bf16 v[160:175], a[88:91], v[56:59], v[160:175]
    v_mfma_f32_32x32x16_bf16 v[192:207], a[88:91], v[60:63], v[192:207]
    v_mfma_f32_32x32x16_bf16 v[224:239], a[88:91], v[64:67], v[224:239]
    v_mfma_f32_32x32x16_bf16 v[144:159], a[92:95], v[52:55], v[144:159]
    v_mfma_f32_32x32x16_bf16 v[176:191], a[92:95], v[56:59], v[176:191]
    v_mfma_f32_32x32x16_bf16 v[208:223], a[92:95], v[60:63], v[208:223]
    v_mfma_f32_32x32x16_bf16 v[240:255], a[92:95], v[64:67], v[240:255]
    ds_read_b128 v[52:55], v5 offset:24576
    ds_read_b128 v[56:59], v5 offset:25600
    ds_read_b128 v[60:63], v5 offset:26624
    ds_read_b128 v[64:67], v5 offset:27648
    s_waitcnt lgkmcnt(8)
    s_waitcnt vmcnt(6)
    v_mfma_f32_32x32x16_bf16 v[128:143], a[0:3], v[20:23], v[128:143]
    v_mfma_f32_32x32x16_bf16 v[160:175], a[0:3], v[24:27], v[160:175]
    v_mfma_f32_32x32x16_bf16 v[192:207], a[0:3], v[28:31], v[192:207]
    v_mfma_f32_32x32x16_bf16 v[224:239], a[0:3], v[32:35], v[224:239]
    v_mfma_f32_32x32x16_bf16 v[144:159], a[4:7], v[20:23], v[144:159]
    v_mfma_f32_32x32x16_bf16 v[176:191], a[4:7], v[24:27], v[176:191]
    v_mfma_f32_32x32x16_bf16 v[208:223], a[4:7], v[28:31], v[208:223]
    v_mfma_f32_32x32x16_bf16 v[240:255], a[4:7], v[32:35], v[240:255]
    ds_read_b128 v[20:23], v5 offset:28672
    ds_read_b128 v[24:27], v5 offset:29696
    ds_read_b128 v[28:31], v5 offset:30720
    ds_read_b128 v[32:35], v5 offset:31744
    s_waitcnt lgkmcnt(8)
    s_waitcnt vmcnt(4)
    v_mfma_f32_32x32x16_bf16 v[128:143], a[8:11], v[36:39], v[128:143]
    v_mfma_f32_32x32x16_bf16 v[160:175], a[8:11], v[40:43], v[160:175]
    v_mfma_f32_32x32x16_bf16 v[192:207], a[8:11], v[44:47], v[192:207]
    v_mfma_f32_32x32x16_bf16 v[224:239], a[8:11], v[48:51], v[224:239]
    v_mfma_f32_32x32x16_bf16 v[144:159], a[12:15], v[36:39], v[144:159]
    v_mfma_f32_32x32x16_bf16 v[176:191], a[12:15], v[40:43], v[176:191]
    v_mfma_f32_32x32x16_bf16 v[208:223], a[12:15], v[44:47], v[208:223]
    v_mfma_f32_32x32x16_bf16 v[240:255], a[12:15], v[48:51], v[240:255]
    s_waitcnt lgkmcnt(4)
    s_waitcnt vmcnt(2)
    v_mfma_f32_32x32x16_bf16 v[128:143], a[16:19], v[52:55], v[128:143]
    v_mfma_f32_32x32x16_bf16 v[160:175], a[16:19], v[56:59], v[160:175]
    v_mfma_f32_32x32x16_bf16 v[192:207], a[16:19], v[60:63], v[192:207]
    v_mfma_f32_32x32x16_bf16 v[224:239], a[16:19], v[64:67], v[224:239]
    v_mfma_f32_32x32x16_bf16 v[144:159], a[20:23], v[52:55], v[144:159]
    v_mfma_f32_32x32x16_bf16 v[176:191], a[20:23], v[56:59], v[176:191]
    v_mfma_f32_32x32x16_bf16 v[208:223], a[20:23], v[60:63], v[208:223]
    v_mfma_f32_32x32x16_bf16 v[240:255], a[20:23], v[64:67], v[240:255]
    s_waitcnt lgkmcnt(0)
    s_waitcnt vmcnt(0)
    v_mfma_f32_32x32x16_bf16 v[128:143], a[24:27], v[20:23], v[128:143]
    v_mfma_f32_32x32x16_bf16 v[160:175], a[24:27], v[24:27], v[160:175]
    v_mfma_f32_32x32x16_bf16 v[192:207], a[24:27], v[28:31], v[192:207]
    v_mfma_f32_32x32x16_bf16 v[224:239], a[24:27], v[32:35], v[224:239]
    v_mfma_f32_32x32x16_bf16 v[144:159], a[28:31], v[20:23], v[144:159]
    v_mfma_f32_32x32x16_bf16 v[176:191], a[28:31], v[24:27], v[176:191]
    v_mfma_f32_32x32x16_bf16 v[208:223], a[28:31], v[28:31], v[208:223]
    v_mfma_f32_32x32x16_bf16 v[240:255], a[28:31], v[32:35], v[240:255]
    s_waitcnt vmcnt(0)
    v_lshlrev_b32 v17, 2, v1
    ds_read_b32 v100, v17 offset:0
    ds_read_b32 v108, v17 offset:512
    ds_read_b32 v102, v17 offset:128
    ds_read_b32 v110, v17 offset:640
    ds_read_b32 v104, v17 offset:256
    ds_read_b32 v112, v17 offset:768
    ds_read_b32 v106, v17 offset:384
    ds_read_b32 v114, v17 offset:896
    s_mul_i32 s37, s8, 442368
    s_lshl_b32 s38, s11, 11
    s_add_u32 s37, s37, s38
    v_mov_b32 v116, 0xc0135761
    v_mov_b32 v118, 0xbdd2d3e8
    v_mov_b32 v120, 1.0
    s_waitcnt lgkmcnt(0)
    s_nop 7
    v_pk_mul_f32 v[128:129], v[128:129], v[100:101] op_sel_hi:[1,0]
    v_pk_mul_f32 v[144:145], v[144:145], v[100:101] op_sel_hi:[1,0]
    v_pk_mul_f32 v[130:131], v[130:131], v[100:101] op_sel_hi:[1,0]
    v_pk_mul_f32 v[146:147], v[146:147], v[100:101] op_sel_hi:[1,0]
    v_pk_mul_f32 v[132:133], v[132:133], v[100:101] op_sel_hi:[1,0]
    v_pk_mul_f32 v[148:149], v[148:149], v[100:101] op_sel_hi:[1,0]
    v_pk_mul_f32 v[134:135], v[134:135], v[100:101] op_sel_hi:[1,0]
    v_pk_mul_f32 v[150:151], v[150:151], v[100:101] op_sel_hi:[1,0]
    v_pk_mul_f32 v[136:137], v[136:137], v[100:101] op_sel_hi:[1,0]
    v_pk_mul_f32 v[152:153], v[152:153], v[100:101] op_sel_hi:[1,0]
    v_pk_mul_f32 v[138:139], v[138:139], v[100:101] op_sel_hi:[1,0]
    v_pk_mul_f32 v[154:155], v[154:155], v[100:101] op_sel_hi:[1,0]
    v_pk_mul_f32 v[140:141], v[140:141], v[100:101] op_sel_hi:[1,0]
    v_pk_mul_f32 v[156:157], v[156:157], v[100:101] op_sel_hi:[1,0]
    v_pk_mul_f32 v[142:143], v[142:143], v[100:101] op_sel_hi:[1,0]
    v_pk_mul_f32 v[158:159], v[158:159], v[100:101] op_sel_hi:[1,0]
    v_pk_fma_f32 v[128:129], v[108:109], v[68:69], v[128:129] op_sel_hi:[0,1,1]
    v_pk_fma_f32 v[144:145], v[108:109], v[84:85], v[144:145] op_sel_hi:[0,1,1]
    v_pk_fma_f32 v[130:131], v[108:109], v[70:71], v[130:131] op_sel_hi:[0,1,1]
    v_pk_fma_f32 v[146:147], v[108:109], v[86:87], v[146:147] op_sel_hi:[0,1,1]
    v_pk_fma_f32 v[132:133], v[108:109], v[72:73], v[132:133] op_sel_hi:[0,1,1]
    v_pk_fma_f32 v[148:149], v[108:109], v[88:89], v[148:149] op_sel_hi:[0,1,1]
    v_pk_fma_f32 v[134:135], v[108:109], v[74:75], v[134:135] op_sel_hi:[0,1,1]
    v_pk_fma_f32 v[150:151], v[108:109], v[90:91], v[150:151] op_sel_hi:[0,1,1]
    v_pk_fma_f32 v[136:137], v[108:109], v[76:77], v[136:137] op_sel_hi:[0,1,1]
    v_pk_fma_f32 v[152:153], v[108:109], v[92:93], v[152:153] op_sel_hi:[0,1,1]
    v_pk_fma_f32 v[138:139], v[108:109], v[78:79], v[138:139] op_sel_hi:[0,1,1]
    v_pk_fma_f32 v[154:155], v[108:109], v[94:95], v[154:155] op_sel_hi:[0,1,1]
    v_pk_fma_f32 v[140:141], v[108:109], v[80:81], v[140:141] op_sel_hi:[0,1,1]
    v_pk_fma_f32 v[156:157], v[108:109], v[96:97], v[156:157] op_sel_hi:[0,1,1]
    v_pk_fma_f32 v[142:143], v[108:109], v[82:83], v[142:143] op_sel_hi:[0,1,1]
    v_pk_fma_f32 v[158:159], v[108:109], v[98:99], v[158:159] op_sel_hi:[0,1,1]
    v_pk_mul_f32 v[20:21], v[128:129], v[128:129]
    v_pk_mul_f32 v[22:23], v[130:131], v[130:131]
    v_pk_mul_f32 v[24:25], v[132:133], v[132:133]
    v_pk_mul_f32 v[26:27], v[134:135], v[134:135]
    v_pk_mul_f32 v[28:29], v[136:137], v[136:137]
    v_pk_mul_f32 v[30:31], v[138:139], v[138:139]
    v_pk_mul_f32 v[32:33], v[140:141], v[140:141]
    v_pk_mul_f32 v[34:35], v[142:143], v[142:143]
    v_pk_fma_f32 v[20:21], v[20:21], v[118:119], v[116:117] op_sel_hi:[1,0,0]
    v_pk_fma_f32 v[22:23], v[22:23], v[118:119], v[116:117] op_sel_hi:[1,0,0]
    v_pk_fma_f32 v[24:25], v[24:25], v[118:119], v[116:117] op_sel_hi:[1,0,0]
    v_pk_fma_f32 v[26:27], v[26:27], v[118:119], v[116:117] op_sel_hi:[1,0,0]
    v_pk_fma_f32 v[28:29], v[28:29], v[118:119], v[116:117] op_sel_hi:[1,0,0]
    v_pk_fma_f32 v[30:31], v[30:31], v[118:119], v[116:117] op_sel_hi:[1,0,0]
    v_pk_fma_f32 v[32:33], v[32:33], v[118:119], v[116:117] op_sel_hi:[1,0,0]
    v_pk_fma_f32 v[34:35], v[34:35], v[118:119], v[116:117] op_sel_hi:[1,0,0]
    v_pk_mul_f32 v[20:21], v[20:21], v[128:129]
    v_pk_mul_f32 v[22:23], v[22:23], v[130:131]
    v_pk_mul_f32 v[24:25], v[24:25], v[132:133]
    v_pk_mul_f32 v[26:27], v[26:27], v[134:135]
    v_pk_mul_f32 v[28:29], v[28:29], v[136:137]
    v_pk_mul_f32 v[30:31], v[30:31], v[138:139]
    v_pk_mul_f32 v[32:33], v[32:33], v[140:141]
    v_pk_mul_f32 v[34:35], v[34:35], v[142:143]
    v_exp_f32 v20, v20
    v_exp_f32 v21, v21
    v_exp_f32 v22, v22
    v_exp_f32 v23, v23
    v_exp_f32 v24, v24
    v_exp_f32 v25, v25
    v_exp_f32 v26, v26
    v_exp_f32 v27, v27
    v_exp_f32 v28, v28
    v_exp_f32 v29, v29
    v_exp_f32 v30, v30
    v_exp_f32 v31, v31
    v_exp_f32 v32, v32
    v_exp_f32 v33, v33
    v_exp_f32 v34, v34
    v_exp_f32 v35, v35
    v_pk_mul_f32 v[128:129], v[128:129], v[144:145]
    v_pk_mul_f32 v[130:131], v[130:131], v[146:147]
    v_pk_mul_f32 v[132:133], v[132:133], v[148:149]
    v_pk_mul_f32 v[134:135], v[134:135], v[150:151]
    v_pk_mul_f32 v[136:137], v[136:137], v[152:153]
    v_pk_mul_f32 v[138:139], v[138:139], v[154:155]
    v_pk_mul_f32 v[140:141], v[140:141], v[156:157]
    v_pk_mul_f32 v[142:143], v[142:143], v[158:159]
    v_pk_add_f32 v[20:21], v[20:21], v[120:121] op_sel_hi:[1,0]
    v_pk_add_f32 v[22:23], v[22:23], v[120:121] op_sel_hi:[1,0]
    v_pk_add_f32 v[24:25], v[24:25], v[120:121] op_sel_hi:[1,0]
    v_pk_add_f32 v[26:27], v[26:27], v[120:121] op_sel_hi:[1,0]
    v_pk_add_f32 v[28:29], v[28:29], v[120:121] op_sel_hi:[1,0]
    v_pk_add_f32 v[30:31], v[30:31], v[120:121] op_sel_hi:[1,0]
    v_pk_add_f32 v[32:33], v[32:33], v[120:121] op_sel_hi:[1,0]
    v_pk_add_f32 v[34:35], v[34:35], v[120:121] op_sel_hi:[1,0]
    v_rcp_f32 v20, v20
    v_rcp_f32 v21, v21
    v_rcp_f32 v22, v22
    v_rcp_f32 v23, v23
    v_rcp_f32 v24, v24
    v_rcp_f32 v25, v25
    v_rcp_f32 v26, v26
    v_rcp_f32 v27, v27
    v_rcp_f32 v28, v28
    v_rcp_f32 v29, v29
    v_rcp_f32 v30, v30
    v_rcp_f32 v31, v31
    v_rcp_f32 v32, v32
    v_rcp_f32 v33, v33
    v_rcp_f32 v34, v34
    v_rcp_f32 v35, v35
    s_nop 0
    v_pk_mul_f32 v[20:21], v[20:21], v[128:129]
    v_pk_mul_f32 v[22:23], v[22:23], v[130:131]
    v_pk_mul_f32 v[24:25], v[24:25], v[132:133]
    v_pk_mul_f32 v[26:27], v[26:27], v[134:135]
    v_pk_mul_f32 v[28:29], v[28:29], v[136:137]
    v_pk_mul_f32 v[30:31], v[30:31], v[138:139]
    v_pk_mul_f32 v[32:33], v[32:33], v[140:141]
    v_pk_mul_f32 v[34:35], v[34:35], v[142:143]
    v_cvt_pk_bf16_f32 v128, v20, v21
    v_cvt_pk_bf16_f32 v129, v22, v23
    v_cvt_pk_bf16_f32 v130, v24, v25
    v_cvt_pk_bf16_f32 v131, v26, v27
    v_cvt_pk_bf16_f32 v132, v28, v29
    v_cvt_pk_bf16_f32 v133, v30, v31
    v_cvt_pk_bf16_f32 v134, v32, v33
    v_cvt_pk_bf16_f32 v135, v34, v35
    s_add_u32 s42, s37, 0x0
    buffer_store_dwordx4 v[128:131], v3, s[28:31], s42 offen
    buffer_store_dwordx4 v[132:135], v3, s[28:31], s42 offen offset:1024
    v_pk_mul_f32 v[160:161], v[160:161], v[102:103] op_sel_hi:[1,0]
    v_pk_mul_f32 v[176:177], v[176:177], v[102:103] op_sel_hi:[1,0]
    v_pk_mul_f32 v[162:163], v[162:163], v[102:103] op_sel_hi:[1,0]
    v_pk_mul_f32 v[178:179], v[178:179], v[102:103] op_sel_hi:[1,0]
    v_pk_mul_f32 v[164:165], v[164:165], v[102:103] op_sel_hi:[1,0]
    v_pk_mul_f32 v[180:181], v[180:181], v[102:103] op_sel_hi:[1,0]
    v_pk_mul_f32 v[166:167], v[166:167], v[102:103] op_sel_hi:[1,0]
    v_pk_mul_f32 v[182:183], v[182:183], v[102:103] op_sel_hi:[1,0]
    v_pk_mul_f32 v[168:169], v[168:169], v[102:103] op_sel_hi:[1,0]
    v_pk_mul_f32 v[184:185], v[184:185], v[102:103] op_sel_hi:[1,0]
    v_pk_mul_f32 v[170:171], v[170:171], v[102:103] op_sel_hi:[1,0]
    v_pk_mul_f32 v[186:187], v[186:187], v[102:103] op_sel_hi:[1,0]
    v_pk_mul_f32 v[172:173], v[172:173], v[102:103] op_sel_hi:[1,0]
    v_pk_mul_f32 v[188:189], v[188:189], v[102:103] op_sel_hi:[1,0]
    v_pk_mul_f32 v[174:175], v[174:175], v[102:103] op_sel_hi:[1,0]
    v_pk_mul_f32 v[190:191], v[190:191], v[102:103] op_sel_hi:[1,0]
    v_pk_fma_f32 v[160:161], v[110:111], v[68:69], v[160:161] op_sel_hi:[0,1,1]
    v_pk_fma_f32 v[176:177], v[110:111], v[84:85], v[176:177] op_sel_hi:[0,1,1]
    v_pk_fma_f32 v[162:163], v[110:111], v[70:71], v[162:163] op_sel_hi:[0,1,1]
    v_pk_fma_f32 v[178:179], v[110:111], v[86:87], v[178:179] op_sel_hi:[0,1,1]
    v_pk_fma_f32 v[164:165], v[110:111], v[72:73], v[164:165] op_sel_hi:[0,1,1]
    v_pk_fma_f32 v[180:181], v[110:111], v[88:89], v[180:181] op_sel_hi:[0,1,1]
    v_pk_fma_f32 v[166:167], v[110:111], v[74:75], v[166:167] op_sel_hi:[0,1,1]
    v_pk_fma_f32 v[182:183], v[110:111], v[90:91], v[182:183] op_sel_hi:[0,1,1]
    v_pk_fma_f32 v[168:169], v[110:111], v[76:77], v[168:169] op_sel_hi:[0,1,1]
    v_pk_fma_f32 v[184:185], v[110:111], v[92:93], v[184:185] op_sel_hi:[0,1,1]
    v_pk_fma_f32 v[170:171], v[110:111], v[78:79], v[170:171] op_sel_hi:[0,1,1]
    v_pk_fma_f32 v[186:187], v[110:111], v[94:95], v[186:187] op_sel_hi:[0,1,1]
    v_pk_fma_f32 v[172:173], v[110:111], v[80:81], v[172:173] op_sel_hi:[0,1,1]
    v_pk_fma_f32 v[188:189], v[110:111], v[96:97], v[188:189] op_sel_hi:[0,1,1]
    v_pk_fma_f32 v[174:175], v[110:111], v[82:83], v[174:175] op_sel_hi:[0,1,1]
    v_pk_fma_f32 v[190:191], v[110:111], v[98:99], v[190:191] op_sel_hi:[0,1,1]
    v_pk_mul_f32 v[20:21], v[160:161], v[160:161]
    v_pk_mul_f32 v[22:23], v[162:163], v[162:163]
    v_pk_mul_f32 v[24:25], v[164:165], v[164:165]
    v_pk_mul_f32 v[26:27], v[166:167], v[166:167]
    v_pk_mul_f32 v[28:29], v[168:169], v[168:169]
    v_pk_mul_f32 v[30:31], v[170:171], v[170:171]
    v_pk_mul_f32 v[32:33], v[172:173], v[172:173]
    v_pk_mul_f32 v[34:35], v[174:175], v[174:175]
    v_pk_fma_f32 v[20:21], v[20:21], v[118:119], v[116:117] op_sel_hi:[1,0,0]
    v_pk_fma_f32 v[22:23], v[22:23], v[118:119], v[116:117] op_sel_hi:[1,0,0]
    v_pk_fma_f32 v[24:25], v[24:25], v[118:119], v[116:117] op_sel_hi:[1,0,0]
    v_pk_fma_f32 v[26:27], v[26:27], v[118:119], v[116:117] op_sel_hi:[1,0,0]
    v_pk_fma_f32 v[28:29], v[28:29], v[118:119], v[116:117] op_sel_hi:[1,0,0]
    v_pk_fma_f32 v[30:31], v[30:31], v[118:119], v[116:117] op_sel_hi:[1,0,0]
    v_pk_fma_f32 v[32:33], v[32:33], v[118:119], v[116:117] op_sel_hi:[1,0,0]
    v_pk_fma_f32 v[34:35], v[34:35], v[118:119], v[116:117] op_sel_hi:[1,0,0]
    v_pk_mul_f32 v[20:21], v[20:21], v[160:161]
    v_pk_mul_f32 v[22:23], v[22:23], v[162:163]
    v_pk_mul_f32 v[24:25], v[24:25], v[164:165]
    v_pk_mul_f32 v[26:27], v[26:27], v[166:167]
    v_pk_mul_f32 v[28:29], v[28:29], v[168:169]
    v_pk_mul_f32 v[30:31], v[30:31], v[170:171]
    v_pk_mul_f32 v[32:33], v[32:33], v[172:173]
    v_pk_mul_f32 v[34:35], v[34:35], v[174:175]
    v_exp_f32 v20, v20
    v_exp_f32 v21, v21
    v_exp_f32 v22, v22
    v_exp_f32 v23, v23
    v_exp_f32 v24, v24
    v_exp_f32 v25, v25
    v_exp_f32 v26, v26
    v_exp_f32 v27, v27
    v_exp_f32 v28, v28
    v_exp_f32 v29, v29
    v_exp_f32 v30, v30
    v_exp_f32 v31, v31
    v_exp_f32 v32, v32
    v_exp_f32 v33, v33
    v_exp_f32 v34, v34
    v_exp_f32 v35, v35
    v_pk_mul_f32 v[160:161], v[160:161], v[176:177]
    v_pk_mul_f32 v[162:163], v[162:163], v[178:179]
    v_pk_mul_f32 v[164:165], v[164:165], v[180:181]
    v_pk_mul_f32 v[166:167], v[166:167], v[182:183]
    v_pk_mul_f32 v[168:169], v[168:169], v[184:185]
    v_pk_mul_f32 v[170:171], v[170:171], v[186:187]
    v_pk_mul_f32 v[172:173], v[172:173], v[188:189]
    v_pk_mul_f32 v[174:175], v[174:175], v[190:191]
    v_pk_add_f32 v[20:21], v[20:21], v[120:121] op_sel_hi:[1,0]
    v_pk_add_f32 v[22:23], v[22:23], v[120:121] op_sel_hi:[1,0]
    v_pk_add_f32 v[24:25], v[24:25], v[120:121] op_sel_hi:[1,0]
    v_pk_add_f32 v[26:27], v[26:27], v[120:121] op_sel_hi:[1,0]
    v_pk_add_f32 v[28:29], v[28:29], v[120:121] op_sel_hi:[1,0]
    v_pk_add_f32 v[30:31], v[30:31], v[120:121] op_sel_hi:[1,0]
    v_pk_add_f32 v[32:33], v[32:33], v[120:121] op_sel_hi:[1,0]
    v_pk_add_f32 v[34:35], v[34:35], v[120:121] op_sel_hi:[1,0]
    v_rcp_f32 v20, v20
    v_rcp_f32 v21, v21
    v_rcp_f32 v22, v22
    v_rcp_f32 v23, v23
    v_rcp_f32 v24, v24
    v_rcp_f32 v25, v25
    v_rcp_f32 v26, v26
    v_rcp_f32 v27, v27
    v_rcp_f32 v28, v28
    v_rcp_f32 v29, v29
    v_rcp_f32 v30, v30
    v_rcp_f32 v31, v31
    v_rcp_f32 v32, v32
    v_rcp_f32 v33, v33
    v_rcp_f32 v34, v34
    v_rcp_f32 v35, v35
    s_nop 0
    v_pk_mul_f32 v[20:21], v[20:21], v[160:161]
    v_pk_mul_f32 v[22:23], v[22:23], v[162:163]
    v_pk_mul_f32 v[24:25], v[24:25], v[164:165]
    v_pk_mul_f32 v[26:27], v[26:27], v[166:167]
    v_pk_mul_f32 v[28:29], v[28:29], v[168:169]
    v_pk_mul_f32 v[30:31], v[30:31], v[170:171]
    v_pk_mul_f32 v[32:33], v[32:33], v[172:173]
    v_pk_mul_f32 v[34:35], v[34:35], v[174:175]
    v_cvt_pk_bf16_f32 v160, v20, v21
    v_cvt_pk_bf16_f32 v161, v22, v23
    v_cvt_pk_bf16_f32 v162, v24, v25
    v_cvt_pk_bf16_f32 v163, v26, v27
    v_cvt_pk_bf16_f32 v164, v28, v29
    v_cvt_pk_bf16_f32 v165, v30, v31
    v_cvt_pk_bf16_f32 v166, v32, v33
    v_cvt_pk_bf16_f32 v167, v34, v35
    s_add_u32 s42, s37, 0x1b000
    buffer_store_dwordx4 v[160:163], v3, s[28:31], s42 offen
    buffer_store_dwordx4 v[164:167], v3, s[28:31], s42 offen offset:1024
    v_pk_mul_f32 v[192:193], v[192:193], v[104:105] op_sel_hi:[1,0]
    v_pk_mul_f32 v[208:209], v[208:209], v[104:105] op_sel_hi:[1,0]
    v_pk_mul_f32 v[194:195], v[194:195], v[104:105] op_sel_hi:[1,0]
    v_pk_mul_f32 v[210:211], v[210:211], v[104:105] op_sel_hi:[1,0]
    v_pk_mul_f32 v[196:197], v[196:197], v[104:105] op_sel_hi:[1,0]
    v_pk_mul_f32 v[212:213], v[212:213], v[104:105] op_sel_hi:[1,0]
    v_pk_mul_f32 v[198:199], v[198:199], v[104:105] op_sel_hi:[1,0]
    v_pk_mul_f32 v[214:215], v[214:215], v[104:105] op_sel_hi:[1,0]
    v_pk_mul_f32 v[200:201], v[200:201], v[104:105] op_sel_hi:[1,0]
    v_pk_mul_f32 v[216:217], v[216:217], v[104:105] op_sel_hi:[1,0]
    v_pk_mul_f32 v[202:203], v[202:203], v[104:105] op_sel_hi:[1,0]
    v_pk_mul_f32 v[218:219], v[218:219], v[104:105] op_sel_hi:[1,0]
    v_pk_mul_f32 v[204:205], v[204:205], v[104:105] op_sel_hi:[1,0]
    v_pk_mul_f32 v[220:221], v[220:221], v[104:105] op_sel_hi:[1,0]
    v_pk_mul_f32 v[206:207], v[206:207], v[104:105] op_sel_hi:[1,0]
    v_pk_mul_f32 v[222:223], v[222:223], v[104:105] op_sel_hi:[1,0]
    v_pk_fma_f32 v[192:193], v[112:113], v[68:69], v[192:193] op_sel_hi:[0,1,1]
    v_pk_fma_f32 v[208:209], v[112:113], v[84:85], v[208:209] op_sel_hi:[0,1,1]
    v_pk_fma_f32 v[194:195], v[112:113], v[70:71], v[194:195] op_sel_hi:[0,1,1]
    v_pk_fma_f32 v[210:211], v[112:113], v[86:87], v[210:211] op_sel_hi:[0,1,1]
    v_pk_fma_f32 v[196:197], v[112:113], v[72:73], v[196:197] op_sel_hi:[0,1,1]
    v_pk_fma_f32 v[212:213], v[112:113], v[88:89], v[212:213] op_sel_hi:[0,1,1]
    v_pk_fma_f32 v[198:199], v[112:113], v[74:75], v[198:199] op_sel_hi:[0,1,1]
    v_pk_fma_f32 v[214:215], v[112:113], v[90:91], v[214:215] op_sel_hi:[0,1,1]
    v_pk_fma_f32 v[200:201], v[112:113], v[76:77], v[200:201] op_sel_hi:[0,1,1]
    v_pk_fma_f32 v[216:217], v[112:113], v[92:93], v[216:217] op_sel_hi:[0,1,1]
    v_pk_fma_f32 v[202:203], v[112:113], v[78:79], v[202:203] op_sel_hi:[0,1,1]
    v_pk_fma_f32 v[218:219], v[112:113], v[94:95], v[218:219] op_sel_hi:[0,1,1]
    v_pk_fma_f32 v[204:205], v[112:113], v[80:81], v[204:205] op_sel_hi:[0,1,1]
    v_pk_fma_f32 v[220:221], v[112:113], v[96:97], v[220:221] op_sel_hi:[0,1,1]
    v_pk_fma_f32 v[206:207], v[112:113], v[82:83], v[206:207] op_sel_hi:[0,1,1]
    v_pk_fma_f32 v[222:223], v[112:113], v[98:99], v[222:223] op_sel_hi:[0,1,1]
    v_pk_mul_f32 v[20:21], v[192:193], v[192:193]
    v_pk_mul_f32 v[22:23], v[194:195], v[194:195]
    v_pk_mul_f32 v[24:25], v[196:197], v[196:197]
    v_pk_mul_f32 v[26:27], v[198:199], v[198:199]
    v_pk_mul_f32 v[28:29], v[200:201], v[200:201]
    v_pk_mul_f32 v[30:31], v[202:203], v[202:203]
    v_pk_mul_f32 v[32:33], v[204:205], v[204:205]
    v_pk_mul_f32 v[34:35], v[206:207], v[206:207]
    v_pk_fma_f32 v[20:21], v[20:21], v[118:119], v[116:117] op_sel_hi:[1,0,0]
    v_pk_fma_f32 v[22:23], v[22:23], v[118:119], v[116:117] op_sel_hi:[1,0,0]
    v_pk_fma_f32 v[24:25], v[24:25], v[118:119], v[116:117] op_sel_hi:[1,0,0]
    v_pk_fma_f32 v[26:27], v[26:27], v[118:119], v[116:117] op_sel_hi:[1,0,0]
    v_pk_fma_f32 v[28:29], v[28:29], v[118:119], v[116:117] op_sel_hi:[1,0,0]
    v_pk_fma_f32 v[30:31], v[30:31], v[118:119], v[116:117] op_sel_hi:[1,0,0]
    v_pk_fma_f32 v[32:33], v[32:33], v[118:119], v[116:117] op_sel_hi:[1,0,0]
    v_pk_fma_f32 v[34:35], v[34:35], v[118:119], v[116:117] op_sel_hi:[1,0,0]
    v_pk_mul_f32 v[20:21], v[20:21], v[192:193]
    v_pk_mul_f32 v[22:23], v[22:23], v[194:195]
    v_pk_mul_f32 v[24:25], v[24:25], v[196:197]
    v_pk_mul_f32 v[26:27], v[26:27], v[198:199]
    v_pk_mul_f32 v[28:29], v[28:29], v[200:201]
    v_pk_mul_f32 v[30:31], v[30:31], v[202:203]
    v_pk_mul_f32 v[32:33], v[32:33], v[204:205]
    v_pk_mul_f32 v[34:35], v[34:35], v[206:207]
    v_exp_f32 v20, v20
    v_exp_f32 v21, v21
    v_exp_f32 v22, v22
    v_exp_f32 v23, v23
    v_exp_f32 v24, v24
    v_exp_f32 v25, v25
    v_exp_f32 v26, v26
    v_exp_f32 v27, v27
    v_exp_f32 v28, v28
    v_exp_f32 v29, v29
    v_exp_f32 v30, v30
    v_exp_f32 v31, v31
    v_exp_f32 v32, v32
    v_exp_f32 v33, v33
    v_exp_f32 v34, v34
    v_exp_f32 v35, v35
    v_pk_mul_f32 v[192:193], v[192:193], v[208:209]
    v_pk_mul_f32 v[194:195], v[194:195], v[210:211]
    v_pk_mul_f32 v[196:197], v[196:197], v[212:213]
    v_pk_mul_f32 v[198:199], v[198:199], v[214:215]
    v_pk_mul_f32 v[200:201], v[200:201], v[216:217]
    v_pk_mul_f32 v[202:203], v[202:203], v[218:219]
    v_pk_mul_f32 v[204:205], v[204:205], v[220:221]
    v_pk_mul_f32 v[206:207], v[206:207], v[222:223]
    v_pk_add_f32 v[20:21], v[20:21], v[120:121] op_sel_hi:[1,0]
    v_pk_add_f32 v[22:23], v[22:23], v[120:121] op_sel_hi:[1,0]
    v_pk_add_f32 v[24:25], v[24:25], v[120:121] op_sel_hi:[1,0]
    v_pk_add_f32 v[26:27], v[26:27], v[120:121] op_sel_hi:[1,0]
    v_pk_add_f32 v[28:29], v[28:29], v[120:121] op_sel_hi:[1,0]
    v_pk_add_f32 v[30:31], v[30:31], v[120:121] op_sel_hi:[1,0]
    v_pk_add_f32 v[32:33], v[32:33], v[120:121] op_sel_hi:[1,0]
    v_pk_add_f32 v[34:35], v[34:35], v[120:121] op_sel_hi:[1,0]
    v_rcp_f32 v20, v20
    v_rcp_f32 v21, v21
    v_rcp_f32 v22, v22
    v_rcp_f32 v23, v23
    v_rcp_f32 v24, v24
    v_rcp_f32 v25, v25
    v_rcp_f32 v26, v26
    v_rcp_f32 v27, v27
    v_rcp_f32 v28, v28
    v_rcp_f32 v29, v29
    v_rcp_f32 v30, v30
    v_rcp_f32 v31, v31
    v_rcp_f32 v32, v32
    v_rcp_f32 v33, v33
    v_rcp_f32 v34, v34
    v_rcp_f32 v35, v35
    s_nop 0
    v_pk_mul_f32 v[20:21], v[20:21], v[192:193]
    v_pk_mul_f32 v[22:23], v[22:23], v[194:195]
    v_pk_mul_f32 v[24:25], v[24:25], v[196:197]
    v_pk_mul_f32 v[26:27], v[26:27], v[198:199]
    v_pk_mul_f32 v[28:29], v[28:29], v[200:201]
    v_pk_mul_f32 v[30:31], v[30:31], v[202:203]
    v_pk_mul_f32 v[32:33], v[32:33], v[204:205]
    v_pk_mul_f32 v[34:35], v[34:35], v[206:207]
    v_cvt_pk_bf16_f32 v192, v20, v21
    v_cvt_pk_bf16_f32 v193, v22, v23
    v_cvt_pk_bf16_f32 v194, v24, v25
    v_cvt_pk_bf16_f32 v195, v26, v27
    v_cvt_pk_bf16_f32 v196, v28, v29
    v_cvt_pk_bf16_f32 v197, v30, v31
    v_cvt_pk_bf16_f32 v198, v32, v33
    v_cvt_pk_bf16_f32 v199, v34, v35
    s_add_u32 s42, s37, 0x36000
    buffer_store_dwordx4 v[192:195], v3, s[28:31], s42 offen
    buffer_store_dwordx4 v[196:199], v3, s[28:31], s42 offen offset:1024
    v_pk_mul_f32 v[224:225], v[224:225], v[106:107] op_sel_hi:[1,0]
    v_pk_mul_f32 v[240:241], v[240:241], v[106:107] op_sel_hi:[1,0]
    v_pk_mul_f32 v[226:227], v[226:227], v[106:107] op_sel_hi:[1,0]
    v_pk_mul_f32 v[242:243], v[242:243], v[106:107] op_sel_hi:[1,0]
    v_pk_mul_f32 v[228:229], v[228:229], v[106:107] op_sel_hi:[1,0]
    v_pk_mul_f32 v[244:245], v[244:245], v[106:107] op_sel_hi:[1,0]
    v_pk_mul_f32 v[230:231], v[230:231], v[106:107] op_sel_hi:[1,0]
    v_pk_mul_f32 v[246:247], v[246:247], v[106:107] op_sel_hi:[1,0]
    v_pk_mul_f32 v[232:233], v[232:233], v[106:107] op_sel_hi:[1,0]
    v_pk_mul_f32 v[248:249], v[248:249], v[106:107] op_sel_hi:[1,0]
    v_pk_mul_f32 v[234:235], v[234:235], v[106:107] op_sel_hi:[1,0]
    v_pk_mul_f32 v[250:251], v[250:251], v[106:107] op_sel_hi:[1,0]
    v_pk_mul_f32 v[236:237], v[236:237], v[106:107] op_sel_hi:[1,0]
    v_pk_mul_f32 v[252:253], v[252:253], v[106:107] op_sel_hi:[1,0]
    v_pk_mul_f32 v[238:239], v[238:239], v[106:107] op_sel_hi:[1,0]
    v_pk_mul_f32 v[254:255], v[254:255], v[106:107] op_sel_hi:[1,0]
    v_pk_fma_f32 v[224:225], v[114:115], v[68:69], v[224:225] op_sel_hi:[0,1,1]
    v_pk_fma_f32 v[240:241], v[114:115], v[84:85], v[240:241] op_sel_hi:[0,1,1]
    v_pk_fma_f32 v[226:227], v[114:115], v[70:71], v[226:227] op_sel_hi:[0,1,1]
    v_pk_fma_f32 v[242:243], v[114:115], v[86:87], v[242:243] op_sel_hi:[0,1,1]
    v_pk_fma_f32 v[228:229], v[114:115], v[72:73], v[228:229] op_sel_hi:[0,1,1]
    v_pk_fma_f32 v[244:245], v[114:115], v[88:89], v[244:245] op_sel_hi:[0,1,1]
    v_pk_fma_f32 v[230:231], v[114:115], v[74:75], v[230:231] op_sel_hi:[0,1,1]
    v_pk_fma_f32 v[246:247], v[114:115], v[90:91], v[246:247] op_sel_hi:[0,1,1]
    v_pk_fma_f32 v[232:233], v[114:115], v[76:77], v[232:233] op_sel_hi:[0,1,1]
    v_pk_fma_f32 v[248:249], v[114:115], v[92:93], v[248:249] op_sel_hi:[0,1,1]
    v_pk_fma_f32 v[234:235], v[114:115], v[78:79], v[234:235] op_sel_hi:[0,1,1]
    v_pk_fma_f32 v[250:251], v[114:115], v[94:95], v[250:251] op_sel_hi:[0,1,1]
    v_pk_fma_f32 v[236:237], v[114:115], v[80:81], v[236:237] op_sel_hi:[0,1,1]
    v_pk_fma_f32 v[252:253], v[114:115], v[96:97], v[252:253] op_sel_hi:[0,1,1]
    v_pk_fma_f32 v[238:239], v[114:115], v[82:83], v[238:239] op_sel_hi:[0,1,1]
    v_pk_fma_f32 v[254:255], v[114:115], v[98:99], v[254:255] op_sel_hi:[0,1,1]
    v_pk_mul_f32 v[20:21], v[224:225], v[224:225]
    v_pk_mul_f32 v[22:23], v[226:227], v[226:227]
    v_pk_mul_f32 v[24:25], v[228:229], v[228:229]
    v_pk_mul_f32 v[26:27], v[230:231], v[230:231]
    v_pk_mul_f32 v[28:29], v[232:233], v[232:233]
    v_pk_mul_f32 v[30:31], v[234:235], v[234:235]
    v_pk_mul_f32 v[32:33], v[236:237], v[236:237]
    v_pk_mul_f32 v[34:35], v[238:239], v[238:239]
    v_pk_fma_f32 v[20:21], v[20:21], v[118:119], v[116:117] op_sel_hi:[1,0,0]
    v_pk_fma_f32 v[22:23], v[22:23], v[118:119], v[116:117] op_sel_hi:[1,0,0]
    v_pk_fma_f32 v[24:25], v[24:25], v[118:119], v[116:117] op_sel_hi:[1,0,0]
    v_pk_fma_f32 v[26:27], v[26:27], v[118:119], v[116:117] op_sel_hi:[1,0,0]
    v_pk_fma_f32 v[28:29], v[28:29], v[118:119], v[116:117] op_sel_hi:[1,0,0]
    v_pk_fma_f32 v[30:31], v[30:31], v[118:119], v[116:117] op_sel_hi:[1,0,0]
    v_pk_fma_f32 v[32:33], v[32:33], v[118:119], v[116:117] op_sel_hi:[1,0,0]
    v_pk_fma_f32 v[34:35], v[34:35], v[118:119], v[116:117] op_sel_hi:[1,0,0]
    v_pk_mul_f32 v[20:21], v[20:21], v[224:225]
    v_pk_mul_f32 v[22:23], v[22:23], v[226:227]
    v_pk_mul_f32 v[24:25], v[24:25], v[228:229]
    v_pk_mul_f32 v[26:27], v[26:27], v[230:231]
    v_pk_mul_f32 v[28:29], v[28:29], v[232:233]
    v_pk_mul_f32 v[30:31], v[30:31], v[234:235]
    v_pk_mul_f32 v[32:33], v[32:33], v[236:237]
    v_pk_mul_f32 v[34:35], v[34:35], v[238:239]
    v_exp_f32 v20, v20
    v_exp_f32 v21, v21
    v_exp_f32 v22, v22
    v_exp_f32 v23, v23
    v_exp_f32 v24, v24
    v_exp_f32 v25, v25
    v_exp_f32 v26, v26
    v_exp_f32 v27, v27
    v_exp_f32 v28, v28
    v_exp_f32 v29, v29
    v_exp_f32 v30, v30
    v_exp_f32 v31, v31
    v_exp_f32 v32, v32
    v_exp_f32 v33, v33
    v_exp_f32 v34, v34
    v_exp_f32 v35, v35
    v_pk_mul_f32 v[224:225], v[224:225], v[240:241]
    v_pk_mul_f32 v[226:227], v[226:227], v[242:243]
    v_pk_mul_f32 v[228:229], v[228:229], v[244:245]
    v_pk_mul_f32 v[230:231], v[230:231], v[246:247]
    v_pk_mul_f32 v[232:233], v[232:233], v[248:249]
    v_pk_mul_f32 v[234:235], v[234:235], v[250:251]
    v_pk_mul_f32 v[236:237], v[236:237], v[252:253]
    v_pk_mul_f32 v[238:239], v[238:239], v[254:255]
    v_pk_add_f32 v[20:21], v[20:21], v[120:121] op_sel_hi:[1,0]
    v_pk_add_f32 v[22:23], v[22:23], v[120:121] op_sel_hi:[1,0]
    v_pk_add_f32 v[24:25], v[24:25], v[120:121] op_sel_hi:[1,0]
    v_pk_add_f32 v[26:27], v[26:27], v[120:121] op_sel_hi:[1,0]
    v_pk_add_f32 v[28:29], v[28:29], v[120:121] op_sel_hi:[1,0]
    v_pk_add_f32 v[30:31], v[30:31], v[120:121] op_sel_hi:[1,0]
    v_pk_add_f32 v[32:33], v[32:33], v[120:121] op_sel_hi:[1,0]
    v_pk_add_f32 v[34:35], v[34:35], v[120:121] op_sel_hi:[1,0]
    v_rcp_f32 v20, v20
    v_rcp_f32 v21, v21
    v_rcp_f32 v22, v22
    v_rcp_f32 v23, v23
    v_rcp_f32 v24, v24
    v_rcp_f32 v25, v25
    v_rcp_f32 v26, v26
    v_rcp_f32 v27, v27
    v_rcp_f32 v28, v28
    v_rcp_f32 v29, v29
    v_rcp_f32 v30, v30
    v_rcp_f32 v31, v31
    v_rcp_f32 v32, v32
    v_rcp_f32 v33, v33
    v_rcp_f32 v34, v34
    v_rcp_f32 v35, v35
    s_nop 0
    v_pk_mul_f32 v[20:21], v[20:21], v[224:225]
    v_pk_mul_f32 v[22:23], v[22:23], v[226:227]
    v_pk_mul_f32 v[24:25], v[24:25], v[228:229]
    v_pk_mul_f32 v[26:27], v[26:27], v[230:231]
    v_pk_mul_f32 v[28:29], v[28:29], v[232:233]
    v_pk_mul_f32 v[30:31], v[30:31], v[234:235]
    v_pk_mul_f32 v[32:33], v[32:33], v[236:237]
    v_pk_mul_f32 v[34:35], v[34:35], v[238:239]
    v_cvt_pk_bf16_f32 v224, v20, v21
    v_cvt_pk_bf16_f32 v225, v22, v23
    v_cvt_pk_bf16_f32 v226, v24, v25
    v_cvt_pk_bf16_f32 v227, v26, v27
    v_cvt_pk_bf16_f32 v228, v28, v29
    v_cvt_pk_bf16_f32 v229, v30, v31
    v_cvt_pk_bf16_f32 v230, v32, v33
    v_cvt_pk_bf16_f32 v231, v34, v35
    s_add_u32 s42, s37, 0x51000
    buffer_store_dwordx4 v[224:227], v3, s[28:31], s42 offen
    buffer_store_dwordx4 v[228:231], v3, s[28:31], s42 offen offset:1024
    s_branch L_gu_end
L_gu_idle:
    s_add_u32 s42, s35, 0x0
    s_mov_b32 m0, s42
    s_add_u32 s43, s34, 0x0
    buffer_load_dwordx4 v3, s[12:15], s43 offen lds
    s_add_u32 s42, s35, 0x1000
    s_mov_b32 m0, s42
    s_add_u32 s43, s34, 0x400
    buffer_load_dwordx4 v3, s[12:15], s43 offen lds
    s_add_u32 s42, s35, 0x2000
    s_mov_b32 m0, s42
    s_add_u32 s43, s34, 0x800
    buffer_load_dwordx4 v3, s[12:15], s43 offen lds
    s_add_u32 s42, s35, 0x3000
    s_mov_b32 m0, s42
    s_add_u32 s43, s34, 0xc00
    buffer_load_dwordx4 v3, s[12:15], s43 offen lds
    s_add_u32 s42, s35, 0x4000
    s_mov_b32 m0, s42
    s_add_u32 s43, s34, 0x1000
    buffer_load_dwordx4 v3, s[12:15], s43 offen lds
    s_add_u32 s42, s35, 0x5000
    s_mov_b32 m0, s42
    s_add_u32 s43, s34, 0x1400
    buffer_load_dwordx4 v3, s[12:15], s43 offen lds
    s_add_u32 s42, s35, 0x6000
    s_mov_b32 m0, s42
    s_add_u32 s43, s34, 0x1800
    buffer_load_dwordx4 v3, s[12:15], s43 offen lds
    s_add_u32 s42, s35, 0x7000
    s_mov_b32 m0, s42
    s_add_u32 s43, s34, 0x1c00
    buffer_load_dwordx4 v3, s[12:15], s43 offen lds
    s_add_u32 s42, s35, 0x8000
    s_mov_b32 m0, s42
    s_add_u32 s43, s34, 0x2000
    buffer_load_dwordx4 v3, s[12:15], s43 offen lds
    s_add_u32 s42, s35, 0x9000
    s_mov_b32 m0, s42
    s_add_u32 s43, s34, 0x2400
    buffer_load_dwordx4 v3, s[12:15], s43 offen lds
    s_waitcnt vmcnt(0)
    s_barrier
    s_add_u32 s42, s35, 0xa000
    s_mov_b32 m0, s42
    s_add_u32 s43, s34, 0x2800
    buffer_load_dwordx4 v3, s[12:15], s43 offen lds
    s_add_u32 s42, s35, 0xb000
    s_mov_b32 m0, s42
    s_add_u32 s43, s34, 0x2c00
    buffer_load_dwordx4 v3, s[12:15], s43 offen lds
    s_add_u32 s42, s35, 0xc000
    s_mov_b32 m0, s42
    s_add_u32 s43, s34, 0x3000
    buffer_load_dwordx4 v3, s[12:15], s43 offen lds
    s_add_u32 s42, s35, 0xd000
    s_mov_b32 m0, s42
    s_add_u32 s43, s34, 0x3400
    buffer_load_dwordx4 v3, s[12:15], s43 offen lds
    s_mov_b32 s41, 0x0
    buffer_load_dwordx2 v[100:101], v9, s[20:23], s41 offen
    s_mov_b32 s41, 0x4000
    buffer_load_dwordx2 v[102:103], v9, s[20:23], s41 offen
    s_mov_b32 s41, 0x8000
    buffer_load_dwordx2 v[104:105], v9, s[20:23], s41 offen
    s_mov_b32 s41, 0xc000
    buffer_load_dwordx2 v[106:107], v9, s[20:23], s41 offen
    s_add_u32 s42, s35, 0xe000
    s_mov_b32 m0, s42
    s_add_u32 s43, s34, 0x3800
    buffer_load_dwordx4 v3, s[12:15], s43 offen lds
    s_add_u32 s42, s35, 0xf000
    s_mov_b32 m0, s42
    s_add_u32 s43, s34, 0x3c00
    buffer_load_dwordx4 v3, s[12:15], s43 offen lds
    s_add_u32 s42, s35, 0x10000
    s_mov_b32 m0, s42
    s_add_u32 s43, s34, 0x4000
    buffer_load_dwordx4 v3, s[12:15], s43 offen lds
    s_add_u32 s42, s35, 0x11000
    s_mov_b32 m0, s42
    s_add_u32 s43, s34, 0x4400
    buffer_load_dwordx4 v3, s[12:15], s43 offen lds
    s_mov_b32 s41, 0x10000
    buffer_load_dwordx2 v[108:109], v9, s[20:23], s41 offen
    s_mov_b32 s41, 0x14000
    buffer_load_dwordx2 v[110:111], v9, s[20:23], s41 offen
    s_mov_b32 s41, 0x18000
    buffer_load_dwordx2 v[112:113], v9, s[20:23], s41 offen
    s_mov_b32 s41, 0x1c000
    buffer_load_dwordx2 v[114:115], v9, s[20:23], s41 offen
    s_add_u32 s42, s35, 0x12000
    s_mov_b32 m0, s42
    s_add_u32 s43, s34, 0x4800
    buffer_load_dwordx4 v3, s[12:15], s43 offen lds
    s_add_u32 s42, s35, 0x13000
    s_mov_b32 m0, s42
    s_add_u32 s43, s34, 0x4c00
    buffer_load_dwordx4 v3, s[12:15], s43 offen lds
    s_add_u32 s42, s35, 0x14000
    s_mov_b32 m0, s42
    s_add_u32 s43, s34, 0x5000
    buffer_load_dwordx4 v3, s[12:15], s43 offen lds
    s_add_u32 s42, s35, 0x15000
    s_mov_b32 m0, s42
    s_add_u32 s43, s34, 0x5400
    buffer_load_dwordx4 v3, s[12:15], s43 offen lds
    s_mov_b32 s41, 0x20000
    buffer_load_dwordx2 v[116:117], v9, s[20:23], s41 offen
    s_mov_b32 s41, 0x24000
    buffer_load_dwordx2 v[118:119], v9, s[20:23], s41 offen
    s_mov_b32 s41, 0x28000
    buffer_load_dwordx2 v[120:121], v9, s[20:23], s41 offen
    s_mov_b32 s41, 0x2c000
    buffer_load_dwordx2 v[122:123], v9, s[20:23], s41 offen
    s_add_u32 s42, s35, 0x16000
    s_mov_b32 m0, s42
    s_add_u32 s43, s34, 0x5800
    buffer_load_dwordx4 v3, s[12:15], s43 offen lds
    s_add_u32 s42, s35, 0x17000
    s_mov_b32 m0, s42
    s_add_u32 s43, s34, 0x5c00
    buffer_load_dwordx4 v3, s[12:15], s43 offen lds
    s_add_u32 s42, s35, 0x18000
    s_mov_b32 m0, s42
    s_add_u32 s43, s34, 0x6000
    buffer_load_dwordx4 v3, s[12:15], s43 offen lds
    s_add_u32 s42, s35, 0x19000
    s_mov_b32 m0, s42
    s_add_u32 s43, s34, 0x6400
    buffer_load_dwordx4 v3, s[12:15], s43 offen lds
    s_waitcnt vmcnt(20)
    v_mov_b32 v124, v100
    v_mov_b32 v125, v101
    v_add_f32 v124, v124, v102
    v_add_f32 v125, v125, v103
    v_add_f32 v124, v124, v104
    v_add_f32 v125, v125, v105
    v_add_f32 v124, v124, v106
    v_add_f32 v125, v125, v107
    s_mov_b32 s41, 0x30000
    buffer_load_dwordx2 v[100:101], v9, s[20:23], s41 offen
    s_mov_b32 s41, 0x34000
    buffer_load_dwordx2 v[102:103], v9, s[20:23], s41 offen
    s_mov_b32 s41, 0x38000
    buffer_load_dwordx2 v[104:105], v9, s[20:23], s41 offen
    s_mov_b32 s41, 0x3c000
    buffer_load_dwordx2 v[106:107], v9, s[20:23], s41 offen
    s_add_u32 s42, s35, 0x1a000
    s_mov_b32 m0, s42
    s_add_u32 s43, s34, 0x6800
    buffer_load_dwordx4 v3, s[12:15], s43 offen lds
    s_add_u32 s42, s35, 0x1b000
    s_mov_b32 m0, s42
    s_add_u32 s43, s34, 0x6c00
    buffer_load_dwordx4 v3, s[12:15], s43 offen lds
    s_add_u32 s42, s35, 0x1c000
    s_mov_b32 m0, s42
    s_add_u32 s43, s34, 0x7000
    buffer_load_dwordx4 v3, s[12:15], s43 offen lds
    s_add_u32 s42, s35, 0x1d000
    s_mov_b32 m0, s42
    s_add_u32 s43, s34, 0x7400
    buffer_load_dwordx4 v3, s[12:15], s43 offen lds
    s_waitcnt vmcnt(20)
    v_add_f32 v124, v124, v108
    v_add_f32 v125, v125, v109
    v_add_f32 v124, v124, v110
    v_add_f32 v125, v125, v111
    v_add_f32 v124, v124, v112
    v_add_f32 v125, v125, v113
    v_add_f32 v124, v124, v114
    v_add_f32 v125, v125, v115
    s_mov_b32 s41, 0x40000
    buffer_load_dwordx2 v[108:109], v9, s[20:23], s41 offen
    s_mov_b32 s41, 0x44000
    buffer_load_dwordx2 v[110:111], v9, s[20:23], s41 offen
    s_mov_b32 s41, 0x48000
    buffer_load_dwordx2 v[112:113], v9, s[20:23], s41 offen
    s_mov_b32 s41, 0x4c000
    buffer_load_dwordx2 v[114:115], v9, s[20:23], s41 offen
    s_waitcnt vmcnt(22)
    s_barrier
    s_add_u32 s42, s35, 0x1e000
    s_mov_b32 m0, s42
    s_add_u32 s43, s34, 0x7800
    buffer_load_dwordx4 v3, s[12:15], s43 offen lds
    s_add_u32 s42, s35, 0x1f000
    s_mov_b32 m0, s42
    s_add_u32 s43, s34, 0x7c00
    buffer_load_dwordx4 v3, s[12:15], s43 offen lds
    s_add_u32 s42, s35, 0x20000
    s_mov_b32 m0, s42
    s_add_u32 s43, s34, 0x8000
    buffer_load_dwordx4 v3, s[12:15], s43 offen lds
    s_add_u32 s42, s35, 0x21000
    s_mov_b32 m0, s42
    s_add_u32 s43, s34, 0x8400
    buffer_load_dwordx4 v3, s[12:15], s43 offen lds
    s_waitcnt vmcnt(20)
    v_add_f32 v124, v124, v116
    v_add_f32 v125, v125, v117
    v_add_f32 v124, v124, v118
    v_add_f32 v125, v125, v119
    v_add_f32 v124, v124, v120
    v_add_f32 v125, v125, v121
    v_add_f32 v124, v124, v122
    v_add_f32 v125, v125, v123
    s_add_u32 s42, s35, 0x22000
    s_mov_b32 m0, s42
    s_add_u32 s43, s34, 0x8800
    buffer_load_dwordx4 v3, s[12:15], s43 offen lds
    s_add_u32 s42, s35, 0x23000
    s_mov_b32 m0, s42
    s_add_u32 s43, s34, 0x8c00
    buffer_load_dwordx4 v3, s[12:15], s43 offen lds
    s_add_u32 s42, s35, 0x24000
    s_mov_b32 m0, s42
    s_add_u32 s43, s34, 0x9000
    buffer_load_dwordx4 v3, s[12:15], s43 offen lds
    s_add_u32 s42, s35, 0x25000
    s_mov_b32 m0, s42
    s_add_u32 s43, s34, 0x9400
    buffer_load_dwordx4 v3, s[12:15], s43 offen lds
    s_waitcnt vmcnt(16)
    v_add_f32 v124, v124, v100
    v_add_f32 v125, v125, v101
    v_add_f32 v124, v124, v102
    v_add_f32 v125, v125, v103
    v_add_f32 v124, v124, v104
    v_add_f32 v125, v125, v105
    v_add_f32 v124, v124, v106
    v_add_f32 v125, v125, v107
    s_add_u32 s42, s35, 0x26000
    s_mov_b32 m0, s42
    s_add_u32 s43, s34, 0x9800
    buffer_load_dwordx4 v3, s[12:15], s43 offen lds
    s_add_u32 s42, s35, 0x27000
    s_mov_b32 m0, s42
    s_add_u32 s43, s34, 0x9c00
    buffer_load_dwordx4 v3, s[12:15], s43 offen lds
    s_waitcnt vmcnt(10)
    v_add_f32 v124, v124, v108
    v_add_f32 v125, v125, v109
    v_add_f32 v124, v124, v110
    v_add_f32 v125, v125, v111
    v_add_f32 v124, v124, v112
    v_add_f32 v125, v125, v113
    v_add_f32 v124, v124, v114
    v_add_f32 v125, v125, v115
    v_mul_f32 v102, 0x3acccccd, v124
    v_mul_f32 v103, 0x3acccccd, v125
    v_fma_f32 v103, -v102, v102, v103
    v_max_f32 v103, 0, v103
    v_cvt_pk_bf16_f32 v102, v102, v102
    v_lshlrev_b32 v102, 16, v102
    v_cvt_pk_bf16_f32 v103, v103, v103
    v_lshlrev_b32 v103, 16, v103
    v_add_f32 v103, 0x3727c5ac, v103
    v_cvt_pk_bf16_f32 v103, v103, v103
    v_lshlrev_b32 v103, 16, v103
    v_sqrt_f32 v103, v103
    s_nop 0
    v_cvt_pk_bf16_f32 v103, v103, v103
    v_lshlrev_b32 v103, 16, v103
    v_rcp_f32 v18, v103
    s_nop 0
    v_mul_f32 v19, v102, v18
    v_sub_f32 v19, 0, v19
    s_barrier
    ds_write_b32 v16, v18
    ds_write_b32 v16, v19 offset:512
    s_waitcnt lgkmcnt(0)
    s_waitcnt vmcnt(0)
    s_barrier
    s_waitcnt vmcnt(0) lgkmcnt(0)
L_gu_end:
    s_endpgm
.globl down_kernel
.p2align 8
.type down_kernel,@function
down_kernel:
    s_load_dwordx2 s[4:5], s[0:1], 72
    s_cmp_ge_u32 s2, 256
    s_cbranch_scc1 L_down_kernel_end
    s_and_b32 s6, s2, 7
    s_lshr_b32 s7, s2, 3
    s_lshr_b32 s8, s6, 1
    s_lshl_b32 s8, s8, 4
    s_lshr_b32 s9, s7, 1
    s_add_u32 s8, s8, s9
    s_and_b32 s9, s6, 1
    s_lshl_b32 s9, s9, 1
    s_and_b32 s7, s7, 1
    s_add_u32 s9, s9, s7
    v_lshrrev_b32 v1, 6, v0
    v_and_b32 v0, 63, v0
    s_nop 0
    v_readfirstlane_b32 s10, v1
    v_and_b32 v1, 31, v0
    v_lshrrev_b32 v2, 5, v0
    v_lshlrev_b32 v3, 4, v0
    s_waitcnt lgkmcnt(0)
    s_add_u32 s12, s4, 0x2400000
    s_addc_u32 s13, s5, 0
    s_and_b32 s13, s13, 0xffff
    s_mov_b32 s14, 0x6c0000
    s_mov_b32 s15, 0x00020000
    s_add_u32 s16, s4, 0xc00000
    s_addc_u32 s17, s5, 0
    s_and_b32 s17, s17, 0xffff
    s_mov_b32 s18, 0x21c000
    s_mov_b32 s19, 0x00020000
    s_add_u32 s20, s4, 0x1300000
    s_addc_u32 s21, s5, 0
    s_and_b32 s21, s21, 0xffff
    s_mov_b32 s22, 0x50000
    s_mov_b32 s23, 0x00020000
    s_add_u32 s24, s4, 0x1000000
    s_addc_u32 s25, s5, 0
    s_and_b32 s25, s25, 0xffff
    s_mov_b32 s26, 0x280000
    s_mov_b32 s27, 0x00020000
    s_mul_i32 s34, s10, 27648
    s_mul_i32 s32, s8, 110592
    s_add_u32 s32, s32, s34
    v_add_u32 v4, s32, v3
    s_mul_i32 s33, s9, 552960
    s_add_u32 s33, s33, s34
    v_add_u32 v5, s33, v3
    v_add_u32 v6, 0x1b000, v5
    v_add_u32 v7, 0x36000, v5
    v_add_u32 v8, 0x51000, v5
    v_add_u32 v9, 0x6c000, v5
    s_mov_b32 s40, 0x0
    buffer_load_dwordx4 a[0:3], v4, s[12:15], s40 offen offset:0
    buffer_load_dwordx4 a[4:7], v5, s[16:19], s40 offen offset:0
    buffer_load_dwordx4 a[8:11], v6, s[16:19], s40 offen offset:0
    buffer_load_dwordx4 a[12:15], v7, s[16:19], s40 offen offset:0
    buffer_load_dwordx4 a[16:19], v8, s[16:19], s40 offen offset:0
    buffer_load_dwordx4 a[20:23], v9, s[16:19], s40 offen offset:0
    buffer_load_dwordx4 a[24:27], v4, s[12:15], s40 offen offset:1024
    buffer_load_dwordx4 a[28:31], v5, s[16:19], s40 offen offset:1024
    buffer_load_dwordx4 a[32:35], v6, s[16:19], s40 offen offset:1024
    buffer_load_dwordx4 a[36:39], v7, s[16:19], s40 offen offset:1024
    buffer_load_dwordx4 a[40:43], v8, s[16:19], s40 offen offset:1024
    buffer_load_dwordx4 a[44:47], v9, s[16:19], s40 offen offset:1024
    buffer_load_dwordx4 a[48:51], v4, s[12:15], s40 offen offset:2048
    buffer_load_dwordx4 a[52:55], v5, s[16:19], s40 offen offset:2048
    buffer_load_dwordx4 a[56:59], v6, s[16:19], s40 offen offset:2048
    buffer_load_dwordx4 a[60:63], v7, s[16:19], s40 offen offset:2048
    buffer_load_dwordx4 a[64:67], v8, s[16:19], s40 offen offset:2048
    buffer_load_dwordx4 a[68:71], v9, s[16:19], s40 offen offset:2048
    buffer_load_dwordx4 a[72:75], v4, s[12:15], s40 offen offset:3072
    buffer_load_dwordx4 a[76:79], v5, s[16:19], s40 offen offset:3072
    buffer_load_dwordx4 a[80:83], v6, s[16:19], s40 offen offset:3072
    buffer_load_dwordx4 a[84:87], v7, s[16:19], s40 offen offset:3072
    buffer_load_dwordx4 a[88:91], v8, s[16:19], s40 offen offset:3072
    buffer_load_dwordx4 a[92:95], v9, s[16:19], s40 offen offset:3072
    s_mov_b32 s40, 0x1000
    buffer_load_dwordx4 a[96:99], v4, s[12:15], s40 offen offset:0
    buffer_load_dwordx4 a[100:103], v5, s[16:19], s40 offen offset:0
    buffer_load_dwordx4 a[104:107], v6, s[16:19], s40 offen offset:0
    buffer_load_dwordx4 a[108:111], v7, s[16:19], s40 offen offset:0
    buffer_load_dwordx4 a[112:115], v8, s[16:19], s40 offen offset:0
    buffer_load_dwordx4 a[116:119], v9, s[16:19], s40 offen offset:0
    buffer_load_dwordx4 a[120:123], v4, s[12:15], s40 offen offset:1024
    buffer_load_dwordx4 a[124:127], v5, s[16:19], s40 offen offset:1024
    buffer_load_dwordx4 a[128:131], v6, s[16:19], s40 offen offset:1024
    buffer_load_dwordx4 a[132:135], v7, s[16:19], s40 offen offset:1024
    buffer_load_dwordx4 a[136:139], v8, s[16:19], s40 offen offset:1024
    buffer_load_dwordx4 a[140:143], v9, s[16:19], s40 offen offset:1024
    buffer_load_dwordx4 a[144:147], v4, s[12:15], s40 offen offset:2048
    buffer_load_dwordx4 a[148:151], v5, s[16:19], s40 offen offset:2048
    buffer_load_dwordx4 a[152:155], v6, s[16:19], s40 offen offset:2048
    buffer_load_dwordx4 a[156:159], v7, s[16:19], s40 offen offset:2048
    buffer_load_dwordx4 a[160:163], v8, s[16:19], s40 offen offset:2048
    buffer_load_dwordx4 a[164:167], v9, s[16:19], s40 offen offset:2048
    buffer_load_dwordx4 a[168:171], v4, s[12:15], s40 offen offset:3072
    buffer_load_dwordx4 a[172:175], v5, s[16:19], s40 offen offset:3072
    buffer_load_dwordx4 a[176:179], v6, s[16:19], s40 offen offset:3072
    buffer_load_dwordx4 a[180:183], v7, s[16:19], s40 offen offset:3072
    buffer_load_dwordx4 a[184:187], v8, s[16:19], s40 offen offset:3072
    buffer_load_dwordx4 a[188:191], v9, s[16:19], s40 offen offset:3072
    s_mov_b32 s40, 0x2000
    buffer_load_dwordx4 a[192:195], v4, s[12:15], s40 offen offset:0
    buffer_load_dwordx4 a[196:199], v5, s[16:19], s40 offen offset:0
    buffer_load_dwordx4 a[200:203], v6, s[16:19], s40 offen offset:0
    buffer_load_dwordx4 a[204:207], v7, s[16:19], s40 offen offset:0
    buffer_load_dwordx4 a[208:211], v8, s[16:19], s40 offen offset:0
    buffer_load_dwordx4 a[212:215], v9, s[16:19], s40 offen offset:0
    buffer_load_dwordx4 a[216:219], v4, s[12:15], s40 offen offset:1024
    buffer_load_dwordx4 a[220:223], v5, s[16:19], s40 offen offset:1024
    buffer_load_dwordx4 a[224:227], v6, s[16:19], s40 offen offset:1024
    buffer_load_dwordx4 a[228:231], v7, s[16:19], s40 offen offset:1024
    buffer_load_dwordx4 a[232:235], v8, s[16:19], s40 offen offset:1024
    buffer_load_dwordx4 a[236:239], v9, s[16:19], s40 offen offset:1024
    s_mul_i32 s38, s9, 5
    s_add_u32 s36, s38, s10
    s_add_u32 s37, s38, 4
    s_mul_i32 s39, s8, 40
    s_lshl_b32 s41, s36, 1
    s_add_u32 s41, s41, s39
    s_lshl_b32 s41, s41, 10
    s_lshl_b32 s42, s37, 1
    s_add_u32 s42, s42, s39
    s_lshl_b32 s42, s42, 10
    s_waitcnt vmcnt(54)
    v_mfma_f32_32x32x16_bf16 v[128:143], a[4:7], a[0:3], 0
    v_mfma_f32_32x32x16_bf16 v[144:159], a[8:11], a[0:3], 0
    v_mfma_f32_32x32x16_bf16 v[160:175], a[12:15], a[0:3], 0
    v_mfma_f32_32x32x16_bf16 v[176:191], a[16:19], a[0:3], 0
    v_mfma_f32_32x32x16_bf16 v[192:207], a[20:23], a[0:3], 0
    buffer_load_dwordx4 a[0:3], v4, s[12:15], s40 offen offset:2048
    buffer_load_dwordx4 a[4:7], v5, s[16:19], s40 offen offset:2048
    buffer_load_dwordx4 a[8:11], v6, s[16:19], s40 offen offset:2048
    buffer_load_dwordx4 a[12:15], v7, s[16:19], s40 offen offset:2048
    buffer_load_dwordx4 a[16:19], v8, s[16:19], s40 offen offset:2048
    buffer_load_dwordx4 a[20:23], v9, s[16:19], s40 offen offset:2048
    s_waitcnt vmcnt(54)
    v_mfma_f32_32x32x16_bf16 v[128:143], a[28:31], a[24:27], v[128:143]
    v_mfma_f32_32x32x16_bf16 v[144:159], a[32:35], a[24:27], v[144:159]
    v_mfma_f32_32x32x16_bf16 v[160:175], a[36:39], a[24:27], v[160:175]
    v_mfma_f32_32x32x16_bf16 v[176:191], a[40:43], a[24:27], v[176:191]
    v_mfma_f32_32x32x16_bf16 v[192:207], a[44:47], a[24:27], v[192:207]
    buffer_load_dwordx4 a[24:27], v4, s[12:15], s40 offen offset:3072
    buffer_load_dwordx4 a[28:31], v5, s[16:19], s40 offen offset:3072
    buffer_load_dwordx4 a[32:35], v6, s[16:19], s40 offen offset:3072
    buffer_load_dwordx4 a[36:39], v7, s[16:19], s40 offen offset:3072
    buffer_load_dwordx4 a[40:43], v8, s[16:19], s40 offen offset:3072
    buffer_load_dwordx4 a[44:47], v9, s[16:19], s40 offen offset:3072
    s_waitcnt vmcnt(54)
    v_mfma_f32_32x32x16_bf16 v[128:143], a[52:55], a[48:51], v[128:143]
    v_mfma_f32_32x32x16_bf16 v[144:159], a[56:59], a[48:51], v[144:159]
    v_mfma_f32_32x32x16_bf16 v[160:175], a[60:63], a[48:51], v[160:175]
    v_mfma_f32_32x32x16_bf16 v[176:191], a[64:67], a[48:51], v[176:191]
    v_mfma_f32_32x32x16_bf16 v[192:207], a[68:71], a[48:51], v[192:207]
    s_mov_b32 s40, 0x3000
    buffer_load_dwordx4 a[48:51], v4, s[12:15], s40 offen offset:0
    buffer_load_dwordx4 a[52:55], v5, s[16:19], s40 offen offset:0
    buffer_load_dwordx4 a[56:59], v6, s[16:19], s40 offen offset:0
    buffer_load_dwordx4 a[60:63], v7, s[16:19], s40 offen offset:0
    buffer_load_dwordx4 a[64:67], v8, s[16:19], s40 offen offset:0
    buffer_load_dwordx4 a[68:71], v9, s[16:19], s40 offen offset:0
    s_waitcnt vmcnt(54)
    v_mfma_f32_32x32x16_bf16 v[128:143], a[76:79], a[72:75], v[128:143]
    v_mfma_f32_32x32x16_bf16 v[144:159], a[80:83], a[72:75], v[144:159]
    v_mfma_f32_32x32x16_bf16 v[160:175], a[84:87], a[72:75], v[160:175]
    v_mfma_f32_32x32x16_bf16 v[176:191], a[88:91], a[72:75], v[176:191]
    v_mfma_f32_32x32x16_bf16 v[192:207], a[92:95], a[72:75], v[192:207]
    buffer_load_dwordx4 a[72:75], v4, s[12:15], s40 offen offset:1024
    buffer_load_dwordx4 a[76:79], v5, s[16:19], s40 offen offset:1024
    buffer_load_dwordx4 a[80:83], v6, s[16:19], s40 offen offset:1024
    buffer_load_dwordx4 a[84:87], v7, s[16:19], s40 offen offset:1024
    buffer_load_dwordx4 a[88:91], v8, s[16:19], s40 offen offset:1024
    buffer_load_dwordx4 a[92:95], v9, s[16:19], s40 offen offset:1024
    s_waitcnt vmcnt(54)
    v_mfma_f32_32x32x16_bf16 v[128:143], a[100:103], a[96:99], v[128:143]
    v_mfma_f32_32x32x16_bf16 v[144:159], a[104:107], a[96:99], v[144:159]
    v_mfma_f32_32x32x16_bf16 v[160:175], a[108:111], a[96:99], v[160:175]
    v_mfma_f32_32x32x16_bf16 v[176:191], a[112:115], a[96:99], v[176:191]
    v_mfma_f32_32x32x16_bf16 v[192:207], a[116:119], a[96:99], v[192:207]
    buffer_load_dwordx4 a[96:99], v4, s[12:15], s40 offen offset:2048
    buffer_load_dwordx4 a[100:103], v5, s[16:19], s40 offen offset:2048
    buffer_load_dwordx4 a[104:107], v6, s[16:19], s40 offen offset:2048
    buffer_load_dwordx4 a[108:111], v7, s[16:19], s40 offen offset:2048
    buffer_load_dwordx4 a[112:115], v8, s[16:19], s40 offen offset:2048
    buffer_load_dwordx4 a[116:119], v9, s[16:19], s40 offen offset:2048
    s_waitcnt vmcnt(54)
    v_mfma_f32_32x32x16_bf16 v[128:143], a[124:127], a[120:123], v[128:143]
    v_mfma_f32_32x32x16_bf16 v[144:159], a[128:131], a[120:123], v[144:159]
    v_mfma_f32_32x32x16_bf16 v[160:175], a[132:135], a[120:123], v[160:175]
    v_mfma_f32_32x32x16_bf16 v[176:191], a[136:139], a[120:123], v[176:191]
    v_mfma_f32_32x32x16_bf16 v[192:207], a[140:143], a[120:123], v[192:207]
    buffer_load_dwordx4 a[120:123], v4, s[12:15], s40 offen offset:3072
    buffer_load_dwordx4 a[124:127], v5, s[16:19], s40 offen offset:3072
    buffer_load_dwordx4 a[128:131], v6, s[16:19], s40 offen offset:3072
    buffer_load_dwordx4 a[132:135], v7, s[16:19], s40 offen offset:3072
    buffer_load_dwordx4 a[136:139], v8, s[16:19], s40 offen offset:3072
    buffer_load_dwordx4 a[140:143], v9, s[16:19], s40 offen offset:3072
    s_waitcnt vmcnt(54)
    v_mfma_f32_32x32x16_bf16 v[128:143], a[148:151], a[144:147], v[128:143]
    v_mfma_f32_32x32x16_bf16 v[144:159], a[152:155], a[144:147], v[144:159]
    v_mfma_f32_32x32x16_bf16 v[160:175], a[156:159], a[144:147], v[160:175]
    v_mfma_f32_32x32x16_bf16 v[176:191], a[160:163], a[144:147], v[176:191]
    v_mfma_f32_32x32x16_bf16 v[192:207], a[164:167], a[144:147], v[192:207]
    s_mov_b32 s40, 0x4000
    buffer_load_dwordx4 a[144:147], v4, s[12:15], s40 offen offset:0
    buffer_load_dwordx4 a[148:151], v5, s[16:19], s40 offen offset:0
    buffer_load_dwordx4 a[152:155], v6, s[16:19], s40 offen offset:0
    buffer_load_dwordx4 a[156:159], v7, s[16:19], s40 offen offset:0
    buffer_load_dwordx4 a[160:163], v8, s[16:19], s40 offen offset:0
    buffer_load_dwordx4 a[164:167], v9, s[16:19], s40 offen offset:0
    s_waitcnt vmcnt(54)
    v_mfma_f32_32x32x16_bf16 v[128:143], a[172:175], a[168:171], v[128:143]
    v_mfma_f32_32x32x16_bf16 v[144:159], a[176:179], a[168:171], v[144:159]
    v_mfma_f32_32x32x16_bf16 v[160:175], a[180:183], a[168:171], v[160:175]
    v_mfma_f32_32x32x16_bf16 v[176:191], a[184:187], a[168:171], v[176:191]
    v_mfma_f32_32x32x16_bf16 v[192:207], a[188:191], a[168:171], v[192:207]
    buffer_load_dwordx4 a[168:171], v4, s[12:15], s40 offen offset:1024
    buffer_load_dwordx4 a[172:175], v5, s[16:19], s40 offen offset:1024
    buffer_load_dwordx4 a[176:179], v6, s[16:19], s40 offen offset:1024
    buffer_load_dwordx4 a[180:183], v7, s[16:19], s40 offen offset:1024
    buffer_load_dwordx4 a[184:187], v8, s[16:19], s40 offen offset:1024
    buffer_load_dwordx4 a[188:191], v9, s[16:19], s40 offen offset:1024
    s_waitcnt vmcnt(54)
    v_mfma_f32_32x32x16_bf16 v[128:143], a[196:199], a[192:195], v[128:143]
    v_mfma_f32_32x32x16_bf16 v[144:159], a[200:203], a[192:195], v[144:159]
    v_mfma_f32_32x32x16_bf16 v[160:175], a[204:207], a[192:195], v[160:175]
    v_mfma_f32_32x32x16_bf16 v[176:191], a[208:211], a[192:195], v[176:191]
    v_mfma_f32_32x32x16_bf16 v[192:207], a[212:215], a[192:195], v[192:207]
    buffer_load_dwordx4 a[192:195], v4, s[12:15], s40 offen offset:2048
    buffer_load_dwordx4 a[196:199], v5, s[16:19], s40 offen offset:2048
    buffer_load_dwordx4 a[200:203], v6, s[16:19], s40 offen offset:2048
    buffer_load_dwordx4 a[204:207], v7, s[16:19], s40 offen offset:2048
    buffer_load_dwordx4 a[208:211], v8, s[16:19], s40 offen offset:2048
    buffer_load_dwordx4 a[212:215], v9, s[16:19], s40 offen offset:2048
    s_waitcnt vmcnt(54)
    v_mfma_f32_32x32x16_bf16 v[128:143], a[220:223], a[216:219], v[128:143]
    v_mfma_f32_32x32x16_bf16 v[144:159], a[224:227], a[216:219], v[144:159]
    v_mfma_f32_32x32x16_bf16 v[160:175], a[228:231], a[216:219], v[160:175]
    v_mfma_f32_32x32x16_bf16 v[176:191], a[232:235], a[216:219], v[176:191]
    v_mfma_f32_32x32x16_bf16 v[192:207], a[236:239], a[216:219], v[192:207]
    buffer_load_dwordx4 a[216:219], v4, s[12:15], s40 offen offset:3072
    buffer_load_dwordx4 a[220:223], v5, s[16:19], s40 offen offset:3072
    buffer_load_dwordx4 a[224:227], v6, s[16:19], s40 offen offset:3072
    buffer_load_dwordx4 a[228:231], v7, s[16:19], s40 offen offset:3072
    buffer_load_dwordx4 a[232:235], v8, s[16:19], s40 offen offset:3072
    buffer_load_dwordx4 a[236:239], v9, s[16:19], s40 offen offset:3072
    s_waitcnt vmcnt(54)
    v_mfma_f32_32x32x16_bf16 v[128:143], a[4:7], a[0:3], v[128:143]
    v_mfma_f32_32x32x16_bf16 v[144:159], a[8:11], a[0:3], v[144:159]
    v_mfma_f32_32x32x16_bf16 v[160:175], a[12:15], a[0:3], v[160:175]
    v_mfma_f32_32x32x16_bf16 v[176:191], a[16:19], a[0:3], v[176:191]
    v_mfma_f32_32x32x16_bf16 v[192:207], a[20:23], a[0:3], v[192:207]
    s_mov_b32 s40, 0x5000
    buffer_load_dwordx4 a[0:3], v4, s[12:15], s40 offen offset:0
    buffer_load_dwordx4 a[4:7], v5, s[16:19], s40 offen offset:0
    buffer_load_dwordx4 a[8:11], v6, s[16:19], s40 offen offset:0
    buffer_load_dwordx4 a[12:15], v7, s[16:19], s40 offen offset:0
    buffer_load_dwordx4 a[16:19], v8, s[16:19], s40 offen offset:0
    buffer_load_dwordx4 a[20:23], v9, s[16:19], s40 offen offset:0
    s_waitcnt vmcnt(54)
    v_mfma_f32_32x32x16_bf16 v[128:143], a[28:31], a[24:27], v[128:143]
    v_mfma_f32_32x32x16_bf16 v[144:159], a[32:35], a[24:27], v[144:159]
    v_mfma_f32_32x32x16_bf16 v[160:175], a[36:39], a[24:27], v[160:175]
    v_mfma_f32_32x32x16_bf16 v[176:191], a[40:43], a[24:27], v[176:191]
    v_mfma_f32_32x32x16_bf16 v[192:207], a[44:47], a[24:27], v[192:207]
    buffer_load_dwordx4 a[24:27], v4, s[12:15], s40 offen offset:1024
    buffer_load_dwordx4 a[28:31], v5, s[16:19], s40 offen offset:1024
    buffer_load_dwordx4 a[32:35], v6, s[16:19], s40 offen offset:1024
    buffer_load_dwordx4 a[36:39], v7, s[16:19], s40 offen offset:1024
    buffer_load_dwordx4 a[40:43], v8, s[16:19], s40 offen offset:1024
    buffer_load_dwordx4 a[44:47], v9, s[16:19], s40 offen offset:1024
    s_waitcnt vmcnt(54)
    v_mfma_f32_32x32x16_bf16 v[128:143], a[52:55], a[48:51], v[128:143]
    v_mfma_f32_32x32x16_bf16 v[144:159], a[56:59], a[48:51], v[144:159]
    v_mfma_f32_32x32x16_bf16 v[160:175], a[60:63], a[48:51], v[160:175]
    v_mfma_f32_32x32x16_bf16 v[176:191], a[64:67], a[48:51], v[176:191]
    v_mfma_f32_32x32x16_bf16 v[192:207], a[68:71], a[48:51], v[192:207]
    buffer_load_dwordx4 a[48:51], v4, s[12:15], s40 offen offset:2048
    buffer_load_dwordx4 a[52:55], v5, s[16:19], s40 offen offset:2048
    buffer_load_dwordx4 a[56:59], v6, s[16:19], s40 offen offset:2048
    buffer_load_dwordx4 a[60:63], v7, s[16:19], s40 offen offset:2048
    buffer_load_dwordx4 a[64:67], v8, s[16:19], s40 offen offset:2048
    buffer_load_dwordx4 a[68:71], v9, s[16:19], s40 offen offset:2048
    s_waitcnt vmcnt(54)
    v_mfma_f32_32x32x16_bf16 v[128:143], a[76:79], a[72:75], v[128:143]
    v_mfma_f32_32x32x16_bf16 v[144:159], a[80:83], a[72:75], v[144:159]
    v_mfma_f32_32x32x16_bf16 v[160:175], a[84:87], a[72:75], v[160:175]
    v_mfma_f32_32x32x16_bf16 v[176:191], a[88:91], a[72:75], v[176:191]
    v_mfma_f32_32x32x16_bf16 v[192:207], a[92:95], a[72:75], v[192:207]
    buffer_load_dwordx4 a[72:75], v4, s[12:15], s40 offen offset:3072
    buffer_load_dwordx4 a[76:79], v5, s[16:19], s40 offen offset:3072
    buffer_load_dwordx4 a[80:83], v6, s[16:19], s40 offen offset:3072
    buffer_load_dwordx4 a[84:87], v7, s[16:19], s40 offen offset:3072
    buffer_load_dwordx4 a[88:91], v8, s[16:19], s40 offen offset:3072
    buffer_load_dwordx4 a[92:95], v9, s[16:19], s40 offen offset:3072
    s_waitcnt vmcnt(54)
    v_mfma_f32_32x32x16_bf16 v[128:143], a[100:103], a[96:99], v[128:143]
    v_mfma_f32_32x32x16_bf16 v[144:159], a[104:107], a[96:99], v[144:159]
    v_mfma_f32_32x32x16_bf16 v[160:175], a[108:111], a[96:99], v[160:175]
    v_mfma_f32_32x32x16_bf16 v[176:191], a[112:115], a[96:99], v[176:191]
    v_mfma_f32_32x32x16_bf16 v[192:207], a[116:119], a[96:99], v[192:207]
    s_mov_b32 s40, 0x6000
    buffer_load_dwordx4 a[96:99], v4, s[12:15], s40 offen offset:0
    buffer_load_dwordx4 a[100:103], v5, s[16:19], s40 offen offset:0
    buffer_load_dwordx4 a[104:107], v6, s[16:19], s40 offen offset:0
    buffer_load_dwordx4 a[108:111], v7, s[16:19], s40 offen offset:0
    buffer_load_dwordx4 a[112:115], v8, s[16:19], s40 offen offset:0
    buffer_load_dwordx4 a[116:119], v9, s[16:19], s40 offen offset:0
    s_waitcnt vmcnt(54)
    v_mfma_f32_32x32x16_bf16 v[128:143], a[124:127], a[120:123], v[128:143]
    v_mfma_f32_32x32x16_bf16 v[144:159], a[128:131], a[120:123], v[144:159]
    v_mfma_f32_32x32x16_bf16 v[160:175], a[132:135], a[120:123], v[160:175]
    v_mfma_f32_32x32x16_bf16 v[176:191], a[136:139], a[120:123], v[176:191]
    v_mfma_f32_32x32x16_bf16 v[192:207], a[140:143], a[120:123], v[192:207]
    buffer_load_dwordx4 a[120:123], v4, s[12:15], s40 offen offset:1024
    buffer_load_dwordx4 a[124:127], v5, s[16:19], s40 offen offset:1024
    buffer_load_dwordx4 a[128:131], v6, s[16:19], s40 offen offset:1024
    buffer_load_dwordx4 a[132:135], v7, s[16:19], s40 offen offset:1024
    buffer_load_dwordx4 a[136:139], v8, s[16:19], s40 offen offset:1024
    buffer_load_dwordx4 a[140:143], v9, s[16:19], s40 offen offset:1024
    s_waitcnt vmcnt(54)
    v_mfma_f32_32x32x16_bf16 v[128:143], a[148:151], a[144:147], v[128:143]
    v_mfma_f32_32x32x16_bf16 v[144:159], a[152:155], a[144:147], v[144:159]
    v_mfma_f32_32x32x16_bf16 v[160:175], a[156:159], a[144:147], v[160:175]
    v_mfma_f32_32x32x16_bf16 v[176:191], a[160:163], a[144:147], v[176:191]
    v_mfma_f32_32x32x16_bf16 v[192:207], a[164:167], a[144:147], v[192:207]
    buffer_load_dwordx4 a[144:147], v4, s[12:15], s40 offen offset:2048
    buffer_load_dwordx4 a[148:151], v5, s[16:19], s40 offen offset:2048
    buffer_load_dwordx4 a[152:155], v6, s[16:19], s40 offen offset:2048
    buffer_load_dwordx4 a[156:159], v7, s[16:19], s40 offen offset:2048
    buffer_load_dwordx4 a[160:163], v8, s[16:19], s40 offen offset:2048
    buffer_load_dwordx4 a[164:167], v9, s[16:19], s40 offen offset:2048
    s_waitcnt vmcnt(54)
    v_mfma_f32_32x32x16_bf16 v[128:143], a[172:175], a[168:171], v[128:143]
    v_mfma_f32_32x32x16_bf16 v[144:159], a[176:179], a[168:171], v[144:159]
    v_mfma_f32_32x32x16_bf16 v[160:175], a[180:183], a[168:171], v[160:175]
    v_mfma_f32_32x32x16_bf16 v[176:191], a[184:187], a[168:171], v[176:191]
    v_mfma_f32_32x32x16_bf16 v[192:207], a[188:191], a[168:171], v[192:207]
    buffer_load_dwordx4 v[12:15], v3, s[24:27], s41 offen
    buffer_load_dwordx4 v[16:19], v3, s[24:27], s41 offen offset:1024
    buffer_load_dwordx4 v[20:23], v3, s[24:27], s42 offen
    buffer_load_dwordx4 v[24:27], v3, s[24:27], s42 offen offset:1024
    s_waitcnt vmcnt(52)
    v_mfma_f32_32x32x16_bf16 v[128:143], a[196:199], a[192:195], v[128:143]
    v_mfma_f32_32x32x16_bf16 v[144:159], a[200:203], a[192:195], v[144:159]
    v_mfma_f32_32x32x16_bf16 v[160:175], a[204:207], a[192:195], v[160:175]
    v_mfma_f32_32x32x16_bf16 v[176:191], a[208:211], a[192:195], v[176:191]
    v_mfma_f32_32x32x16_bf16 v[192:207], a[212:215], a[192:195], v[192:207]
    s_waitcnt vmcnt(46)
    v_mfma_f32_32x32x16_bf16 v[128:143], a[220:223], a[216:219], v[128:143]
    v_mfma_f32_32x32x16_bf16 v[144:159], a[224:227], a[216:219], v[144:159]
    v_mfma_f32_32x32x16_bf16 v[160:175], a[228:231], a[216:219], v[160:175]
    v_mfma_f32_32x32x16_bf16 v[176:191], a[232:235], a[216:219], v[176:191]
    v_mfma_f32_32x32x16_bf16 v[192:207], a[236:239], a[216:219], v[192:207]
    s_waitcnt vmcnt(40)
    v_mfma_f32_32x32x16_bf16 v[128:143], a[4:7], a[0:3], v[128:143]
    v_mfma_f32_32x32x16_bf16 v[144:159], a[8:11], a[0:3], v[144:159]
    v_mfma_f32_32x32x16_bf16 v[160:175], a[12:15], a[0:3], v[160:175]
    v_mfma_f32_32x32x16_bf16 v[176:191], a[16:19], a[0:3], v[176:191]
    v_mfma_f32_32x32x16_bf16 v[192:207], a[20:23], a[0:3], v[192:207]
    s_waitcnt vmcnt(34)
    v_mfma_f32_32x32x16_bf16 v[128:143], a[28:31], a[24:27], v[128:143]
    v_mfma_f32_32x32x16_bf16 v[144:159], a[32:35], a[24:27], v[144:159]
    v_mfma_f32_32x32x16_bf16 v[160:175], a[36:39], a[24:27], v[160:175]
    v_mfma_f32_32x32x16_bf16 v[176:191], a[40:43], a[24:27], v[176:191]
    v_mfma_f32_32x32x16_bf16 v[192:207], a[44:47], a[24:27], v[192:207]
    s_waitcnt vmcnt(28)
    v_mfma_f32_32x32x16_bf16 v[128:143], a[52:55], a[48:51], v[128:143]
    v_mfma_f32_32x32x16_bf16 v[144:159], a[56:59], a[48:51], v[144:159]
    v_mfma_f32_32x32x16_bf16 v[160:175], a[60:63], a[48:51], v[160:175]
    v_mfma_f32_32x32x16_bf16 v[176:191], a[64:67], a[48:51], v[176:191]
    v_mfma_f32_32x32x16_bf16 v[192:207], a[68:71], a[48:51], v[192:207]
    s_waitcnt vmcnt(22)
    v_mfma_f32_32x32x16_bf16 v[128:143], a[76:79], a[72:75], v[128:143]
    v_mfma_f32_32x32x16_bf16 v[144:159], a[80:83], a[72:75], v[144:159]
    v_mfma_f32_32x32x16_bf16 v[160:175], a[84:87], a[72:75], v[160:175]
    v_mfma_f32_32x32x16_bf16 v[176:191], a[88:91], a[72:75], v[176:191]
    v_mfma_f32_32x32x16_bf16 v[192:207], a[92:95], a[72:75], v[192:207]
    s_waitcnt vmcnt(16)
    v_mfma_f32_32x32x16_bf16 v[128:143], a[100:103], a[96:99], v[128:143]
    v_mfma_f32_32x32x16_bf16 v[144:159], a[104:107], a[96:99], v[144:159]
    v_mfma_f32_32x32x16_bf16 v[160:175], a[108:111], a[96:99], v[160:175]
    v_mfma_f32_32x32x16_bf16 v[176:191], a[112:115], a[96:99], v[176:191]
    v_mfma_f32_32x32x16_bf16 v[192:207], a[116:119], a[96:99], v[192:207]
    s_waitcnt vmcnt(10)
    v_mfma_f32_32x32x16_bf16 v[128:143], a[124:127], a[120:123], v[128:143]
    v_mfma_f32_32x32x16_bf16 v[144:159], a[128:131], a[120:123], v[144:159]
    v_mfma_f32_32x32x16_bf16 v[160:175], a[132:135], a[120:123], v[160:175]
    v_mfma_f32_32x32x16_bf16 v[176:191], a[136:139], a[120:123], v[176:191]
    v_mfma_f32_32x32x16_bf16 v[192:207], a[140:143], a[120:123], v[192:207]
    s_waitcnt vmcnt(4)
    v_mfma_f32_32x32x16_bf16 v[128:143], a[148:151], a[144:147], v[128:143]
    v_mfma_f32_32x32x16_bf16 v[144:159], a[152:155], a[144:147], v[144:159]
    v_mfma_f32_32x32x16_bf16 v[160:175], a[156:159], a[144:147], v[160:175]
    v_mfma_f32_32x32x16_bf16 v[176:191], a[160:163], a[144:147], v[176:191]
    v_mfma_f32_32x32x16_bf16 v[192:207], a[164:167], a[144:147], v[192:207]
    s_waitcnt vmcnt(0)
    s_nop 15
    s_mul_i32 s43, s10, 20480
    v_add_u32 v10, s43, v3
    ds_write_b128 v10, v[128:131] offset:0
    ds_write_b128 v10, v[132:135] offset:1024
    ds_write_b128 v10, v[136:139] offset:2048
    ds_write_b128 v10, v[140:143] offset:3072
    ds_write_b128 v10, v[144:147] offset:4096
    ds_write_b128 v10, v[148:151] offset:5120
    ds_write_b128 v10, v[152:155] offset:6144
    ds_write_b128 v10, v[156:159] offset:7168
    ds_write_b128 v10, v[160:163] offset:8192
    ds_write_b128 v10, v[164:167] offset:9216
    ds_write_b128 v10, v[168:171] offset:10240
    ds_write_b128 v10, v[172:175] offset:11264
    ds_write_b128 v10, v[176:179] offset:12288
    ds_write_b128 v10, v[180:183] offset:13312
    ds_write_b128 v10, v[184:187] offset:14336
    ds_write_b128 v10, v[188:191] offset:15360
    ds_write_b128 v10, v[192:195] offset:16384
    ds_write_b128 v10, v[196:199] offset:17408
    ds_write_b128 v10, v[200:203] offset:18432
    ds_write_b128 v10, v[204:207] offset:19456
    s_waitcnt lgkmcnt(0)
    s_barrier
    s_lshl_b32 s43, s10, 12
    v_add_u32 v11, s43, v3
    ds_read_b128 v[32:35], v11 offset:0
    ds_read_b128 v[36:39], v11 offset:1024
    ds_read_b128 v[40:43], v11 offset:2048
    ds_read_b128 v[44:47], v11 offset:3072
    ds_read_b128 v[48:51], v11 offset:20480
    ds_read_b128 v[52:55], v11 offset:21504
    ds_read_b128 v[56:59], v11 offset:22528
    ds_read_b128 v[60:63], v11 offset:23552
    ds_read_b128 v[64:67], v11 offset:40960
    ds_read_b128 v[68:71], v11 offset:41984
    ds_read_b128 v[72:75], v11 offset:43008
    ds_read_b128 v[76:79], v11 offset:44032
    ds_read_b128 v[80:83], v11 offset:61440
    ds_read_b128 v[84:87], v11 offset:62464
    ds_read_b128 v[88:91], v11 offset:63488
    ds_read_b128 v[92:95], v11 offset:64512
    s_waitcnt lgkmcnt(0)
    v_pk_add_f32 v[32:33], v[32:33], v[48:49]
    v_pk_add_f32 v[64:65], v[64:65], v[80:81]
    v_pk_add_f32 v[34:35], v[34:35], v[50:51]
    v_pk_add_f32 v[66:67], v[66:67], v[82:83]
    v_pk_add_f32 v[36:37], v[36:37], v[52:53]
    v_pk_add_f32 v[68:69], v[68:69], v[84:85]
    v_pk_add_f32 v[38:39], v[38:39], v[54:55]
    v_pk_add_f32 v[70:71], v[70:71], v[86:87]
    v_pk_add_f32 v[40:41], v[40:41], v[56:57]
    v_pk_add_f32 v[72:73], v[72:73], v[88:89]
    v_pk_add_f32 v[42:43], v[42:43], v[58:59]
    v_pk_add_f32 v[74:75], v[74:75], v[90:91]
    v_pk_add_f32 v[44:45], v[44:45], v[60:61]
    v_pk_add_f32 v[76:77], v[76:77], v[92:93]
    v_pk_add_f32 v[46:47], v[46:47], v[62:63]
    v_pk_add_f32 v[78:79], v[78:79], v[94:95]
    v_pk_add_f32 v[32:33], v[32:33], v[64:65]
    v_pk_add_f32 v[34:35], v[34:35], v[66:67]
    v_pk_add_f32 v[36:37], v[36:37], v[68:69]
    v_pk_add_f32 v[38:39], v[38:39], v[70:71]
    v_pk_add_f32 v[40:41], v[40:41], v[72:73]
    v_pk_add_f32 v[42:43], v[42:43], v[74:75]
    v_pk_add_f32 v[44:45], v[44:45], v[76:77]
    v_pk_add_f32 v[46:47], v[46:47], v[78:79]
    v_cvt_pk_bf16_f32 v48, v32, v33
    v_cvt_pk_bf16_f32 v49, v34, v35
    v_cvt_pk_bf16_f32 v50, v36, v37
    v_cvt_pk_bf16_f32 v51, v38, v39
    v_cvt_pk_bf16_f32 v52, v40, v41
    v_cvt_pk_bf16_f32 v53, v42, v43
    v_cvt_pk_bf16_f32 v54, v44, v45
    v_cvt_pk_bf16_f32 v55, v46, v47
    v_lshlrev_b32 v32, 16, v48
    v_and_b32 v33, 0xffff0000, v48
    v_lshlrev_b32 v64, 16, v12
    v_and_b32 v65, 0xffff0000, v12
    v_lshlrev_b32 v34, 16, v49
    v_and_b32 v35, 0xffff0000, v49
    v_lshlrev_b32 v66, 16, v13
    v_and_b32 v67, 0xffff0000, v13
    v_lshlrev_b32 v36, 16, v50
    v_and_b32 v37, 0xffff0000, v50
    v_lshlrev_b32 v68, 16, v14
    v_and_b32 v69, 0xffff0000, v14
    v_lshlrev_b32 v38, 16, v51
    v_and_b32 v39, 0xffff0000, v51
    v_lshlrev_b32 v70, 16, v15
    v_and_b32 v71, 0xffff0000, v15
    v_lshlrev_b32 v40, 16, v52
    v_and_b32 v41, 0xffff0000, v52
    v_lshlrev_b32 v72, 16, v16
    v_and_b32 v73, 0xffff0000, v16
    v_lshlrev_b32 v42, 16, v53
    v_and_b32 v43, 0xffff0000, v53
    v_lshlrev_b32 v74, 16, v17
    v_and_b32 v75, 0xffff0000, v17
    v_lshlrev_b32 v44, 16, v54
    v_and_b32 v45, 0xffff0000, v54
    v_lshlrev_b32 v76, 16, v18
    v_and_b32 v77, 0xffff0000, v18
    v_lshlrev_b32 v46, 16, v55
    v_and_b32 v47, 0xffff0000, v55
    v_lshlrev_b32 v78, 16, v19
    v_and_b32 v79, 0xffff0000, v19
    v_pk_add_f32 v[32:33], v[32:33], v[64:65]
    v_pk_add_f32 v[34:35], v[34:35], v[66:67]
    v_pk_add_f32 v[36:37], v[36:37], v[68:69]
    v_pk_add_f32 v[38:39], v[38:39], v[70:71]
    v_pk_add_f32 v[40:41], v[40:41], v[72:73]
    v_pk_add_f32 v[42:43], v[42:43], v[74:75]
    v_pk_add_f32 v[44:45], v[44:45], v[76:77]
    v_pk_add_f32 v[46:47], v[46:47], v[78:79]
    v_cvt_pk_bf16_f32 v48, v32, v33
    v_cvt_pk_bf16_f32 v49, v34, v35
    v_cvt_pk_bf16_f32 v50, v36, v37
    v_cvt_pk_bf16_f32 v51, v38, v39
    v_cvt_pk_bf16_f32 v52, v40, v41
    v_cvt_pk_bf16_f32 v53, v42, v43
    v_cvt_pk_bf16_f32 v54, v44, v45
    v_cvt_pk_bf16_f32 v55, v46, v47
    buffer_store_dwordx4 v[48:51], v3, s[24:27], s41 offen
    buffer_store_dwordx4 v[52:55], v3, s[24:27], s41 offen offset:1024
    v_mov_b32 v100, 0x3f803f80
    v_mov_b32 v102, 0
    v_mov_b32 v103, 0
    v_dot2_f32_bf16 v102, v48, v100, v102
    v_dot2_f32_bf16 v103, v48, v48, v103
    v_dot2_f32_bf16 v102, v49, v100, v102
    v_dot2_f32_bf16 v103, v49, v49, v103
    v_dot2_f32_bf16 v102, v50, v100, v102
    v_dot2_f32_bf16 v103, v50, v50, v103
    v_dot2_f32_bf16 v102, v51, v100, v102
    v_dot2_f32_bf16 v103, v51, v51, v103
    v_dot2_f32_bf16 v102, v52, v100, v102
    v_dot2_f32_bf16 v103, v52, v52, v103
    v_dot2_f32_bf16 v102, v53, v100, v102
    v_dot2_f32_bf16 v103, v53, v53, v103
    v_dot2_f32_bf16 v102, v54, v100, v102
    v_dot2_f32_bf16 v103, v54, v54, v103
    v_dot2_f32_bf16 v102, v55, v100, v102
    v_dot2_f32_bf16 v103, v55, v55, v103
    s_nop 4
    v_mov_b32 v104, v102
    v_mov_b32 v105, v103
    s_nop 1
    v_permlane32_swap_b32 v104, v102
    v_permlane32_swap_b32 v105, v103
    s_nop 1
    v_add_f32 v102, v102, v104
    v_add_f32 v103, v103, v105
    s_lshl_b32 s46, s8, 8
    v_lshl_add_u32 v96, v1, 3, s46
    s_lshl_b32 s47, s36, 14
    buffer_store_dwordx2 v[102:103], v96, s[20:23], s47 offen
    s_nop 1
    s_cmp_lg_u32 s10, 3
    s_cbranch_scc1 L_down_kernel_end
    v_add_u32 v11, 16384, v3
    ds_read_b128 v[32:35], v11 offset:0
    ds_read_b128 v[36:39], v11 offset:1024
    ds_read_b128 v[40:43], v11 offset:2048
    ds_read_b128 v[44:47], v11 offset:3072
    ds_read_b128 v[48:51], v11 offset:20480
    ds_read_b128 v[52:55], v11 offset:21504
    ds_read_b128 v[56:59], v11 offset:22528
    ds_read_b128 v[60:63], v11 offset:23552
    ds_read_b128 v[64:67], v11 offset:40960
    ds_read_b128 v[68:71], v11 offset:41984
    ds_read_b128 v[72:75], v11 offset:43008
    ds_read_b128 v[76:79], v11 offset:44032
    ds_read_b128 v[80:83], v11 offset:61440
    ds_read_b128 v[84:87], v11 offset:62464
    ds_read_b128 v[88:91], v11 offset:63488
    ds_read_b128 v[92:95], v11 offset:64512
    s_waitcnt lgkmcnt(0)
    v_pk_add_f32 v[32:33], v[32:33], v[48:49]
    v_pk_add_f32 v[64:65], v[64:65], v[80:81]
    v_pk_add_f32 v[34:35], v[34:35], v[50:51]
    v_pk_add_f32 v[66:67], v[66:67], v[82:83]
    v_pk_add_f32 v[36:37], v[36:37], v[52:53]
    v_pk_add_f32 v[68:69], v[68:69], v[84:85]
    v_pk_add_f32 v[38:39], v[38:39], v[54:55]
    v_pk_add_f32 v[70:71], v[70:71], v[86:87]
    v_pk_add_f32 v[40:41], v[40:41], v[56:57]
    v_pk_add_f32 v[72:73], v[72:73], v[88:89]
    v_pk_add_f32 v[42:43], v[42:43], v[58:59]
    v_pk_add_f32 v[74:75], v[74:75], v[90:91]
    v_pk_add_f32 v[44:45], v[44:45], v[60:61]
    v_pk_add_f32 v[76:77], v[76:77], v[92:93]
    v_pk_add_f32 v[46:47], v[46:47], v[62:63]
    v_pk_add_f32 v[78:79], v[78:79], v[94:95]
    v_pk_add_f32 v[32:33], v[32:33], v[64:65]
    v_pk_add_f32 v[34:35], v[34:35], v[66:67]
    v_pk_add_f32 v[36:37], v[36:37], v[68:69]
    v_pk_add_f32 v[38:39], v[38:39], v[70:71]
    v_pk_add_f32 v[40:41], v[40:41], v[72:73]
    v_pk_add_f32 v[42:43], v[42:43], v[74:75]
    v_pk_add_f32 v[44:45], v[44:45], v[76:77]
    v_pk_add_f32 v[46:47], v[46:47], v[78:79]
    v_cvt_pk_bf16_f32 v48, v32, v33
    v_cvt_pk_bf16_f32 v49, v34, v35
    v_cvt_pk_bf16_f32 v50, v36, v37
    v_cvt_pk_bf16_f32 v51, v38, v39
    v_cvt_pk_bf16_f32 v52, v40, v41
    v_cvt_pk_bf16_f32 v53, v42, v43
    v_cvt_pk_bf16_f32 v54, v44, v45
    v_cvt_pk_bf16_f32 v55, v46, v47
    v_lshlrev_b32 v32, 16, v48
    v_and_b32 v33, 0xffff0000, v48
    v_lshlrev_b32 v64, 16, v20
    v_and_b32 v65, 0xffff0000, v20
    v_lshlrev_b32 v34, 16, v49
    v_and_b32 v35, 0xffff0000, v49
    v_lshlrev_b32 v66, 16, v21
    v_and_b32 v67, 0xffff0000, v21
    v_lshlrev_b32 v36, 16, v50
    v_and_b32 v37, 0xffff0000, v50
    v_lshlrev_b32 v68, 16, v22
    v_and_b32 v69, 0xffff0000, v22
    v_lshlrev_b32 v38, 16, v51
    v_and_b32 v39, 0xffff0000, v51
    v_lshlrev_b32 v70, 16, v23
    v_and_b32 v71, 0xffff0000, v23
    v_lshlrev_b32 v40, 16, v52
    v_and_b32 v41, 0xffff0000, v52
    v_lshlrev_b32 v72, 16, v24
    v_and_b32 v73, 0xffff0000, v24
    v_lshlrev_b32 v42, 16, v53
    v_and_b32 v43, 0xffff0000, v53
    v_lshlrev_b32 v74, 16, v25
    v_and_b32 v75, 0xffff0000, v25
    v_lshlrev_b32 v44, 16, v54
    v_and_b32 v45, 0xffff0000, v54
    v_lshlrev_b32 v76, 16, v26
    v_and_b32 v77, 0xffff0000, v26
    v_lshlrev_b32 v46, 16, v55
    v_and_b32 v47, 0xffff0000, v55
    v_lshlrev_b32 v78, 16, v27
    v_and_b32 v79, 0xffff0000, v27
    v_pk_add_f32 v[32:33], v[32:33], v[64:65]
    v_pk_add_f32 v[34:35], v[34:35], v[66:67]
    v_pk_add_f32 v[36:37], v[36:37], v[68:69]
    v_pk_add_f32 v[38:39], v[38:39], v[70:71]
    v_pk_add_f32 v[40:41], v[40:41], v[72:73]
    v_pk_add_f32 v[42:43], v[42:43], v[74:75]
    v_pk_add_f32 v[44:45], v[44:45], v[76:77]
    v_pk_add_f32 v[46:47], v[46:47], v[78:79]
    v_cvt_pk_bf16_f32 v48, v32, v33
    v_cvt_pk_bf16_f32 v49, v34, v35
    v_cvt_pk_bf16_f32 v50, v36, v37
    v_cvt_pk_bf16_f32 v51, v38, v39
    v_cvt_pk_bf16_f32 v52, v40, v41
    v_cvt_pk_bf16_f32 v53, v42, v43
    v_cvt_pk_bf16_f32 v54, v44, v45
    v_cvt_pk_bf16_f32 v55, v46, v47
    buffer_store_dwordx4 v[48:51], v3, s[24:27], s42 offen
    buffer_store_dwordx4 v[52:55], v3, s[24:27], s42 offen offset:1024
    v_mov_b32 v100, 0x3f803f80
    v_mov_b32 v102, 0
    v_mov_b32 v103, 0
    v_dot2_f32_bf16 v102, v48, v100, v102
    v_dot2_f32_bf16 v103, v48, v48, v103
    v_dot2_f32_bf16 v102, v49, v100, v102
    v_dot2_f32_bf16 v103, v49, v49, v103
    v_dot2_f32_bf16 v102, v50, v100, v102
    v_dot2_f32_bf16 v103, v50, v50, v103
    v_dot2_f32_bf16 v102, v51, v100, v102
    v_dot2_f32_bf16 v103, v51, v51, v103
    v_dot2_f32_bf16 v102, v52, v100, v102
    v_dot2_f32_bf16 v103, v52, v52, v103
    v_dot2_f32_bf16 v102, v53, v100, v102
    v_dot2_f32_bf16 v103, v53, v53, v103
    v_dot2_f32_bf16 v102, v54, v100, v102
    v_dot2_f32_bf16 v103, v54, v54, v103
    v_dot2_f32_bf16 v102, v55, v100, v102
    v_dot2_f32_bf16 v103, v55, v55, v103
    s_nop 4
    v_mov_b32 v104, v102
    v_mov_b32 v105, v103
    s_nop 1
    v_permlane32_swap_b32 v104, v102
    v_permlane32_swap_b32 v105, v103
    s_nop 1
    v_add_f32 v102, v102, v104
    v_add_f32 v103, v103, v105
    s_lshl_b32 s46, s8, 8
    v_lshl_add_u32 v96, v1, 3, s46
    s_lshl_b32 s47, s37, 14
    buffer_store_dwordx2 v[102:103], v96, s[20:23], s47 offen
    s_nop 1
L_down_kernel_end:
    s_endpgm
.globl downf_kernel
.p2align 8
.type downf_kernel,@function
downf_kernel:
    s_load_dwordx2 s[4:5], s[0:1], 72
    s_load_dwordx2 s[44:45], s[0:1], 56
    s_cmp_ge_u32 s2, 256
    s_cbranch_scc1 L_downf_kernel_end
    s_and_b32 s6, s2, 7
    s_lshr_b32 s7, s2, 3
    s_lshr_b32 s8, s6, 1
    s_lshl_b32 s8, s8, 4
    s_lshr_b32 s9, s7, 1
    s_add_u32 s8, s8, s9
    s_and_b32 s9, s6, 1
    s_lshl_b32 s9, s9, 1
    s_and_b32 s7, s7, 1
    s_add_u32 s9, s9, s7
    v_lshrrev_b32 v1, 6, v0
    v_and_b32 v0, 63, v0
    s_nop 0
    v_readfirstlane_b32 s10, v1
    v_and_b32 v1, 31, v0
    v_lshrrev_b32 v2, 5, v0
    v_lshlrev_b32 v3, 4, v0
    s_waitcnt lgkmcnt(0)
    s_add_u32 s12, s4, 0x2400000
    s_addc_u32 s13, s5, 0
    s_and_b32 s13, s13, 0xffff
    s_mov_b32 s14, 0x6c0000
    s_mov_b32 s15, 0x00020000
    s_add_u32 s16, s4, 0xc00000
    s_addc_u32 s17, s5, 0
    s_and_b32 s17, s17, 0xffff
    s_mov_b32 s18, 0x21c000
    s_mov_b32 s19, 0x00020000
    s_add_u32 s20, s4, 0x1300000
    s_addc_u32 s21, s5, 0
    s_and_b32 s21, s21, 0xffff
    s_mov_b32 s22, 0x50000
    s_mov_b32 s23, 0x00020000
    s_add_u32 s24, s4, 0x1000000
    s_addc_u32 s25, s5, 0
    s_and_b32 s25, s25, 0xffff
    s_mov_b32 s26, 0x280000
    s_mov_b32 s27, 0x00020000
    s_mov_b32 s28, s44
    s_and_b32 s29, s45, 0xffff
    s_mov_b32 s30, 0x280000
    s_mov_b32 s31, 0x00020000
    s_mul_i32 s34, s10, 27648
    s_mul_i32 s32, s8, 110592
    s_add_u32 s32, s32, s34
    v_add_u32 v4, s32, v3
    s_mul_i32 s33, s9, 552960
    s_add_u32 s33, s33, s34
    v_add_u32 v5, s33, v3
    v_add_u32 v6, 0x1b000, v5
    v_add_u32 v7, 0x36000, v5
    v_add_u32 v8, 0x51000, v5
    v_add_u32 v9, 0x6c000, v5
    s_mov_b32 s40, 0x0
    buffer_load_dwordx4 a[0:3], v4, s[12:15], s40 offen offset:0
    buffer_load_dwordx4 a[4:7], v5, s[16:19], s40 offen offset:0
    buffer_load_dwordx4 a[8:11], v6, s[16:19], s40 offen offset:0
    buffer_load_dwordx4 a[12:15], v7, s[16:19], s40 offen offset:0
    buffer_load_dwordx4 a[16:19], v8, s[16:19], s40 offen offset:0
    buffer_load_dwordx4 a[20:23], v9, s[16:19], s40 offen offset:0
    buffer_load_dwordx4 a[24:27], v4, s[12:15], s40 offen offset:1024
    buffer_load_dwordx4 a[28:31], v5, s[16:19], s40 offen offset:1024
    buffer_load_dwordx4 a[32:35], v6, s[16:19], s40 offen offset:1024
    buffer_load_dwordx4 a[36:39], v7, s[16:19], s40 offen offset:1024
    buffer_load_dwordx4 a[40:43], v8, s[16:19], s40 offen offset:1024
    buffer_load_dwordx4 a[44:47], v9, s[16:19], s40 offen offset:1024
    buffer_load_dwordx4 a[48:51], v4, s[12:15], s40 offen offset:2048
    buffer_load_dwordx4 a[52:55], v5, s[16:19], s40 offen offset:2048
    buffer_load_dwordx4 a[56:59], v6, s[16:19], s40 offen offset:2048
    buffer_load_dwordx4 a[60:63], v7, s[16:19], s40 offen offset:2048
    buffer_load_dwordx4 a[64:67], v8, s[16:19], s40 offen offset:2048
    buffer_load_dwordx4 a[68:71], v9, s[16:19], s40 offen offset:2048
    buffer_load_dwordx4 a[72:75], v4, s[12:15], s40 offen offset:3072
    buffer_load_dwordx4 a[76:79], v5, s[16:19], s40 offen offset:3072
    buffer_load_dwordx4 a[80:83], v6, s[16:19], s40 offen offset:3072
    buffer_load_dwordx4 a[84:87], v7, s[16:19], s40 offen offset:3072
    buffer_load_dwordx4 a[88:91], v8, s[16:19], s40 offen offset:3072
    buffer_load_dwordx4 a[92:95], v9, s[16:19], s40 offen offset:3072
    s_mov_b32 s40, 0x1000
    buffer_load_dwordx4 a[96:99], v4, s[12:15], s40 offen offset:0
    buffer_load_dwordx4 a[100:103], v5, s[16:19], s40 offen offset:0
    buffer_load_dwordx4 a[104:107], v6, s[16:19], s40 offen offset:0
    buffer_load_dwordx4 a[108:111], v7, s[16:19], s40 offen offset:0
    buffer_load_dwordx4 a[112:115], v8, s[16:19], s40 offen offset:0
    buffer_load_dwordx4 a[116:119], v9, s[16:19], s40 offen offset:0
    buffer_load_dwordx4 a[120:123], v4, s[12:15], s40 offen offset:1024
    buffer_load_dwordx4 a[124:127], v5, s[16:19], s40 offen offset:1024
    buffer_load_dwordx4 a[128:131], v6, s[16:19], s40 offen offset:1024
    buffer_load_dwordx4 a[132:135], v7, s[16:19], s40 offen offset:1024
    buffer_load_dwordx4 a[136:139], v8, s[16:19], s40 offen offset:1024
    buffer_load_dwordx4 a[140:143], v9, s[16:19], s40 offen offset:1024
    buffer_load_dwordx4 a[144:147], v4, s[12:15], s40 offen offset:2048
    buffer_load_dwordx4 a[148:151], v5, s[16:19], s40 offen offset:2048
    buffer_load_dwordx4 a[152:155], v6, s[16:19], s40 offen offset:2048
    buffer_load_dwordx4 a[156:159], v7, s[16:19], s40 offen offset:2048
    buffer_load_dwordx4 a[160:163], v8, s[16:19], s40 offen offset:2048
    buffer_load_dwordx4 a[164:167], v9, s[16:19], s40 offen offset:2048
    buffer_load_dwordx4 a[168:171], v4, s[12:15], s40 offen offset:3072
    buffer_load_dwordx4 a[172:175], v5, s[16:19], s40 offen offset:3072
    buffer_load_dwordx4 a[176:179], v6, s[16:19], s40 offen offset:3072
    buffer_load_dwordx4 a[180:183], v7, s[16:19], s40 offen offset:3072
    buffer_load_dwordx4 a[184:187], v8, s[16:19], s40 offen offset:3072
    buffer_load_dwordx4 a[188:191], v9, s[16:19], s40 offen offset:3072
    s_mov_b32 s40, 0x2000
    buffer_load_dwordx4 a[192:195], v4, s[12:15], s40 offen offset:0
    buffer_load_dwordx4 a[196:199], v5, s[16:19], s40 offen offset:0
    buffer_load_dwordx4 a[200:203], v6, s[16:19], s40 offen offset:0
    buffer_load_dwordx4 a[204:207], v7, s[16:19], s40 offen offset:0
    buffer_load_dwordx4 a[208:211], v8, s[16:19], s40 offen offset:0
    buffer_load_dwordx4 a[212:215], v9, s[16:19], s40 offen offset:0
    buffer_load_dwordx4 a[216:219], v4, s[12:15], s40 offen offset:1024
    buffer_load_dwordx4 a[220:223], v5, s[16:19], s40 offen offset:1024
    buffer_load_dwordx4 a[224:227], v6, s[16:19], s40 offen offset:1024
    buffer_load_dwordx4 a[228:231], v7, s[16:19], s40 offen offset:1024
    buffer_load_dwordx4 a[232:235], v8, s[16:19], s40 offen offset:1024
    buffer_load_dwordx4 a[236:239], v9, s[16:19], s40 offen offset:1024
    s_mul_i32 s38, s9, 5
    s_add_u32 s36, s38, s10
    s_add_u32 s37, s38, 4
    s_mul_i32 s39, s8, 40
    s_lshl_b32 s41, s36, 1
    s_add_u32 s41, s41, s39
    s_lshl_b32 s41, s41, 10
    s_lshl_b32 s42, s37, 1
    s_add_u32 s42, s42, s39
    s_lshl_b32 s42, s42, 10
    s_waitcnt vmcnt(54)
    v_mfma_f32_32x32x16_bf16 v[128:143], a[4:7], a[0:3], 0
    v_mfma_f32_32x32x16_bf16 v[144:159], a[8:11], a[0:3], 0
    v_mfma_f32_32x32x16_bf16 v[160:175], a[12:15], a[0:3], 0
    v_mfma_f32_32x32x16_bf16 v[176:191], a[16:19], a[0:3], 0
    v_mfma_f32_32x32x16_bf16 v[192:207], a[20:23], a[0:3], 0
    buffer_load_dwordx4 a[0:3], v4, s[12:15], s40 offen offset:2048
    buffer_load_dwordx4 a[4:7], v5, s[16:19], s40 offen offset:2048
    buffer_load_dwordx4 a[8:11], v6, s[16:19], s40 offen offset:2048
    buffer_load_dwordx4 a[12:15], v7, s[16:19], s40 offen offset:2048
    buffer_load_dwordx4 a[16:19], v8, s[16:19], s40 offen offset:2048
    buffer_load_dwordx4 a[20:23], v9, s[16:19], s40 offen offset:2048
    s_waitcnt vmcnt(54)
    v_mfma_f32_32x32x16_bf16 v[128:143], a[28:31], a[24:27], v[128:143]
    v_mfma_f32_32x32x16_bf16 v[144:159], a[32:35], a[24:27], v[144:159]
    v_mfma_f32_32x32x16_bf16 v[160:175], a[36:39], a[24:27], v[160:175]
    v_mfma_f32_32x32x16_bf16 v[176:191], a[40:43], a[24:27], v[176:191]
    v_mfma_f32_32x32x16_bf16 v[192:207], a[44:47], a[24:27], v[192:207]
    buffer_load_dwordx4 a[24:27], v4, s[12:15], s40 offen offset:3072
    buffer_load_dwordx4 a[28:31], v5, s[16:19], s40 offen offset:3072
    buffer_load_dwordx4 a[32:35], v6, s[16:19], s40 offen offset:3072
    buffer_load_dwordx4 a[36:39], v7, s[16:19], s40 offen offset:3072
    buffer_load_dwordx4 a[40:43], v8, s[16:19], s40 offen offset:3072
    buffer_load_dwordx4 a[44:47], v9, s[16:19], s40 offen offset:3072
    s_waitcnt vmcnt(54)
    v_mfma_f32_32x32x16_bf16 v[128:143], a[52:55], a[48:51], v[128:143]
    v_mfma_f32_32x32x16_bf16 v[144:159], a[56:59], a[48:51], v[144:159]
    v_mfma_f32_32x32x16_bf16 v[160:175], a[60:63], a[48:51], v[160:175]
    v_mfma_f32_32x32x16_bf16 v[176:191], a[64:67], a[48:51], v[176:191]
    v_mfma_f32_32x32x16_bf16 v[192:207], a[68:71], a[48:51], v[192:207]
    s_mov_b32 s40, 0x3000
    buffer_load_dwordx4 a[48:51], v4, s[12:15], s40 offen offset:0
    buffer_load_dwordx4 a[52:55], v5, s[16:19], s40 offen offset:0
    buffer_load_dwordx4 a[56:59], v6, s[16:19], s40 offen offset:0
    buffer_load_dwordx4 a[60:63], v7, s[16:19], s40 offen offset:0
    buffer_load_dwordx4 a[64:67], v8, s[16:19], s40 offen offset:0
    buffer_load_dwordx4 a[68:71], v9, s[16:19], s40 offen offset:0
    s_waitcnt vmcnt(54)
    v_mfma_f32_32x32x16_bf16 v[128:143], a[76:79], a[72:75], v[128:143]
    v_mfma_f32_32x32x16_bf16 v[144:159], a[80:83], a[72:75], v[144:159]
    v_mfma_f32_32x32x16_bf16 v[160:175], a[84:87], a[72:75], v[160:175]
    v_mfma_f32_32x32x16_bf16 v[176:191], a[88:91], a[72:75], v[176:191]
    v_mfma_f32_32x32x16_bf16 v[192:207], a[92:95], a[72:75], v[192:207]
    buffer_load_dwordx4 a[72:75], v4, s[12:15], s40 offen offset:1024
    buffer_load_dwordx4 a[76:79], v5, s[16:19], s40 offen offset:1024
    buffer_load_dwordx4 a[80:83], v6, s[16:19], s40 offen offset:1024
    buffer_load_dwordx4 a[84:87], v7, s[16:19], s40 offen offset:1024
    buffer_load_dwordx4 a[88:91], v8, s[16:19], s40 offen offset:1024
    buffer_load_dwordx4 a[92:95], v9, s[16:19], s40 offen offset:1024
    s_waitcnt vmcnt(54)
    v_mfma_f32_32x32x16_bf16 v[128:143], a[100:103], a[96:99], v[128:143]
    v_mfma_f32_32x32x16_bf16 v[144:159], a[104:107], a[96:99], v[144:159]
    v_mfma_f32_32x32x16_bf16 v[160:175], a[108:111], a[96:99], v[160:175]
    v_mfma_f32_32x32x16_bf16 v[176:191], a[112:115], a[96:99], v[176:191]
    v_mfma_f32_32x32x16_bf16 v[192:207], a[116:119], a[96:99], v[192:207]
    buffer_load_dwordx4 a[96:99], v4, s[12:15], s40 offen offset:2048
    buffer_load_dwordx4 a[100:103], v5, s[16:19], s40 offen offset:2048
    buffer_load_dwordx4 a[104:107], v6, s[16:19], s40 offen offset:2048
    buffer_load_dwordx4 a[108:111], v7, s[16:19], s40 offen offset:2048
    buffer_load_dwordx4 a[112:115], v8, s[16:19], s40 offen offset:2048
    buffer_load_dwordx4 a[116:119], v9, s[16:19], s40 offen offset:2048
    s_waitcnt vmcnt(54)
    v_mfma_f32_32x32x16_bf16 v[128:143], a[124:127], a[120:123], v[128:143]
    v_mfma_f32_32x32x16_bf16 v[144:159], a[128:131], a[120:123], v[144:159]
    v_mfma_f32_32x32x16_bf16 v[160:175], a[132:135], a[120:123], v[160:175]
    v_mfma_f32_32x32x16_bf16 v[176:191], a[136:139], a[120:123], v[176:191]
    v_mfma_f32_32x32x16_bf16 v[192:207], a[140:143], a[120:123], v[192:207]
    buffer_load_dwordx4 a[120:123], v4, s[12:15], s40 offen offset:3072
    buffer_load_dwordx4 a[124:127], v5, s[16:19], s40 offen offset:3072
    buffer_load_dwordx4 a[128:131], v6, s[16:19], s40 offen offset:3072
    buffer_load_dwordx4 a[132:135], v7, s[16:19], s40 offen offset:3072
    buffer_load_dwordx4 a[136:139], v8, s[16:19], s40 offen offset:3072
    buffer_load_dwordx4 a[140:143], v9, s[16:19], s40 offen offset:3072
    s_waitcnt vmcnt(54)
    v_mfma_f32_32x32x16_bf16 v[128:143], a[148:151], a[144:147], v[128:143]
    v_mfma_f32_32x32x16_bf16 v[144:159], a[152:155], a[144:147], v[144:159]
    v_mfma_f32_32x32x16_bf16 v[160:175], a[156:159], a[144:147], v[160:175]
    v_mfma_f32_32x32x16_bf16 v[176:191], a[160:163], a[144:147], v[176:191]
    v_mfma_f32_32x32x16_bf16 v[192:207], a[164:167], a[144:147], v[192:207]
    s_mov_b32 s40, 0x4000
    buffer_load_dwordx4 a[144:147], v4, s[12:15], s40 offen offset:0
    buffer_load_dwordx4 a[148:151], v5, s[16:19], s40 offen offset:0
    buffer_load_dwordx4 a[152:155], v6, s[16:19], s40 offen offset:0
    buffer_load_dwordx4 a[156:159], v7, s[16:19], s40 offen offset:0
    buffer_load_dwordx4 a[160:163], v8, s[16:19], s40 offen offset:0
    buffer_load_dwordx4 a[164:167], v9, s[16:19], s40 offen offset:0
    s_waitcnt vmcnt(54)
    v_mfma_f32_32x32x16_bf16 v[128:143], a[172:175], a[168:171], v[128:143]
    v_mfma_f32_32x32x16_bf16 v[144:159], a[176:179], a[168:171], v[144:159]
    v_mfma_f32_32x32x16_bf16 v[160:175], a[180:183], a[168:171], v[160:175]
    v_mfma_f32_32x32x16_bf16 v[176:191], a[184:187], a[168:171], v[176:191]
    v_mfma_f32_32x32x16_bf16 v[192:207], a[188:191], a[168:171], v[192:207]
    buffer_load_dwordx4 a[168:171], v4, s[12:15], s40 offen offset:1024
    buffer_load_dwordx4 a[172:175], v5, s[16:19], s40 offen offset:1024
    buffer_load_dwordx4 a[176:179], v6, s[16:19], s40 offen offset:1024
    buffer_load_dwordx4 a[180:183], v7, s[16:19], s40 offen offset:1024
    buffer_load_dwordx4 a[184:187], v8, s[16:19], s40 offen offset:1024
    buffer_load_dwordx4 a[188:191], v9, s[16:19], s40 offen offset:1024
    s_waitcnt vmcnt(54)
    v_mfma_f32_32x32x16_bf16 v[128:143], a[196:199], a[192:195], v[128:143]
    v_mfma_f32_32x32x16_bf16 v[144:159], a[200:203], a[192:195], v[144:159]
    v_mfma_f32_32x32x16_bf16 v[160:175], a[204:207], a[192:195], v[160:175]
    v_mfma_f32_32x32x16_bf16 v[176:191], a[208:211], a[192:195], v[176:191]
    v_mfma_f32_32x32x16_bf16 v[192:207], a[212:215], a[192:195], v[192:207]
    buffer_load_dwordx4 a[192:195], v4, s[12:15], s40 offen offset:2048
    buffer_load_dwordx4 a[196:199], v5, s[16:19], s40 offen offset:2048
    buffer_load_dwordx4 a[200:203], v6, s[16:19], s40 offen offset:2048
    buffer_load_dwordx4 a[204:207], v7, s[16:19], s40 offen offset:2048
    buffer_load_dwordx4 a[208:211], v8, s[16:19], s40 offen offset:2048
    buffer_load_dwordx4 a[212:215], v9, s[16:19], s40 offen offset:2048
    s_waitcnt vmcnt(54)
    v_mfma_f32_32x32x16_bf16 v[128:143], a[220:223], a[216:219], v[128:143]
    v_mfma_f32_32x32x16_bf16 v[144:159], a[224:227], a[216:219], v[144:159]
    v_mfma_f32_32x32x16_bf16 v[160:175], a[228:231], a[216:219], v[160:175]
    v_mfma_f32_32x32x16_bf16 v[176:191], a[232:235], a[216:219], v[176:191]
    v_mfma_f32_32x32x16_bf16 v[192:207], a[236:239], a[216:219], v[192:207]
    buffer_load_dwordx4 a[216:219], v4, s[12:15], s40 offen offset:3072
    buffer_load_dwordx4 a[220:223], v5, s[16:19], s40 offen offset:3072
    buffer_load_dwordx4 a[224:227], v6, s[16:19], s40 offen offset:3072
    buffer_load_dwordx4 a[228:231], v7, s[16:19], s40 offen offset:3072
    buffer_load_dwordx4 a[232:235], v8, s[16:19], s40 offen offset:3072
    buffer_load_dwordx4 a[236:239], v9, s[16:19], s40 offen offset:3072
    s_waitcnt vmcnt(54)
    v_mfma_f32_32x32x16_bf16 v[128:143], a[4:7], a[0:3], v[128:143]
    v_mfma_f32_32x32x16_bf16 v[144:159], a[8:11], a[0:3], v[144:159]
    v_mfma_f32_32x32x16_bf16 v[160:175], a[12:15], a[0:3], v[160:175]
    v_mfma_f32_32x32x16_bf16 v[176:191], a[16:19], a[0:3], v[176:191]
    v_mfma_f32_32x32x16_bf16 v[192:207], a[20:23], a[0:3], v[192:207]
    s_mov_b32 s40, 0x5000
    buffer_load_dwordx4 a[0:3], v4, s[12:15], s40 offen offset:0
    buffer_load_dwordx4 a[4:7], v5, s[16:19], s40 offen offset:0
    buffer_load_dwordx4 a[8:11], v6, s[16:19], s40 offen offset:0
    buffer_load_dwordx4 a[12:15], v7, s[16:19], s40 offen offset:0
    buffer_load_dwordx4 a[16:19], v8, s[16:19], s40 offen offset:0
    buffer_load_dwordx4 a[20:23], v9, s[16:19], s40 offen offset:0
    s_waitcnt vmcnt(54)
    v_mfma_f32_32x32x16_bf16 v[128:143], a[28:31], a[24:27], v[128:143]
    v_mfma_f32_32x32x16_bf16 v[144:159], a[32:35], a[24:27], v[144:159]
    v_mfma_f32_32x32x16_bf16 v[160:175], a[36:39], a[24:27], v[160:175]
    v_mfma_f32_32x32x16_bf16 v[176:191], a[40:43], a[24:27], v[176:191]
    v_mfma_f32_32x32x16_bf16 v[192:207], a[44:47], a[24:27], v[192:207]
    buffer_load_dwordx4 a[24:27], v4, s[12:15], s40 offen offset:1024
    buffer_load_dwordx4 a[28:31], v5, s[16:19], s40 offen offset:1024
    buffer_load_dwordx4 a[32:35], v6, s[16:19], s40 offen offset:1024
    buffer_load_dwordx4 a[36:39], v7, s[16:19], s40 offen offset:1024
    buffer_load_dwordx4 a[40:43], v8, s[16:19], s40 offen offset:1024
    buffer_load_dwordx4 a[44:47], v9, s[16:19], s40 offen offset:1024
    s_waitcnt vmcnt(54)
    v_mfma_f32_32x32x16_bf16 v[128:143], a[52:55], a[48:51], v[128:143]
    v_mfma_f32_32x32x16_bf16 v[144:159], a[56:59], a[48:51], v[144:159]
    v_mfma_f32_32x32x16_bf16 v[160:175], a[60:63], a[48:51], v[160:175]
    v_mfma_f32_32x32x16_bf16 v[176:191], a[64:67], a[48:51], v[176:191]
    v_mfma_f32_32x32x16_bf16 v[192:207], a[68:71], a[48:51], v[192:207]
    buffer_load_dwordx4 a[48:51], v4, s[12:15], s40 offen offset:2048
    buffer_load_dwordx4 a[52:55], v5, s[16:19], s40 offen offset:2048
    buffer_load_dwordx4 a[56:59], v6, s[16:19], s40 offen offset:2048
    buffer_load_dwordx4 a[60:63], v7, s[16:19], s40 offen offset:2048
    buffer_load_dwordx4 a[64:67], v8, s[16:19], s40 offen offset:2048
    buffer_load_dwordx4 a[68:71], v9, s[16:19], s40 offen offset:2048
    s_waitcnt vmcnt(54)
    v_mfma_f32_32x32x16_bf16 v[128:143], a[76:79], a[72:75], v[128:143]
    v_mfma_f32_32x32x16_bf16 v[144:159], a[80:83], a[72:75], v[144:159]
    v_mfma_f32_32x32x16_bf16 v[160:175], a[84:87], a[72:75], v[160:175]
    v_mfma_f32_32x32x16_bf16 v[176:191], a[88:91], a[72:75], v[176:191]
    v_mfma_f32_32x32x16_bf16 v[192:207], a[92:95], a[72:75], v[192:207]
    buffer_load_dwordx4 a[72:75], v4, s[12:15], s40 offen offset:3072
    buffer_load_dwordx4 a[76:79], v5, s[16:19], s40 offen offset:3072
    buffer_load_dwordx4 a[80:83], v6, s[16:19], s40 offen offset:3072
    buffer_load_dwordx4 a[84:87], v7, s[16:19], s40 offen offset:3072
    buffer_load_dwordx4 a[88:91], v8, s[16:19], s40 offen offset:3072
    buffer_load_dwordx4 a[92:95], v9, s[16:19], s40 offen offset:3072
    s_waitcnt vmcnt(54)
    v_mfma_f32_32x32x16_bf16 v[128:143], a[100:103], a[96:99], v[128:143]
    v_mfma_f32_32x32x16_bf16 v[144:159], a[104:107], a[96:99], v[144:159]
    v_mfma_f32_32x32x16_bf16 v[160:175], a[108:111], a[96:99], v[160:175]
    v_mfma_f32_32x32x16_bf16 v[176:191], a[112:115], a[96:99], v[176:191]
    v_mfma_f32_32x32x16_bf16 v[192:207], a[116:119], a[96:99], v[192:207]
    s_mov_b32 s40, 0x6000
    buffer_load_dwordx4 a[96:99], v4, s[12:15], s40 offen offset:0
    buffer_load_dwordx4 a[100:103], v5, s[16:19], s40 offen offset:0
    buffer_load_dwordx4 a[104:107], v6, s[16:19], s40 offen offset:0
    buffer_load_dwordx4 a[108:111], v7, s[16:19], s40 offen offset:0
    buffer_load_dwordx4 a[112:115], v8, s[16:19], s40 offen offset:0
    buffer_load_dwordx4 a[116:119], v9, s[16:19], s40 offen offset:0
    s_waitcnt vmcnt(54)
    v_mfma_f32_32x32x16_bf16 v[128:143], a[124:127], a[120:123], v[128:143]
    v_mfma_f32_32x32x16_bf16 v[144:159], a[128:131], a[120:123], v[144:159]
    v_mfma_f32_32x32x16_bf16 v[160:175], a[132:135], a[120:123], v[160:175]
    v_mfma_f32_32x32x16_bf16 v[176:191], a[136:139], a[120:123], v[176:191]
    v_mfma_f32_32x32x16_bf16 v[192:207], a[140:143], a[120:123], v[192:207]
    buffer_load_dwordx4 a[120:123], v4, s[12:15], s40 offen offset:1024
    buffer_load_dwordx4 a[124:127], v5, s[16:19], s40 offen offset:1024
    buffer_load_dwordx4 a[128:131], v6, s[16:19], s40 offen offset:1024
    buffer_load_dwordx4 a[132:135], v7, s[16:19], s40 offen offset:1024
    buffer_load_dwordx4 a[136:139], v8, s[16:19], s40 offen offset:1024
    buffer_load_dwordx4 a[140:143], v9, s[16:19], s40 offen offset:1024
    s_waitcnt vmcnt(54)
    v_mfma_f32_32x32x16_bf16 v[128:143], a[148:151], a[144:147], v[128:143]
    v_mfma_f32_32x32x16_bf16 v[144:159], a[152:155], a[144:147], v[144:159]
    v_mfma_f32_32x32x16_bf16 v[160:175], a[156:159], a[144:147], v[160:175]
    v_mfma_f32_32x32x16_bf16 v[176:191], a[160:163], a[144:147], v[176:191]
    v_mfma_f32_32x32x16_bf16 v[192:207], a[164:167], a[144:147], v[192:207]
    buffer_load_dwordx4 a[144:147], v4, s[12:15], s40 offen offset:2048
    buffer_load_dwordx4 a[148:151], v5, s[16:19], s40 offen offset:2048
    buffer_load_dwordx4 a[152:155], v6, s[16:19], s40 offen offset:2048
    buffer_load_dwordx4 a[156:159], v7, s[16:19], s40 offen offset:2048
    buffer_load_dwordx4 a[160:163], v8, s[16:19], s40 offen offset:2048
    buffer_load_dwordx4 a[164:167], v9, s[16:19], s40 offen offset:2048
    s_waitcnt vmcnt(54)
    v_mfma_f32_32x32x16_bf16 v[128:143], a[172:175], a[168:171], v[128:143]
    v_mfma_f32_32x32x16_bf16 v[144:159], a[176:179], a[168:171], v[144:159]
    v_mfma_f32_32x32x16_bf16 v[160:175], a[180:183], a[168:171], v[160:175]
    v_mfma_f32_32x32x16_bf16 v[176:191], a[184:187], a[168:171], v[176:191]
    v_mfma_f32_32x32x16_bf16 v[192:207], a[188:191], a[168:171], v[192:207]
    buffer_load_dwordx4 v[12:15], v3, s[24:27], s41 offen
    buffer_load_dwordx4 v[16:19], v3, s[24:27], s41 offen offset:1024
    buffer_load_dwordx4 v[20:23], v3, s[24:27], s42 offen
    buffer_load_dwordx4 v[24:27], v3, s[24:27], s42 offen offset:1024
    s_waitcnt vmcnt(52)
    v_mfma_f32_32x32x16_bf16 v[128:143], a[196:199], a[192:195], v[128:143]
    v_mfma_f32_32x32x16_bf16 v[144:159], a[200:203], a[192:195], v[144:159]
    v_mfma_f32_32x32x16_bf16 v[160:175], a[204:207], a[192:195], v[160:175]
    v_mfma_f32_32x32x16_bf16 v[176:191], a[208:211], a[192:195], v[176:191]
    v_mfma_f32_32x32x16_bf16 v[192:207], a[212:215], a[192:195], v[192:207]
    s_waitcnt vmcnt(46)
    v_mfma_f32_32x32x16_bf16 v[128:143], a[220:223], a[216:219], v[128:143]
    v_mfma_f32_32x32x16_bf16 v[144:159], a[224:227], a[216:219], v[144:159]
    v_mfma_f32_32x32x16_bf16 v[160:175], a[228:231], a[216:219], v[160:175]
    v_mfma_f32_32x32x16_bf16 v[176:191], a[232:235], a[216:219], v[176:191]
    v_mfma_f32_32x32x16_bf16 v[192:207], a[236:239], a[216:219], v[192:207]
    s_waitcnt vmcnt(40)
    v_mfma_f32_32x32x16_bf16 v[128:143], a[4:7], a[0:3], v[128:143]
    v_mfma_f32_32x32x16_bf16 v[144:159], a[8:11], a[0:3], v[144:159]
    v_mfma_f32_32x32x16_bf16 v[160:175], a[12:15], a[0:3], v[160:175]
    v_mfma_f32_32x32x16_bf16 v[176:191], a[16:19], a[0:3], v[176:191]
    v_mfma_f32_32x32x16_bf16 v[192:207], a[20:23], a[0:3], v[192:207]
    s_waitcnt vmcnt(34)
    v_mfma_f32_32x32x16_bf16 v[128:143], a[28:31], a[24:27], v[128:143]
    v_mfma_f32_32x32x16_bf16 v[144:159], a[32:35], a[24:27], v[144:159]
    v_mfma_f32_32x32x16_bf16 v[160:175], a[36:39], a[24:27], v[160:175]
    v_mfma_f32_32x32x16_bf16 v[176:191], a[40:43], a[24:27], v[176:191]
    v_mfma_f32_32x32x16_bf16 v[192:207], a[44:47], a[24:27], v[192:207]
    s_waitcnt vmcnt(28)
    v_mfma_f32_32x32x16_bf16 v[128:143], a[52:55], a[48:51], v[128:143]
    v_mfma_f32_32x32x16_bf16 v[144:159], a[56:59], a[48:51], v[144:159]
    v_mfma_f32_32x32x16_bf16 v[160:175], a[60:63], a[48:51], v[160:175]
    v_mfma_f32_32x32x16_bf16 v[176:191], a[64:67], a[48:51], v[176:191]
    v_mfma_f32_32x32x16_bf16 v[192:207], a[68:71], a[48:51], v[192:207]
    s_waitcnt vmcnt(22)
    v_mfma_f32_32x32x16_bf16 v[128:143], a[76:79], a[72:75], v[128:143]
    v_mfma_f32_32x32x16_bf16 v[144:159], a[80:83], a[72:75], v[144:159]
    v_mfma_f32_32x32x16_bf16 v[160:175], a[84:87], a[72:75], v[160:175]
    v_mfma_f32_32x32x16_bf16 v[176:191], a[88:91], a[72:75], v[176:191]
    v_mfma_f32_32x32x16_bf16 v[192:207], a[92:95], a[72:75], v[192:207]
    s_waitcnt vmcnt(16)
    v_mfma_f32_32x32x16_bf16 v[128:143], a[100:103], a[96:99], v[128:143]
    v_mfma_f32_32x32x16_bf16 v[144:159], a[104:107], a[96:99], v[144:159]
    v_mfma_f32_32x32x16_bf16 v[160:175], a[108:111], a[96:99], v[160:175]
    v_mfma_f32_32x32x16_bf16 v[176:191], a[112:115], a[96:99], v[176:191]
    v_mfma_f32_32x32x16_bf16 v[192:207], a[116:119], a[96:99], v[192:207]
    s_waitcnt vmcnt(10)
    v_mfma_f32_32x32x16_bf16 v[128:143], a[124:127], a[120:123], v[128:143]
    v_mfma_f32_32x32x16_bf16 v[144:159], a[128:131], a[120:123], v[144:159]
    v_mfma_f32_32x32x16_bf16 v[160:175], a[132:135], a[120:123], v[160:175]
    v_mfma_f32_32x32x16_bf16 v[176:191], a[136:139], a[120:123], v[176:191]
    v_mfma_f32_32x32x16_bf16 v[192:207], a[140:143], a[120:123], v[192:207]
    s_waitcnt vmcnt(4)
    v_mfma_f32_32x32x16_bf16 v[128:143], a[148:151], a[144:147], v[128:143]
    v_mfma_f32_32x32x16_bf16 v[144:159], a[152:155], a[144:147], v[144:159]
    v_mfma_f32_32x32x16_bf16 v[160:175], a[156:159], a[144:147], v[160:175]
    v_mfma_f32_32x32x16_bf16 v[176:191], a[160:163], a[144:147], v[176:191]
    v_mfma_f32_32x32x16_bf16 v[192:207], a[164:167], a[144:147], v[192:207]
    s_waitcnt vmcnt(0)
    s_nop 15
    s_mul_i32 s43, s10, 20480
    v_add_u32 v10, s43, v3
    ds_write_b128 v10, v[128:131] offset:0
    ds_write_b128 v10, v[132:135] offset:1024
    ds_write_b128 v10, v[136:139] offset:2048
    ds_write_b128 v10, v[140:143] offset:3072
    ds_write_b128 v10, v[144:147] offset:4096
    ds_write_b128 v10, v[148:151] offset:5120
    ds_write_b128 v10, v[152:155] offset:6144
    ds_write_b128 v10, v[156:159] offset:7168
    ds_write_b128 v10, v[160:163] offset:8192
    ds_write_b128 v10, v[164:167] offset:9216
    ds_write_b128 v10, v[168:171] offset:10240
    ds_write_b128 v10, v[172:175] offset:11264
    ds_write_b128 v10, v[176:179] offset:12288
    ds_write_b128 v10, v[180:183] offset:13312
    ds_write_b128 v10, v[184:187] offset:14336
    ds_write_b128 v10, v[188:191] offset:15360
    ds_write_b128 v10, v[192:195] offset:16384
    ds_write_b128 v10, v[196:199] offset:17408
    ds_write_b128 v10, v[200:203] offset:18432
    ds_write_b128 v10, v[204:207] offset:19456
    s_waitcnt lgkmcnt(0)
    s_barrier
    s_lshl_b32 s43, s10, 12
    v_add_u32 v11, s43, v3
    ds_read_b128 v[32:35], v11 offset:0
    ds_read_b128 v[36:39], v11 offset:1024
    ds_read_b128 v[40:43], v11 offset:2048
    ds_read_b128 v[44:47], v11 offset:3072
    ds_read_b128 v[48:51], v11 offset:20480
    ds_read_b128 v[52:55], v11 offset:21504
    ds_read_b128 v[56:59], v11 offset:22528
    ds_read_b128 v[60:63], v11 offset:23552
    ds_read_b128 v[64:67], v11 offset:40960
    ds_read_b128 v[68:71], v11 offset:41984
    ds_read_b128 v[72:75], v11 offset:43008
    ds_read_b128 v[76:79], v11 offset:44032
    ds_read_b128 v[80:83], v11 offset:61440
    ds_read_b128 v[84:87], v11 offset:62464
    ds_read_b128 v[88:91], v11 offset:63488
    ds_read_b128 v[92:95], v11 offset:64512
    s_waitcnt lgkmcnt(0)
    v_pk_add_f32 v[32:33], v[32:33], v[48:49]
    v_pk_add_f32 v[64:65], v[64:65], v[80:81]
    v_pk_add_f32 v[34:35], v[34:35], v[50:51]
    v_pk_add_f32 v[66:67], v[66:67], v[82:83]
    v_pk_add_f32 v[36:37], v[36:37], v[52:53]
    v_pk_add_f32 v[68:69], v[68:69], v[84:85]
    v_pk_add_f32 v[38:39], v[38:39], v[54:55]
    v_pk_add_f32 v[70:71], v[70:71], v[86:87]
    v_pk_add_f32 v[40:41], v[40:41], v[56:57]
    v_pk_add_f32 v[72:73], v[72:73], v[88:89]
    v_pk_add_f32 v[42:43], v[42:43], v[58:59]
    v_pk_add_f32 v[74:75], v[74:75], v[90:91]
    v_pk_add_f32 v[44:45], v[44:45], v[60:61]
    v_pk_add_f32 v[76:77], v[76:77], v[92:93]
    v_pk_add_f32 v[46:47], v[46:47], v[62:63]
    v_pk_add_f32 v[78:79], v[78:79], v[94:95]
    v_pk_add_f32 v[32:33], v[32:33], v[64:65]
    v_pk_add_f32 v[34:35], v[34:35], v[66:67]
    v_pk_add_f32 v[36:37], v[36:37], v[68:69]
    v_pk_add_f32 v[38:39], v[38:39], v[70:71]
    v_pk_add_f32 v[40:41], v[40:41], v[72:73]
    v_pk_add_f32 v[42:43], v[42:43], v[74:75]
    v_pk_add_f32 v[44:45], v[44:45], v[76:77]
    v_pk_add_f32 v[46:47], v[46:47], v[78:79]
    v_cvt_pk_bf16_f32 v48, v32, v33
    v_cvt_pk_bf16_f32 v49, v34, v35
    v_cvt_pk_bf16_f32 v50, v36, v37
    v_cvt_pk_bf16_f32 v51, v38, v39
    v_cvt_pk_bf16_f32 v52, v40, v41
    v_cvt_pk_bf16_f32 v53, v42, v43
    v_cvt_pk_bf16_f32 v54, v44, v45
    v_cvt_pk_bf16_f32 v55, v46, v47
    v_lshlrev_b32 v32, 16, v48
    v_and_b32 v33, 0xffff0000, v48
    v_lshlrev_b32 v64, 16, v12
    v_and_b32 v65, 0xffff0000, v12
    v_lshlrev_b32 v34, 16, v49
    v_and_b32 v35, 0xffff0000, v49
    v_lshlrev_b32 v66, 16, v13
    v_and_b32 v67, 0xffff0000, v13
    v_lshlrev_b32 v36, 16, v50
    v_and_b32 v37, 0xffff0000, v50
    v_lshlrev_b32 v68, 16, v14
    v_and_b32 v69, 0xffff0000, v14
    v_lshlrev_b32 v38, 16, v51
    v_and_b32 v39, 0xffff0000, v51
    v_lshlrev_b32 v70, 16, v15
    v_and_b32 v71, 0xffff0000, v15
    v_lshlrev_b32 v40, 16, v52
    v_and_b32 v41, 0xffff0000, v52
    v_lshlrev_b32 v72, 16, v16
    v_and_b32 v73, 0xffff0000, v16
    v_lshlrev_b32 v42, 16, v53
    v_and_b32 v43, 0xffff0000, v53
    v_lshlrev_b32 v74, 16, v17
    v_and_b32 v75, 0xffff0000, v17
    v_lshlrev_b32 v44, 16, v54
    v_and_b32 v45, 0xffff0000, v54
    v_lshlrev_b32 v76, 16, v18
    v_and_b32 v77, 0xffff0000, v18
    v_lshlrev_b32 v46, 16, v55
    v_and_b32 v47, 0xffff0000, v55
    v_lshlrev_b32 v78, 16, v19
    v_and_b32 v79, 0xffff0000, v19
    v_pk_add_f32 v[32:33], v[32:33], v[64:65]
    v_pk_add_f32 v[34:35], v[34:35], v[66:67]
    v_pk_add_f32 v[36:37], v[36:37], v[68:69]
    v_pk_add_f32 v[38:39], v[38:39], v[70:71]
    v_pk_add_f32 v[40:41], v[40:41], v[72:73]
    v_pk_add_f32 v[42:43], v[42:43], v[74:75]
    v_pk_add_f32 v[44:45], v[44:45], v[76:77]
    v_pk_add_f32 v[46:47], v[46:47], v[78:79]
    v_cvt_pk_bf16_f32 v48, v32, v33
    v_cvt_pk_bf16_f32 v49, v34, v35
    v_cvt_pk_bf16_f32 v50, v36, v37
    v_cvt_pk_bf16_f32 v51, v38, v39
    v_cvt_pk_bf16_f32 v52, v40, v41
    v_cvt_pk_bf16_f32 v53, v42, v43
    v_cvt_pk_bf16_f32 v54, v44, v45
    v_cvt_pk_bf16_f32 v55, v46, v47
    s_lshl_b32 s46, s8, 5
    v_add_u32 v96, s46, v1
    s_movk_i32 s47, 1280
    v_mul_lo_u32 v96, v96, s47
    v_lshl_add_u32 v96, v2, 3, v96
    s_lshl_b32 s47, s36, 6
    buffer_store_dwordx2 v[48:49], v96, s[28:31], s47 offen offset:0
    buffer_store_dwordx2 v[50:51], v96, s[28:31], s47 offen offset:16
    buffer_store_dwordx2 v[52:53], v96, s[28:31], s47 offen offset:32
    buffer_store_dwordx2 v[54:55], v96, s[28:31], s47 offen offset:48
    s_nop 1
    s_cmp_lg_u32 s10, 3
    s_cbranch_scc1 L_downf_kernel_end
    v_add_u32 v11, 16384, v3
    ds_read_b128 v[32:35], v11 offset:0
    ds_read_b128 v[36:39], v11 offset:1024
    ds_read_b128 v[40:43], v11 offset:2048
    ds_read_b128 v[44:47], v11 offset:3072
    ds_read_b128 v[48:51], v11 offset:20480
    ds_read_b128 v[52:55], v11 offset:21504
    ds_read_b128 v[56:59], v11 offset:22528
    ds_read_b128 v[60:63], v11 offset:23552
    ds_read_b128 v[64:67], v11 offset:40960
    ds_read_b128 v[68:71], v11 offset:41984
    ds_read_b128 v[72:75], v11 offset:43008
    ds_read_b128 v[76:79], v11 offset:44032
    ds_read_b128 v[80:83], v11 offset:61440
    ds_read_b128 v[84:87], v11 offset:62464
    ds_read_b128 v[88:91], v11 offset:63488
    ds_read_b128 v[92:95], v11 offset:64512
    s_waitcnt lgkmcnt(0)
    v_pk_add_f32 v[32:33], v[32:33], v[48:49]
    v_pk_add_f32 v[64:65], v[64:65], v[80:81]
    v_pk_add_f32 v[34:35], v[34:35], v[50:51]
    v_pk_add_f32 v[66:67], v[66:67], v[82:83]
    v_pk_add_f32 v[36:37], v[36:37], v[52:53]
    v_pk_add_f32 v[68:69], v[68:69], v[84:85]
    v_pk_add_f32 v[38:39], v[38:39], v[54:55]
    v_pk_add_f32 v[70:71], v[70:71], v[86:87]
    v_pk_add_f32 v[40:41], v[40:41], v[56:57]
    v_pk_add_f32 v[72:73], v[72:73], v[88:89]
    v_pk_add_f32 v[42:43], v[42:43], v[58:59]
    v_pk_add_f32 v[74:75], v[74:75], v[90:91]
    v_pk_add_f32 v[44:45], v[44:45], v[60:61]
    v_pk_add_f32 v[76:77], v[76:77], v[92:93]
    v_pk_add_f32 v[46:47], v[46:47], v[62:63]
    v_pk_add_f32 v[78:79], v[78:79], v[94:95]
    v_pk_add_f32 v[32:33], v[32:33], v[64:65]
    v_pk_add_f32 v[34:35], v[34:35], v[66:67]
    v_pk_add_f32 v[36:37], v[36:37], v[68:69]
    v_pk_add_f32 v[38:39], v[38:39], v[70:71]
    v_pk_add_f32 v[40:41], v[40:41], v[72:73]
    v_pk_add_f32 v[42:43], v[42:43], v[74:75]
    v_pk_add_f32 v[44:45], v[44:45], v[76:77]
    v_pk_add_f32 v[46:47], v[46:47], v[78:79]
    v_cvt_pk_bf16_f32 v48, v32, v33
    v_cvt_pk_bf16_f32 v49, v34, v35
    v_cvt_pk_bf16_f32 v50, v36, v37
    v_cvt_pk_bf16_f32 v51, v38, v39
    v_cvt_pk_bf16_f32 v52, v40, v41
    v_cvt_pk_bf16_f32 v53, v42, v43
    v_cvt_pk_bf16_f32 v54, v44, v45
    v_cvt_pk_bf16_f32 v55, v46, v47
    v_lshlrev_b32 v32, 16, v48
    v_and_b32 v33, 0xffff0000, v48
    v_lshlrev_b32 v64, 16, v20
    v_and_b32 v65, 0xffff0000, v20
    v_lshlrev_b32 v34, 16, v49
    v_and_b32 v35, 0xffff0000, v49
    v_lshlrev_b32 v66, 16, v21
    v_and_b32 v67, 0xffff0000, v21
    v_lshlrev_b32 v36, 16, v50
    v_and_b32 v37, 0xffff0000, v50
    v_lshlrev_b32 v68, 16, v22
    v_and_b32 v69, 0xffff0000, v22
    v_lshlrev_b32 v38, 16, v51
    v_and_b32 v39, 0xffff0000, v51
    v_lshlrev_b32 v70, 16, v23
    v_and_b32 v71, 0xffff0000, v23
    v_lshlrev_b32 v40, 16, v52
    v_and_b32 v41, 0xffff0000, v52
    v_lshlrev_b32 v72, 16, v24
    v_and_b32 v73, 0xffff0000, v24
    v_lshlrev_b32 v42, 16, v53
    v_and_b32 v43, 0xffff0000, v53
    v_lshlrev_b32 v74, 16, v25
    v_and_b32 v75, 0xffff0000, v25
    v_lshlrev_b32 v44, 16, v54
    v_and_b32 v45, 0xffff0000, v54
    v_lshlrev_b32 v76, 16, v26
    v_and_b32 v77, 0xffff0000, v26
    v_lshlrev_b32 v46, 16, v55
    v_and_b32 v47, 0xffff0000, v55
    v_lshlrev_b32 v78, 16, v27
    v_and_b32 v79, 0xffff0000, v27
    v_pk_add_f32 v[32:33], v[32:33], v[64:65]
    v_pk_add_f32 v[34:35], v[34:35], v[66:67]
    v_pk_add_f32 v[36:37], v[36:37], v[68:69]
    v_pk_add_f32 v[38:39], v[38:39], v[70:71]
    v_pk_add_f32 v[40:41], v[40:41], v[72:73]
    v_pk_add_f32 v[42:43], v[42:43], v[74:75]
    v_pk_add_f32 v[44:45], v[44:45], v[76:77]
    v_pk_add_f32 v[46:47], v[46:47], v[78:79]
    v_cvt_pk_bf16_f32 v48, v32, v33
    v_cvt_pk_bf16_f32 v49, v34, v35
    v_cvt_pk_bf16_f32 v50, v36, v37
    v_cvt_pk_bf16_f32 v51, v38, v39
    v_cvt_pk_bf16_f32 v52, v40, v41
    v_cvt_pk_bf16_f32 v53, v42, v43
    v_cvt_pk_bf16_f32 v54, v44, v45
    v_cvt_pk_bf16_f32 v55, v46, v47
    s_lshl_b32 s46, s8, 5
    v_add_u32 v96, s46, v1
    s_movk_i32 s47, 1280
    v_mul_lo_u32 v96, v96, s47
    v_lshl_add_u32 v96, v2, 3, v96
    s_lshl_b32 s47, s37, 6
    buffer_store_dwordx2 v[48:49], v96, s[28:31], s47 offen offset:0
    buffer_store_dwordx2 v[50:51], v96, s[28:31], s47 offen offset:16
    buffer_store_dwordx2 v[52:53], v96, s[28:31], s47 offen offset:32
    buffer_store_dwordx2 v[54:55], v96, s[28:31], s47 offen offset:48
    s_nop 1
L_downf_kernel_end:
    s_endpgm
.section .rodata,"a"
.p2align 6
.p2align 6
.amdhsa_kernel prep_kernel
  .amdhsa_next_free_vgpr 128
  .amdhsa_next_free_sgpr 102
  .amdhsa_accum_offset 128
  .amdhsa_group_segment_fixed_size 0
  .amdhsa_kernarg_size 80
  .amdhsa_user_sgpr_count 2
  .amdhsa_user_sgpr_kernarg_segment_ptr 1
  .amdhsa_system_sgpr_workgroup_id_x 1
.end_amdhsa_kernel
.p2align 6
.amdhsa_kernel qkv_kernel
  .amdhsa_next_free_vgpr 320
  .amdhsa_next_free_sgpr 102
  .amdhsa_accum_offset 256
  .amdhsa_group_segment_fixed_size 0
  .amdhsa_kernarg_size 80
  .amdhsa_user_sgpr_count 2
  .amdhsa_user_sgpr_kernarg_segment_ptr 1
  .amdhsa_system_sgpr_workgroup_id_x 1
.end_amdhsa_kernel
.p2align 6
.amdhsa_kernel attn_kernel
  .amdhsa_next_free_vgpr 168
  .amdhsa_next_free_sgpr 102
  .amdhsa_accum_offset 168
  .amdhsa_group_segment_fixed_size 0
  .amdhsa_kernarg_size 80
  .amdhsa_user_sgpr_count 2
  .amdhsa_user_sgpr_kernarg_segment_ptr 1
  .amdhsa_system_sgpr_workgroup_id_x 1
.end_amdhsa_kernel
.p2align 6
.amdhsa_kernel wo_kernel
  .amdhsa_next_free_vgpr 496
  .amdhsa_next_free_sgpr 102
  .amdhsa_accum_offset 256
  .amdhsa_group_segment_fixed_size 0
  .amdhsa_kernarg_size 80
  .amdhsa_user_sgpr_count 2
  .amdhsa_user_sgpr_kernarg_segment_ptr 1
  .amdhsa_system_sgpr_workgroup_id_x 1
.end_amdhsa_kernel
.p2align 6
.amdhsa_kernel gu_kernel
  .amdhsa_next_free_vgpr 352
  .amdhsa_next_free_sgpr 102
  .amdhsa_accum_offset 256
  .amdhsa_group_segment_fixed_size 0
  .amdhsa_kernarg_size 80
  .amdhsa_user_sgpr_count 2
  .amdhsa_user_sgpr_kernarg_segment_ptr 1
  .amdhsa_system_sgpr_workgroup_id_x 1
.end_amdhsa_kernel
.p2align 6
.amdhsa_kernel down_kernel
  .amdhsa_next_free_vgpr 496
  .amdhsa_next_free_sgpr 102
  .amdhsa_accum_offset 256
  .amdhsa_group_segment_fixed_size 0
  .amdhsa_kernarg_size 80
  .amdhsa_user_sgpr_count 2
  .amdhsa_user_sgpr_kernarg_segment_ptr 1
  .amdhsa_system_sgpr_workgroup_id_x 1
.end_amdhsa_kernel
.p2align 6
.amdhsa_kernel downf_kernel
  .amdhsa_next_free_vgpr 496
  .amdhsa_next_free_sgpr 102
  .amdhsa_accum_offset 256
  .amdhsa_group_segment_fixed_size 0
  .amdhsa_kernarg_size 80
  .amdhsa_user_sgpr_count 2
  .amdhsa_user_sgpr_kernarg_segment_ptr 1
  .amdhsa_system_sgpr_workgroup_id_x 1
.end_amdhsa_kernel
```
